```python
import torch

def _softmax(x, axis=-1):
    return torch.softmax(x, dim=axis)
def _gelu(x):
    return torch.nn.functional.gelu(x, approximate="tanh")
def _silu(x):
    return torch.nn.functional.silu(x)
def _sigmoid(x):
    return torch.sigmoid(x)
def _layernorm(x, axis=-1, eps=1e-5):
    m = x.mean(dim=axis, keepdim=True)
    v = x.var(dim=axis, keepdim=True, unbiased=False)
    return (x - m) / torch.sqrt(v + eps)
def _scatter_add(tgt, idx, src, axis=0):
    return tgt.clone().index_add_(axis, idx, src)
def _segment_sum(src, seg, n):
    out = torch.zeros((n,) + src.shape[1:], dtype=src.dtype)
    return out.index_add_(0, seg, src)
def _pad(x, pw):
    flat = tuple(v for pair in reversed(pw) for v in pair)
    return torch.nn.functional.pad(x, flat)

kernel_name = 'recurrent_scan__sliding_block__glu_gated_swiglu__prompt'

def setup_inputs():

    _w = (lambda a: (lambda t: t.to(torch.bfloat16) if t.is_floating_point() else t)(torch.as_tensor(a)))
    def _A_setup():
        B, S, D = 1, 2048, 448
        return {
            "x": _w((lambda *s: torch.randn(*s, dtype=torch.bfloat16) * 0.05)(B, S, D)),
            "wqkv": _w((lambda *s: torch.randn(*s, dtype=torch.bfloat16) * 0.2)(D, 3 * D)),
            "wo": _w((lambda *s: torch.randn(*s, dtype=torch.bfloat16) * 0.2)(D, D)),
        }
    _A_in = _A_setup()

    def _B_setup():
        B, S, D, F = 1, 2048, 448, 1792
        return {
            "x": _w((lambda *s: torch.randn(*s, dtype=torch.bfloat16) * 0.05)(B, S, D)),
            "w1": _w((lambda *s: torch.randn(*s, dtype=torch.bfloat16) * 0.1)(D, F) * (2.0 / D) ** 0.5),
            "w3": _w((lambda *s: torch.randn(*s, dtype=torch.bfloat16) * 0.1)(D, F) * (2.0 / D) ** 0.5),
            "w2": _w((lambda *s: torch.randn(*s, dtype=torch.bfloat16) * 0.1)(F, D) * (2.0 / F) ** 0.5),
        }
    _B_in = _B_setup()

    return {
        "A_x": _A_in["x"],
        "A_wqkv": _A_in["wqkv"],
        "A_wo": _A_in["wo"],
        "B_x": _B_in["x"],
        "B_w1": _B_in["w1"],
        "B_w3": _B_in["w3"],
        "B_w2": _B_in["w2"],
    }

def reference(A_x, A_wqkv, A_wo, B_x, B_w1, B_w3, B_w2):
    def _A_ref(x, wqkv, wo):
        B, S, D = x.shape
        H = 16; Dh = D // H; W = 256
        qkv = (lambda x, *d: x.permute(*d))((x @ wqkv).reshape(B, S, 3, H, Dh), 2, 0, 3, 1, 4)
        q, k, v = qkv[0], qkv[1], qkv[2]
        scores = torch.einsum("bhqd,bhkd->bhqk", q, k) * (Dh ** -0.5)
        idx = torch.arange(S)
        mask = (idx[:, None] - idx[None, :] >= 0) & (idx[:, None] - idx[None, :] < W)
        scores = torch.where(mask[None, None], scores, -1e9)
        p = _softmax(scores, axis=-1)
        o = torch.einsum("bhqk,bhkd->bhqd", p, v)
        return (lambda x, *d: x.permute(*d))(o, 0, 2, 1, 3).reshape(B, S, D) @ wo

    def _B_ref(x, w1, w3, w2):
        gate = torch.einsum("bsd,df->bsf", x, w1)
        up = torch.einsum("bsd,df->bsf", x, w3)
        h = _silu(gate) * up
        out = torch.einsum("bsf,fd->bsd", h, w2)
        return out

    x = A_x
    xn = _layernorm(x, axis=-1)
    s = _A_ref(xn, A_wqkv, A_wo)
    g = _silu(_B_ref(xn, B_w1, B_w3, B_w2))
    return x + s * g
```

```asm
; @launch grid=(256,1,1) block=(256,1,1) lds=163840
.amdgcn_target "amdgcn-amd-amdhsa--gfx950"
.text
.globl recurrent_scan__sliding_block__glu_gated_swiglu__prompt_kernel
.p2align 12
.fill 832, 4, 0xbf810000
.p2align 8
.type recurrent_scan__sliding_block__glu_gated_swiglu__prompt_kernel,@function
recurrent_scan__sliding_block__glu_gated_swiglu__prompt_kernel:
    s_cmp_ge_u32 s2, 256
    s_cbranch_scc1 L_exit
    s_load_dwordx2 s[4:5], s[0:1], 0
    s_load_dwordx16 s[36:51], s[0:1], 8
    s_load_dwordx2 s[24:25], s[0:1], 72
    v_lshrrev_b32 v2, 6, v0
    v_and_b32 v0, 63, v0
    s_and_b32 s57, s2, 7
    v_readfirstlane_b32 s55, v2
    s_lshr_b32 s56, s2, 3
    s_getpc_b64 s[60:61]
L_pc:
    s_and_b32 s62, s56, 3
    s_lshl_b32 s62, s62, 2
    s_add_u32 s62, s62, s55
    s_lshl_b32 s62, s62, 11
    s_cmp_lt_u32 s56, 4
    s_cselect_b32 s63, L_Q-L_pc, 0
    s_add_u32 s62, s62, s63
    v_and_b32 v250, 15, v0
    v_lshl_add_u32 v250, v250, 7, s62
    v_min_u32 v250, L_pfend-L_pc, v250
    v_mov_b32 v251, s61
    v_add_co_u32 v250, vcc, s60, v250
    s_nop 1
    v_addc_co_u32 v251, vcc, 0, v251, vcc
    global_load_dword v253, v[250:251], off
    s_lshr_b32 s61, s57, 1
    s_mul_i32 s60, s61, 28
    s_sub_u32 s60, s60, 4
    s_lshl_b32 s61, s61, 2
    s_add_u32 s53, s61, 112
    s_cmp_lt_u32 s56, 4
    s_cselect_b32 s60, s53, s60
    s_add_u32 s60, s60, s56
    s_lshr_b32 s53, s60, 3
    s_and_b32 s60, s60, 7
    s_and_b32 s57, s57, 1
    s_lshl_b32 s52, s57, 3
    s_add_u32 s52, s52, s60
    s_lshl_b32 s100, s57, 4
    s_add_u32 s100, s100, s61
    s_mul_i32 s61, s53, 1
    s_add_u32 s54, s60, s61
    s_mul_i32 s60, s54, 37
    s_lshr_b32 s60, s60, 8
    s_mul_i32 s60, s60, 7
    s_sub_u32 s54, s54, s60
    s_lshl_b32 s58, s52, 2
    s_add_u32 s58, s58, s55
    s_mul_i32 s80, s55, 28672
    s_add_u32 s80, s80, 49152
    s_lshl_b32 s99, s55, 12
    s_mov_b32 s6, 1835008
    s_mov_b32 s7, 0x20000
    s_mov_b32 s26, 268435456
    s_mov_b32 s27, 0x20000
    v_lshrrev_b32 v2, 3, v0
    v_and_b32 v3, 7, v0
    v_lshrrev_b32 v4, 4, v0
    v_xor_b32 v4, v3, v4
    v_mul_u32_u24 v5, 896, v2
    v_lshl_add_u32 v24, v4, 4, v5
    v_xor_b32 v25, 64, v24
    v_add_u32 v25, 6144, v25
    v_add_u32 v26, 12288, v24
    v_add_u32 v27, 12288, v25
    v_lshlrev_b32 v1, 4, v0
    s_mul_i32 s30, s58, 28672
    s_lshl_b32 s28, s54, 7
    s_add_u32 s28, s28, s30
    s_add_u32 s29, s30, 896
    s_mov_b32 m0, s80
    s_cmp_ge_u32 s53, 14
    s_cbranch_scc1 L_Q
    s_lshl_b32 s3, s53, 6
    s_add_u32 s3, s3, s58
    s_mul_i32 s31, s3, 7
    v_min_u32 v23, 6, v0
    v_add_u32 v23, s31, v23
    v_lshl_add_u32 v23, v23, 1, 1
    v_lshlrev_b32 v23, 7, v23
    s_lshl_b32 s31, s31, 1
    v_min_u32 v22, 13, v0
    v_add_lshl_u32 v22, v22, s31, 7
    v_lshl_add_u32 v5, s55, 4, v2
    v_bfe_u32 v4, v0, 4, 1
    v_lshlrev_b32 v7, 4, v3
    v_lshlrev_b32 v6, 6, v4
    v_xor_b32 v6, v6, v7
    v_mul_u32_u24 v12, 2688, v5
    v_add_u32 v12, v12, v6
    v_add_u32 v13, 20480, v12
    v_mul_u32_u24 v16, 896, v2
    v_add_u32 v16, v16, v6
    v_add_u32 v17, 6144, v16
    v_lshlrev_b32 v6, 5, v4
    v_xor_b32 v6, v6, v7
    v_mul_u32_u24 v8, 3584, v5
    v_add_u32 v8, v8, v6
    v_add_u32 v9, 27648, v8
    v_xor_b32 v10, 64, v8
    v_xor_b32 v11, 64, v9
    s_mov_b32 s1, s54
    s_lshl_b32 s59, s53, 8
    s_lshl_b32 s62, s53, 7
    s_add_u32 s62, s62, 896
    s_mul_i32 s66, s1, 229376
    s_add_u32 s66, s66, s59
    s_mul_i32 s73, s1, 172032
    s_add_u32 s73, s73, s62
    s_add_u32 s73, s73, 2048
    s_add_u32 s1, s1, 1
    s_cmp_eq_u32 s1, 7
    s_cselect_b32 s1, 0, s1
    s_mul_i32 s67, s1, 229376
    s_add_u32 s67, s67, s59
    s_mul_i32 s74, s1, 172032
    s_add_u32 s74, s74, s62
    s_add_u32 s1, s1, 1
    s_cmp_eq_u32 s1, 7
    s_cselect_b32 s1, 0, s1
    s_mul_i32 s68, s1, 229376
    s_add_u32 s68, s68, s59
    s_mul_i32 s75, s1, 172032
    s_add_u32 s75, s75, s62
    s_add_u32 s75, s75, 2048
    s_waitcnt lgkmcnt(0)
    buffer_load_dwordx4 v24, s[4:7], s28 offen offset:0 lds
    buffer_load_dwordx4 v25, s[4:7], s28 offen offset:1024 lds
    buffer_load_dwordx4 v26, s[4:7], s28 offen offset:2048 lds
    buffer_load_dwordx4 v27, s[4:7], s28 offen offset:3072 lds
    s_add_u32 m0, s80, 4096
    s_add_u32 s28, s28, 128
    s_cmp_eq_u32 s28, s29
    s_cselect_b32 s28, s30, s28
    s_add_u32 s1, s1, 1
    s_cmp_eq_u32 s1, 7
    s_cselect_b32 s1, 0, s1
    s_mul_i32 s69, s1, 229376
    s_add_u32 s69, s69, s59
    s_mul_i32 s76, s1, 172032
    s_add_u32 s76, s76, s62
    s_add_u32 s1, s1, 1
    s_cmp_eq_u32 s1, 7
    s_cselect_b32 s1, 0, s1
    s_mul_i32 s70, s1, 229376
    s_add_u32 s70, s70, s59
    s_mul_i32 s77, s1, 172032
    s_add_u32 s77, s77, s62
    buffer_load_dwordx4 v24, s[4:7], s28 offen offset:0 lds
    s_add_u32 s77, s77, 2048
    s_add_u32 s1, s1, 1
    s_cmp_eq_u32 s1, 7
    s_cselect_b32 s1, 0, s1
    s_mul_i32 s71, s1, 229376
    s_add_u32 s71, s71, s59
    s_mul_i32 s78, s1, 172032
    s_add_u32 s78, s78, s62
    s_add_u32 s1, s1, 1
    s_cmp_eq_u32 s1, 7
    s_cselect_b32 s1, 0, s1
    s_mul_i32 s72, s1, 229376
    s_add_u32 s72, s72, s59
    s_mul_i32 s79, s1, 172032
    buffer_load_dwordx4 v25, s[4:7], s28 offen offset:1024 lds
    s_add_u32 s79, s79, s62
    s_add_u32 s79, s79, 2048
    v_lshrrev_b32 v240, 5, v0
    v_bfe_u32 v241, v0, 4, 1
    v_bfe_u32 v242, v0, 2, 2
    v_and_b32 v243, 3, v0
    v_and_b32 v244, 31, v0
    v_bfe_u32 v245, v0, 3, 1
    v_lshlrev_b32 v246, 7, v242
    v_lshl_add_u32 v246, v243, 3, v246
    v_lshl_add_u32 v247, v245, 1, v241
    v_lshl_add_u32 v247, v247, 5, v246
    buffer_load_dwordx4 v26, s[4:7], s28 offen offset:2048 lds
    v_lshl_add_u32 v6, v240, 10, v247
    v_xor_b32 v7, 64, v6
    v_lshl_add_u32 v14, v240, 9, v247
    v_add_u32 v14, s80, v14
    s_lshr_b32 s60, s55, 1
    s_lshl_b32 s60, s60, 6
    v_xor_b32 v14, s60, v14
    v_xor_b32 v15, 64, v14
    v_lshl_add_u32 v247, v241, 1, v245
    v_lshl_add_u32 v247, v247, 5, v246
    v_lshl_add_u32 v247, v240, 10, v247
    v_lshl_add_u32 v247, v241, 11, v247
    buffer_load_dwordx4 v27, s[4:7], s28 offen offset:3072 lds
    s_add_u32 m0, s80, 8192
    s_add_u32 s28, s28, 128
    s_cmp_eq_u32 s28, s29
    s_cselect_b32 s28, s30, s28
    v_add_u32 v2, 49152, v247
    v_xor_b32 v3, 32, v2
    v_xor_b32 v4, 64, v2
    v_xor_b32 v5, 96, v2
    v_bfe_u32 v247, v0, 1, 3
    v_xor_b32 v247, v247, v240
    v_lshlrev_b32 v247, 4, v247
    v_lshl_add_u32 v18, v244, 7, v247
    v_add_u32 v18, s80, v18
    v_xor_b32 v19, 32, v18
    v_xor_b32 v20, 64, v18
    v_xor_b32 v21, 96, v18
    buffer_load_dwordx4 v24, s[4:7], s28 offen offset:0 lds
    v_mov_b32 v247, 0x3f803f80
    v_accvgpr_write_b32 a248, v247
    v_accvgpr_write_b32 a249, v247
    s_sub_u32 s8, s36, 2048
    s_subb_u32 s9, s37, 0
    s_mov_b32 s10, 1206272
    s_mov_b32 s11, 0x20000
    s_mov_b32 s12, s42
    s_mov_b32 s13, s43
    s_mov_b32 s14, 1605632
    s_mov_b32 s15, 0x20000
    s_sub_u32 s16, s44, 2048
    s_subb_u32 s17, s45, 0
    s_mov_b32 s18, 1607680
    buffer_load_dwordx4 v25, s[4:7], s28 offen offset:1024 lds
    s_mov_b32 s19, 0x20000
    s_mov_b32 s32, s50
    s_mov_b32 s33, s51
    s_mov_b32 s20, s46
    s_mov_b32 s21, s47
    s_mov_b32 s22, 1605632
    s_mov_b32 s23, 0x20000
    s_and_b32 s60, s56, 3
    s_add_u32 s100, s100, s60
    s_lshr_b32 s101, s56, 2
    s_sub_u32 s101, s101, 1
    s_mul_i32 s84, s55, 14336
    buffer_load_dwordx4 v26, s[4:7], s28 offen offset:2048 lds
    s_lshl_b32 s60, s101, 7
    s_add_u32 s84, s84, s60
    s_mul_i32 s61, s58, 86016
    s_add_u32 s61, s61, 65536
    s_lshl_b32 s60, s53, 12
    s_add_u32 s82, s61, s60
    s_add_u32 s82, s82, 28672
    s_lshl_b32 s41, s52, 7
    s_cmp_ge_u32 s53, 7
    s_cselect_b32 s60, 4, 0
    s_add_u32 s44, s41, s60
    s_mul_i32 s60, s60, 7
    s_lshl2_add_u32 s43, s53, s55
    buffer_load_dwordx4 v27, s[4:7], s28 offen offset:3072 lds
    s_add_u32 m0, s80, 12288
    s_add_u32 s28, s28, 128
    s_cmp_eq_u32 s28, s29
    s_cselect_b32 s28, s30, s28
    s_sub_u32 s60, s43, s60
    s_lshl_b32 s43, 1, s60
    s_mov_b32 s0, 0x3fb8aa3b
    s_min_u32 s60, s55, 2
    s_add_u32 s60, s60, s52
    s_max_u32 s60, s60, 2
    s_sub_u32 s60, s60, 2
    s_lshl_b32 s42, s60, 7
    s_lshr_b32 s60, s58, 1
    s_lshl_b32 s83, s60, 7
    s_and_b32 s60, s55, 1
    s_lshl1_add_u32 s60, s53, s60
    buffer_load_dwordx4 v24, s[4:7], s28 offen offset:0 lds
    s_lshl_b32 s91, 1, s60
    s_mul_i32 s81, s58, 114688
    s_lshl_b32 s60, s53, 13
    s_add_u32 s81, s81, s60
    s_add_u32 s81, s81, 6291456
    s_mul_i32 s97, s100, 229376
    s_lshl_b32 s60, s55, 10
    s_add_u32 s97, s97, s60
    s_add_u32 s97, s97, 6291456
    s_mul_i32 s59, s53, 7
    s_lshr_b32 s59, s59, 1
    s_lshl_b32 s60, s59, 9
    buffer_load_dwordx4 v25, s[4:7], s28 offen offset:1024 lds
    s_add_u32 s60, s60, 28672
    s_add_u32 s87, s61, s60
    s_add_u32 s60, s60, 65536
    s_sub_u32 s85, s87, 688128
    s_add_u32 s88, s85, 28672
    s_waitcnt vmcnt(10)
    s_cmp_eq_u32 s99, 0
    s_cbranch_scc1 L_padG1
    s_cmp_eq_u32 s99, 4096
    s_cbranch_scc1 L_padG2
    s_cmp_eq_u32 s99, 8192
    s_cbranch_scc1 L_padG3
    s_branch L_padG4
L_retGa:
    ds_read_b128 v[36:39], v18 offset:0
    ds_read_b128 v[44:47], v19 offset:0
    ds_read_b128 v[52:55], v20 offset:0
    ds_read_b128 v[60:63], v21 offset:0
    buffer_load_dwordx4 v26, s[4:7], s28 offen offset:2048 lds
    s_cmp_ge_u32 s52, 2
    s_cselect_b32 s85, s85, s60
    s_cselect_b32 s88, s88, 268435456
    s_sub_u32 s86, s87, 344064
    s_add_u32 s89, s86, 28672
    s_cmp_ge_u32 s52, 1
    s_cselect_b32 s86, s86, s60
    s_cselect_b32 s89, s89, 268435456
    s_lshr_b32 s60, s59, 3
    s_lshl_b32 s60, s60, 2
    s_lshl_b32 s90, 15, s60
    s_add_u32 s60, s59, 3
    s_lshr_b32 s60, s60, 3
    s_lshl_b32 s60, s60, 2
    s_waitcnt lgkmcnt(3)
    v_mfma_f32_4x4x4_16b_bf16 a[0:3], a[248:249], v[36:37], 0
    v_mfma_f32_4x4x4_16b_bf16 v[28:31], v[36:37], v[36:37], 0
    s_lshl_b32 s60, 15, s60
    buffer_load_dwordx4 v27, s[4:7], s28 offen offset:3072 lds
    s_add_u32 m0, s80, 16384
    s_add_u32 s28, s28, 128
    s_cmp_eq_u32 s28, s29
    s_cselect_b32 s28, s30, s28
    s_or_b32 s90, s90, s60
    v_mfma_f32_4x4x4_16b_bf16 a[0:3], a[248:249], v[38:39], a[0:3]
    v_mfma_f32_4x4x4_16b_bf16 v[28:31], v[38:39], v[38:39], v[28:31]
    s_cmp_ge_u32 s53, 8
    s_cselect_b32 s96, 16, 1
    s_lshl_b32 s96, s96, s55
    s_waitcnt lgkmcnt(2)
    v_mfma_f32_4x4x4_16b_bf16 a[0:3], a[248:249], v[44:45], a[0:3]
    v_mfma_f32_4x4x4_16b_bf16 v[28:31], v[44:45], v[44:45], v[28:31]
    s_bitcmp1_b32 s53, 0
    s_cselect_b32 s92, -1, 0
    s_cselect_b32 s95, 0, -1
    s_mov_b32 s93, 0
    v_mfma_f32_4x4x4_16b_bf16 a[0:3], a[248:249], v[46:47], a[0:3]
    v_mfma_f32_4x4x4_16b_bf16 v[28:31], v[46:47], v[46:47], v[28:31]
    s_mov_b32 s94, 0
    s_waitcnt lgkmcnt(1)
    buffer_load_dwordx4 v24, s[4:7], s28 offen offset:0 lds
    v_mfma_f32_4x4x4_16b_bf16 a[0:3], a[248:249], v[52:53], a[0:3]
    v_mfma_f32_4x4x4_16b_bf16 v[28:31], v[52:53], v[52:53], v[28:31]
    s_lshl_b32 s98, s58, 15
    v_mfma_f32_4x4x4_16b_bf16 a[0:3], a[248:249], v[54:55], a[0:3]
    v_mfma_f32_4x4x4_16b_bf16 v[28:31], v[54:55], v[54:55], v[28:31]
    s_lshl_b32 s60, s53, 11
    s_waitcnt lgkmcnt(0)
    v_mfma_f32_4x4x4_16b_bf16 a[0:3], a[248:249], v[60:61], a[0:3]
    v_mfma_f32_4x4x4_16b_bf16 v[28:31], v[60:61], v[60:61], v[28:31]
    s_add_u32 s98, s98, s60
    v_mfma_f32_4x4x4_16b_bf16 a[0:3], a[248:249], v[62:63], a[0:3]
    v_mfma_f32_4x4x4_16b_bf16 v[28:31], v[62:63], v[62:63], v[28:31]
    s_add_u32 s98, s98, 14680064
    s_waitcnt vmcnt(9)
    buffer_load_dwordx4 v25, s[4:7], s28 offen offset:1024 lds
    ds_read_b128 v[68:71], v18 offset:4096
    ds_read_b128 v[76:79], v19 offset:4096
    ds_read_b128 v[84:87], v20 offset:4096
    ds_read_b128 v[92:95], v21 offset:4096
    v_lshlrev_b32 v32, 16, v36
    v_and_b32 v33, 0xffff0000, v36
    v_lshlrev_b32 v34, 16, v37
    v_and_b32 v35, 0xffff0000, v37
    v_lshlrev_b32 v36, 16, v38
    v_and_b32 v37, 0xffff0000, v38
    v_lshlrev_b32 v38, 16, v39
    v_and_b32 v39, 0xffff0000, v39
    v_lshlrev_b32 v40, 16, v44
    v_and_b32 v41, 0xffff0000, v44
    buffer_load_dwordx4 v26, s[4:7], s28 offen offset:2048 lds
    s_waitcnt lgkmcnt(3)
    v_mfma_f32_4x4x4_16b_bf16 a[0:3], a[248:249], v[68:69], a[0:3]
    v_mfma_f32_4x4x4_16b_bf16 v[28:31], v[68:69], v[68:69], v[28:31]
    v_lshlrev_b32 v42, 16, v45
    v_and_b32 v43, 0xffff0000, v45
    v_lshlrev_b32 v44, 16, v46
    v_mfma_f32_4x4x4_16b_bf16 a[0:3], a[248:249], v[70:71], a[0:3]
    v_mfma_f32_4x4x4_16b_bf16 v[28:31], v[70:71], v[70:71], v[28:31]
    v_and_b32 v45, 0xffff0000, v46
    v_lshlrev_b32 v46, 16, v47
    v_and_b32 v47, 0xffff0000, v47
    s_waitcnt lgkmcnt(2)
    v_mfma_f32_4x4x4_16b_bf16 a[0:3], a[248:249], v[76:77], a[0:3]
    v_mfma_f32_4x4x4_16b_bf16 v[28:31], v[76:77], v[76:77], v[28:31]
    buffer_load_dwordx4 v27, s[4:7], s28 offen offset:3072 lds
    s_add_u32 m0, s80, 20480
    s_add_u32 s28, s28, 128
    s_cmp_eq_u32 s28, s29
    s_cselect_b32 s28, s30, s28
    v_lshlrev_b32 v48, 16, v52
    v_and_b32 v49, 0xffff0000, v52
    v_lshlrev_b32 v50, 16, v53
    v_mfma_f32_4x4x4_16b_bf16 a[0:3], a[248:249], v[78:79], a[0:3]
    v_mfma_f32_4x4x4_16b_bf16 v[28:31], v[78:79], v[78:79], v[28:31]
    v_and_b32 v51, 0xffff0000, v53
    v_lshlrev_b32 v52, 16, v54
    v_and_b32 v53, 0xffff0000, v54
    s_waitcnt lgkmcnt(1)
    v_mfma_f32_4x4x4_16b_bf16 a[0:3], a[248:249], v[84:85], a[0:3]
    v_mfma_f32_4x4x4_16b_bf16 v[28:31], v[84:85], v[84:85], v[28:31]
    v_lshlrev_b32 v54, 16, v55
    v_and_b32 v55, 0xffff0000, v55
    v_lshlrev_b32 v56, 16, v60
    buffer_load_dwordx4 v24, s[4:7], s28 offen offset:0 lds
    v_mfma_f32_4x4x4_16b_bf16 a[0:3], a[248:249], v[86:87], a[0:3]
    v_mfma_f32_4x4x4_16b_bf16 v[28:31], v[86:87], v[86:87], v[28:31]
    v_and_b32 v57, 0xffff0000, v60
    v_lshlrev_b32 v58, 16, v61
    v_and_b32 v59, 0xffff0000, v61
    s_waitcnt lgkmcnt(0)
    v_mfma_f32_4x4x4_16b_bf16 a[0:3], a[248:249], v[92:93], a[0:3]
    v_mfma_f32_4x4x4_16b_bf16 v[28:31], v[92:93], v[92:93], v[28:31]
    v_lshlrev_b32 v60, 16, v62
    v_and_b32 v61, 0xffff0000, v62
    v_mfma_f32_4x4x4_16b_bf16 a[0:3], a[248:249], v[94:95], a[0:3]
    v_mfma_f32_4x4x4_16b_bf16 v[28:31], v[94:95], v[94:95], v[28:31]
    v_lshlrev_b32 v62, 16, v63
    v_and_b32 v63, 0xffff0000, v63
    buffer_load_dwordx4 v25, s[4:7], s28 offen offset:1024 lds
    s_waitcnt vmcnt(10)
    ds_read_b128 v[100:103], v18 offset:8192
    ds_read_b128 v[108:111], v19 offset:8192
    ds_read_b128 v[116:119], v20 offset:8192
    ds_read_b128 v[124:127], v21 offset:8192
    v_lshlrev_b32 v64, 16, v68
    v_and_b32 v65, 0xffff0000, v68
    v_lshlrev_b32 v66, 16, v69
    v_and_b32 v67, 0xffff0000, v69
    v_lshlrev_b32 v68, 16, v70
    v_and_b32 v69, 0xffff0000, v70
    v_lshlrev_b32 v70, 16, v71
    v_and_b32 v71, 0xffff0000, v71
    v_lshlrev_b32 v72, 16, v76
    buffer_load_dwordx4 v26, s[4:7], s28 offen offset:2048 lds
    v_and_b32 v73, 0xffff0000, v76
    s_waitcnt lgkmcnt(3)
    v_mfma_f32_4x4x4_16b_bf16 a[0:3], a[248:249], v[100:101], a[0:3]
    v_mfma_f32_4x4x4_16b_bf16 v[28:31], v[100:101], v[100:101], v[28:31]
    v_lshlrev_b32 v74, 16, v77
    v_and_b32 v75, 0xffff0000, v77
    v_lshlrev_b32 v76, 16, v78
    v_mfma_f32_4x4x4_16b_bf16 a[0:3], a[248:249], v[102:103], a[0:3]
    v_mfma_f32_4x4x4_16b_bf16 v[28:31], v[102:103], v[102:103], v[28:31]
    v_and_b32 v77, 0xffff0000, v78
    v_lshlrev_b32 v78, 16, v79
    v_and_b32 v79, 0xffff0000, v79
    s_waitcnt lgkmcnt(2)
    v_mfma_f32_4x4x4_16b_bf16 a[0:3], a[248:249], v[108:109], a[0:3]
    buffer_load_dwordx4 v27, s[4:7], s28 offen offset:3072 lds
    s_add_u32 m0, s80, 24576
    s_add_u32 s28, s28, 128
    s_cmp_eq_u32 s28, s29
    s_cselect_b32 s28, s30, s28
    v_mfma_f32_4x4x4_16b_bf16 v[28:31], v[108:109], v[108:109], v[28:31]
    v_lshlrev_b32 v80, 16, v84
    v_and_b32 v81, 0xffff0000, v84
    v_lshlrev_b32 v82, 16, v85
    v_mfma_f32_4x4x4_16b_bf16 a[0:3], a[248:249], v[110:111], a[0:3]
    v_mfma_f32_4x4x4_16b_bf16 v[28:31], v[110:111], v[110:111], v[28:31]
    v_and_b32 v83, 0xffff0000, v85
    v_lshlrev_b32 v84, 16, v86
    v_and_b32 v85, 0xffff0000, v86
    s_waitcnt lgkmcnt(1)
    v_mfma_f32_4x4x4_16b_bf16 a[0:3], a[248:249], v[116:117], a[0:3]
    v_mfma_f32_4x4x4_16b_bf16 v[28:31], v[116:117], v[116:117], v[28:31]
    v_lshlrev_b32 v86, 16, v87
    v_and_b32 v87, 0xffff0000, v87
    buffer_load_dwordx4 v24, s[4:7], s28 offen offset:0 lds
    v_lshlrev_b32 v88, 16, v92
    v_mfma_f32_4x4x4_16b_bf16 a[0:3], a[248:249], v[118:119], a[0:3]
    v_mfma_f32_4x4x4_16b_bf16 v[28:31], v[118:119], v[118:119], v[28:31]
    v_and_b32 v89, 0xffff0000, v92
    v_lshlrev_b32 v90, 16, v93
    v_and_b32 v91, 0xffff0000, v93
    s_waitcnt lgkmcnt(0)
    v_mfma_f32_4x4x4_16b_bf16 a[0:3], a[248:249], v[124:125], a[0:3]
    v_mfma_f32_4x4x4_16b_bf16 v[28:31], v[124:125], v[124:125], v[28:31]
    v_lshlrev_b32 v92, 16, v94
    v_and_b32 v93, 0xffff0000, v94
    v_mfma_f32_4x4x4_16b_bf16 a[0:3], a[248:249], v[126:127], a[0:3]
    v_mfma_f32_4x4x4_16b_bf16 v[28:31], v[126:127], v[126:127], v[28:31]
    v_lshlrev_b32 v94, 16, v95
    buffer_load_dwordx4 v25, s[4:7], s28 offen offset:1024 lds
    v_and_b32 v95, 0xffff0000, v95
    s_waitcnt vmcnt(10)
    ds_read_b128 v[132:135], v18 offset:12288
    ds_read_b128 v[140:143], v19 offset:12288
    ds_read_b128 v[148:151], v20 offset:12288
    ds_read_b128 v[156:159], v21 offset:12288
    v_lshlrev_b32 v96, 16, v100
    v_and_b32 v97, 0xffff0000, v100
    v_lshlrev_b32 v98, 16, v101
    v_and_b32 v99, 0xffff0000, v101
    v_lshlrev_b32 v100, 16, v102
    v_and_b32 v101, 0xffff0000, v102
    v_lshlrev_b32 v102, 16, v103
    v_and_b32 v103, 0xffff0000, v103
    buffer_load_dwordx4 v26, s[4:7], s28 offen offset:2048 lds
    v_lshlrev_b32 v104, 16, v108
    v_and_b32 v105, 0xffff0000, v108
    s_waitcnt lgkmcnt(3)
    v_mfma_f32_4x4x4_16b_bf16 a[0:3], a[248:249], v[132:133], a[0:3]
    v_mfma_f32_4x4x4_16b_bf16 v[28:31], v[132:133], v[132:133], v[28:31]
    v_lshlrev_b32 v106, 16, v109
    v_and_b32 v107, 0xffff0000, v109
    v_lshlrev_b32 v108, 16, v110
    v_mfma_f32_4x4x4_16b_bf16 a[0:3], a[248:249], v[134:135], a[0:3]
    v_mfma_f32_4x4x4_16b_bf16 v[28:31], v[134:135], v[134:135], v[28:31]
    v_and_b32 v109, 0xffff0000, v110
    v_lshlrev_b32 v110, 16, v111
    v_and_b32 v111, 0xffff0000, v111
    s_waitcnt lgkmcnt(2)
    buffer_load_dwordx4 v27, s[4:7], s28 offen offset:3072 lds
    s_add_u32 m0, s99, 0
    v_mfma_f32_4x4x4_16b_bf16 a[0:3], a[248:249], v[140:141], a[0:3]
    v_mfma_f32_4x4x4_16b_bf16 v[28:31], v[140:141], v[140:141], v[28:31]
    v_lshlrev_b32 v112, 16, v116
    v_and_b32 v113, 0xffff0000, v116
    v_lshlrev_b32 v114, 16, v117
    v_mfma_f32_4x4x4_16b_bf16 a[0:3], a[248:249], v[142:143], a[0:3]
    v_mfma_f32_4x4x4_16b_bf16 v[28:31], v[142:143], v[142:143], v[28:31]
    v_and_b32 v115, 0xffff0000, v117
    v_lshlrev_b32 v116, 16, v118
    v_and_b32 v117, 0xffff0000, v118
    s_waitcnt lgkmcnt(1)
    v_mfma_f32_4x4x4_16b_bf16 a[0:3], a[248:249], v[148:149], a[0:3]
    v_mfma_f32_4x4x4_16b_bf16 v[28:31], v[148:149], v[148:149], v[28:31]
    v_lshlrev_b32 v118, 16, v119
    buffer_load_dwordx4 v12, s[8:11], s73 offen offset:0 lds
    v_and_b32 v119, 0xffff0000, v119
    v_lshlrev_b32 v120, 16, v124
    v_mfma_f32_4x4x4_16b_bf16 a[0:3], a[248:249], v[150:151], a[0:3]
    v_mfma_f32_4x4x4_16b_bf16 v[28:31], v[150:151], v[150:151], v[28:31]
    v_and_b32 v121, 0xffff0000, v124
    v_lshlrev_b32 v122, 16, v125
    v_and_b32 v123, 0xffff0000, v125
    s_waitcnt lgkmcnt(0)
    v_mfma_f32_4x4x4_16b_bf16 a[0:3], a[248:249], v[156:157], a[0:3]
    v_mfma_f32_4x4x4_16b_bf16 v[28:31], v[156:157], v[156:157], v[28:31]
    v_lshlrev_b32 v124, 16, v126
    v_and_b32 v125, 0xffff0000, v126
    v_mfma_f32_4x4x4_16b_bf16 a[0:3], a[248:249], v[158:159], a[0:3]
    v_mfma_f32_4x4x4_16b_bf16 v[28:31], v[158:159], v[158:159], v[28:31]
    buffer_load_dwordx4 v13, s[8:11], s73 offen offset:1024 lds
    v_lshlrev_b32 v126, 16, v127
    v_and_b32 v127, 0xffff0000, v127
    s_waitcnt vmcnt(10)
    ds_read_b128 v[164:167], v18 offset:16384
    ds_read_b128 v[172:175], v19 offset:16384
    ds_read_b128 v[180:183], v20 offset:16384
    ds_read_b128 v[188:191], v21 offset:16384
    v_lshlrev_b32 v128, 16, v132
    v_and_b32 v129, 0xffff0000, v132
    v_lshlrev_b32 v130, 16, v133
    v_and_b32 v131, 0xffff0000, v133
    v_lshlrev_b32 v132, 16, v134
    v_and_b32 v133, 0xffff0000, v134
    v_lshlrev_b32 v134, 16, v135
    buffer_load_dwordx4 v12, s[8:11], s74 offen offset:2048 lds
    v_and_b32 v135, 0xffff0000, v135
    v_lshlrev_b32 v136, 16, v140
    v_and_b32 v137, 0xffff0000, v140
    s_waitcnt lgkmcnt(3)
    v_mfma_f32_4x4x4_16b_bf16 a[0:3], a[248:249], v[164:165], a[0:3]
    v_mfma_f32_4x4x4_16b_bf16 v[28:31], v[164:165], v[164:165], v[28:31]
    v_lshlrev_b32 v138, 16, v141
    v_and_b32 v139, 0xffff0000, v141
    v_lshlrev_b32 v140, 16, v142
    v_mfma_f32_4x4x4_16b_bf16 a[0:3], a[248:249], v[166:167], a[0:3]
    v_mfma_f32_4x4x4_16b_bf16 v[28:31], v[166:167], v[166:167], v[28:31]
    v_and_b32 v141, 0xffff0000, v142
    v_lshlrev_b32 v142, 16, v143
    v_and_b32 v143, 0xffff0000, v143
    buffer_load_dwordx4 v13, s[8:11], s74 offen offset:3072 lds
    s_add_u32 m0, s99, 16384
    s_waitcnt lgkmcnt(2)
    v_mfma_f32_4x4x4_16b_bf16 a[0:3], a[248:249], v[172:173], a[0:3]
    v_mfma_f32_4x4x4_16b_bf16 v[28:31], v[172:173], v[172:173], v[28:31]
    v_lshlrev_b32 v144, 16, v148
    v_and_b32 v145, 0xffff0000, v148
    v_lshlrev_b32 v146, 16, v149
    v_mfma_f32_4x4x4_16b_bf16 a[0:3], a[248:249], v[174:175], a[0:3]
    v_mfma_f32_4x4x4_16b_bf16 v[28:31], v[174:175], v[174:175], v[28:31]
    v_and_b32 v147, 0xffff0000, v149
    v_lshlrev_b32 v148, 16, v150
    v_and_b32 v149, 0xffff0000, v150
    s_waitcnt lgkmcnt(1)
    v_mfma_f32_4x4x4_16b_bf16 a[0:3], a[248:249], v[180:181], a[0:3]
    v_mfma_f32_4x4x4_16b_bf16 v[28:31], v[180:181], v[180:181], v[28:31]
    buffer_load_dwordx4 v12, s[8:11], s75 offen offset:0 lds
    v_lshlrev_b32 v150, 16, v151
    v_and_b32 v151, 0xffff0000, v151
    v_lshlrev_b32 v152, 16, v156
    v_mfma_f32_4x4x4_16b_bf16 a[0:3], a[248:249], v[182:183], a[0:3]
    v_mfma_f32_4x4x4_16b_bf16 v[28:31], v[182:183], v[182:183], v[28:31]
    v_and_b32 v153, 0xffff0000, v156
    v_lshlrev_b32 v154, 16, v157
    v_and_b32 v155, 0xffff0000, v157
    s_waitcnt lgkmcnt(0)
    v_mfma_f32_4x4x4_16b_bf16 a[0:3], a[248:249], v[188:189], a[0:3]
    v_mfma_f32_4x4x4_16b_bf16 v[28:31], v[188:189], v[188:189], v[28:31]
    v_lshlrev_b32 v156, 16, v158
    v_and_b32 v157, 0xffff0000, v158
    v_mfma_f32_4x4x4_16b_bf16 a[0:3], a[248:249], v[190:191], a[0:3]
    buffer_load_dwordx4 v13, s[8:11], s75 offen offset:1024 lds
    v_mfma_f32_4x4x4_16b_bf16 v[28:31], v[190:191], v[190:191], v[28:31]
    v_lshlrev_b32 v158, 16, v159
    v_and_b32 v159, 0xffff0000, v159
    s_waitcnt vmcnt(10)
    ds_read_b128 v[196:199], v18 offset:20480
    ds_read_b128 v[204:207], v19 offset:20480
    ds_read_b128 v[212:215], v20 offset:20480
    ds_read_b128 v[220:223], v21 offset:20480
    v_lshlrev_b32 v160, 16, v164
    v_and_b32 v161, 0xffff0000, v164
    v_lshlrev_b32 v162, 16, v165
    v_and_b32 v163, 0xffff0000, v165
    v_lshlrev_b32 v164, 16, v166
    v_and_b32 v165, 0xffff0000, v166
    buffer_load_dwordx4 v12, s[8:11], s76 offen offset:2048 lds
    v_lshlrev_b32 v166, 16, v167
    v_and_b32 v167, 0xffff0000, v167
    v_lshlrev_b32 v168, 16, v172
    v_and_b32 v169, 0xffff0000, v172
    s_waitcnt lgkmcnt(3)
    v_mfma_f32_4x4x4_16b_bf16 a[0:3], a[248:249], v[196:197], a[0:3]
    v_mfma_f32_4x4x4_16b_bf16 v[28:31], v[196:197], v[196:197], v[28:31]
    v_lshlrev_b32 v170, 16, v173
    v_and_b32 v171, 0xffff0000, v173
    v_lshlrev_b32 v172, 16, v174
    v_mfma_f32_4x4x4_16b_bf16 a[0:3], a[248:249], v[198:199], a[0:3]
    v_mfma_f32_4x4x4_16b_bf16 v[28:31], v[198:199], v[198:199], v[28:31]
    v_and_b32 v173, 0xffff0000, v174
    v_lshlrev_b32 v174, 16, v175
    buffer_load_dwordx4 v13, s[8:11], s76 offen offset:3072 lds
    s_add_u32 m0, s99, 32768
    v_and_b32 v175, 0xffff0000, v175
    s_waitcnt lgkmcnt(2)
    v_mfma_f32_4x4x4_16b_bf16 a[0:3], a[248:249], v[204:205], a[0:3]
    v_mfma_f32_4x4x4_16b_bf16 v[28:31], v[204:205], v[204:205], v[28:31]
    v_lshlrev_b32 v176, 16, v180
    v_and_b32 v177, 0xffff0000, v180
    v_lshlrev_b32 v178, 16, v181
    v_mfma_f32_4x4x4_16b_bf16 a[0:3], a[248:249], v[206:207], a[0:3]
    v_mfma_f32_4x4x4_16b_bf16 v[28:31], v[206:207], v[206:207], v[28:31]
    v_and_b32 v179, 0xffff0000, v181
    v_lshlrev_b32 v180, 16, v182
    v_and_b32 v181, 0xffff0000, v182
    s_waitcnt lgkmcnt(1)
    v_mfma_f32_4x4x4_16b_bf16 a[0:3], a[248:249], v[212:213], a[0:3]
    buffer_load_dwordx4 v12, s[8:11], s77 offen offset:0 lds
    v_mfma_f32_4x4x4_16b_bf16 v[28:31], v[212:213], v[212:213], v[28:31]
    v_lshlrev_b32 v182, 16, v183
    v_and_b32 v183, 0xffff0000, v183
    v_lshlrev_b32 v184, 16, v188
    v_mfma_f32_4x4x4_16b_bf16 a[0:3], a[248:249], v[214:215], a[0:3]
    v_mfma_f32_4x4x4_16b_bf16 v[28:31], v[214:215], v[214:215], v[28:31]
    v_and_b32 v185, 0xffff0000, v188
    v_lshlrev_b32 v186, 16, v189
    v_and_b32 v187, 0xffff0000, v189
    s_waitcnt lgkmcnt(0)
    v_mfma_f32_4x4x4_16b_bf16 a[0:3], a[248:249], v[220:221], a[0:3]
    v_mfma_f32_4x4x4_16b_bf16 v[28:31], v[220:221], v[220:221], v[28:31]
    v_lshlrev_b32 v188, 16, v190
    v_and_b32 v189, 0xffff0000, v190
    buffer_load_dwordx4 v13, s[8:11], s77 offen offset:1024 lds
    v_mfma_f32_4x4x4_16b_bf16 a[0:3], a[248:249], v[222:223], a[0:3]
    v_mfma_f32_4x4x4_16b_bf16 v[28:31], v[222:223], v[222:223], v[28:31]
    v_lshlrev_b32 v190, 16, v191
    v_and_b32 v191, 0xffff0000, v191
    s_waitcnt vmcnt(10)
    s_branch L_overG1
    .p2align 12
L_padG1:
    s_branch L_retGa
L_overG1:
    ds_read_b128 v[228:231], v18 offset:24576
    ds_read_b128 v[236:239], v19 offset:24576
    ds_read_b128 v[244:247], v20 offset:24576
    ds_read_b128 v[252:255], v21 offset:24576
    v_lshlrev_b32 v192, 16, v196
    v_and_b32 v193, 0xffff0000, v196
    v_lshlrev_b32 v194, 16, v197
    v_and_b32 v195, 0xffff0000, v197
    v_lshlrev_b32 v196, 16, v198
    buffer_load_dwordx4 v12, s[8:11], s78 offen offset:2048 lds
    v_and_b32 v197, 0xffff0000, v198
    v_lshlrev_b32 v198, 16, v199
    v_and_b32 v199, 0xffff0000, v199
    v_lshlrev_b32 v200, 16, v204
    v_and_b32 v201, 0xffff0000, v204
    s_waitcnt lgkmcnt(3)
    v_mfma_f32_4x4x4_16b_bf16 a[0:3], a[248:249], v[228:229], a[0:3]
    v_mfma_f32_4x4x4_16b_bf16 v[28:31], v[228:229], v[228:229], v[28:31]
    v_lshlrev_b32 v202, 16, v205
    v_and_b32 v203, 0xffff0000, v205
    v_lshlrev_b32 v204, 16, v206
    v_mfma_f32_4x4x4_16b_bf16 a[0:3], a[248:249], v[230:231], a[0:3]
    v_mfma_f32_4x4x4_16b_bf16 v[28:31], v[230:231], v[230:231], v[28:31]
    v_and_b32 v205, 0xffff0000, v206
    buffer_load_dwordx4 v13, s[8:11], s78 offen offset:3072 lds
    s_add_u32 m0, s80, 0
    v_lshlrev_b32 v206, 16, v207
    v_and_b32 v207, 0xffff0000, v207
    s_waitcnt lgkmcnt(2)
    v_mfma_f32_4x4x4_16b_bf16 a[0:3], a[248:249], v[236:237], a[0:3]
    v_mfma_f32_4x4x4_16b_bf16 v[28:31], v[236:237], v[236:237], v[28:31]
    v_lshlrev_b32 v208, 16, v212
    v_and_b32 v209, 0xffff0000, v212
    v_lshlrev_b32 v210, 16, v213
    v_mfma_f32_4x4x4_16b_bf16 a[0:3], a[248:249], v[238:239], a[0:3]
    v_mfma_f32_4x4x4_16b_bf16 v[28:31], v[238:239], v[238:239], v[28:31]
    v_and_b32 v211, 0xffff0000, v213
    v_lshlrev_b32 v212, 16, v214
    v_and_b32 v213, 0xffff0000, v214
    s_waitcnt lgkmcnt(1)
    buffer_load_dwordx4 v8, s[12:15], s66 offen offset:0 lds
    v_mfma_f32_4x4x4_16b_bf16 a[0:3], a[248:249], v[244:245], a[0:3]
    v_mfma_f32_4x4x4_16b_bf16 v[28:31], v[244:245], v[244:245], v[28:31]
    v_lshlrev_b32 v214, 16, v215
    v_and_b32 v215, 0xffff0000, v215
    v_lshlrev_b32 v216, 16, v220
    v_mfma_f32_4x4x4_16b_bf16 a[0:3], a[248:249], v[246:247], a[0:3]
    v_mfma_f32_4x4x4_16b_bf16 v[28:31], v[246:247], v[246:247], v[28:31]
    v_and_b32 v217, 0xffff0000, v220
    v_lshlrev_b32 v218, 16, v221
    v_and_b32 v219, 0xffff0000, v221
    s_waitcnt lgkmcnt(0)
    v_mfma_f32_4x4x4_16b_bf16 a[0:3], a[248:249], v[252:253], a[0:3]
    v_mfma_f32_4x4x4_16b_bf16 v[28:31], v[252:253], v[252:253], v[28:31]
    v_lshlrev_b32 v220, 16, v222
    buffer_load_dwordx4 v9, s[12:15], s66 offen offset:1024 lds
    v_and_b32 v221, 0xffff0000, v222
    v_mfma_f32_4x4x4_16b_bf16 a[0:3], a[248:249], v[254:255], a[0:3]
    v_mfma_f32_4x4x4_16b_bf16 v[28:31], v[254:255], v[254:255], v[28:31]
    v_lshlrev_b32 v222, 16, v223
    v_and_b32 v223, 0xffff0000, v223
    s_waitcnt vmcnt(10)
    s_barrier
    ds_read_b64_tr_b16 a[64:65], v6 offset:0
    ds_read_b64_tr_b16 a[66:67], v6 offset:512
    ds_read_b64_tr_b16 a[68:69], v7 offset:0
    ds_read_b64_tr_b16 a[70:71], v7 offset:512
    ds_read_b64_tr_b16 a[72:73], v6 offset:4096
    ds_read_b64_tr_b16 a[74:75], v6 offset:4608
    ds_read_b64_tr_b16 a[76:77], v7 offset:4096
    buffer_load_dwordx4 v10, s[16:19], s66 offen offset:2048 lds
    ds_read_b64_tr_b16 a[78:79], v7 offset:4608
    ds_read_b64_tr_b16 a[80:81], v6 offset:8192
    ds_read_b64_tr_b16 a[82:83], v6 offset:8704
    ds_read_b64_tr_b16 a[84:85], v7 offset:8192
    ds_read_b64_tr_b16 a[86:87], v7 offset:8704
    ds_read_b64_tr_b16 a[88:89], v6 offset:12288
    ds_read_b64_tr_b16 a[90:91], v6 offset:12800
    ds_read_b64_tr_b16 a[92:93], v7 offset:12288
    ds_read_b64_tr_b16 a[94:95], v7 offset:12800
    s_mov_b32 vcc_lo, 0xaaaaaaaa
    s_mov_b32 vcc_hi, 0xaaaaaaaa
    s_mov_b32 s2, 0xcccccccc
    s_mov_b32 s3, 0xcccccccc
    v_cndmask_b32 v28, v28, v29, vcc
    buffer_load_dwordx4 v11, s[16:19], s66 offen offset:3072 lds
    s_add_u32 s66, s66, 128
    v_cndmask_b32 v30, v30, v31, vcc
    v_accvgpr_read_b32 v24, a0
    v_accvgpr_read_b32 v25, a0
    v_cndmask_b32 v28, v28, v30, s[2:3]
    v_lshlrev_b32 v224, 16, v228
    v_mov_b32 v29, v28
    v_permlane32_swap_b32 v24, v25
    v_and_b32 v225, 0xffff0000, v228
    v_permlane32_swap_b32 v28, v29
    v_add_f32 v24, v24, v25
    v_add_f32 v28, v28, v29
    v_mul_f32 v24, 0xbb124925, v24
    v_mul_f32 v28, 0x3b124925, v28
    v_fma_f32 v28, -v24, v24, v28
    v_max_f32 v28, 0, v28
    v_add_f32 v28, 0x3727c5ac, v28
    v_rsq_f32 v28, v28
    v_lshlrev_b32 v226, 16, v229
    v_mul_f32 v18, 0x3fb8aa3b, v28
    v_mul_f32 v19, v24, v18
    v_fma_f32 v32, v32, v18, v19
    v_fma_f32 v33, v33, v18, v19
    v_fma_f32 v34, v34, v18, v19
    v_fma_f32 v35, v35, v18, v19
    v_fma_f32 v36, v36, v18, v19
    v_fma_f32 v37, v37, v18, v19
    v_fma_f32 v38, v38, v18, v19
    v_fma_f32 v39, v39, v18, v19
    v_cvt_pk_bf16_f32 v32, v32, v33
    v_cvt_pk_bf16_f32 v33, v34, v35
    v_cvt_pk_bf16_f32 v34, v36, v37
    v_cvt_pk_bf16_f32 v35, v38, v39
    v_fma_f32 v40, v40, v18, v19
    v_fma_f32 v41, v41, v18, v19
    v_fma_f32 v42, v42, v18, v19
    v_fma_f32 v43, v43, v18, v19
    v_fma_f32 v44, v44, v18, v19
    v_fma_f32 v45, v45, v18, v19
    v_fma_f32 v46, v46, v18, v19
    v_fma_f32 v47, v47, v18, v19
    v_cvt_pk_bf16_f32 v36, v40, v41
    v_cvt_pk_bf16_f32 v37, v42, v43
    v_cvt_pk_bf16_f32 v38, v44, v45
    v_cvt_pk_bf16_f32 v39, v46, v47
    s_waitcnt lgkmcnt(8)
    v_mfma_f32_32x32x16_bf16 a[0:15], a[64:67], v[32:35], 0
    ds_read_b64_tr_b16 a[96:97], v6 offset:2048
    ds_read_b64_tr_b16 a[98:99], v6 offset:2560
    s_add_u32 m0, s80, 4096
    s_nop 0
    buffer_load_dwordx4 v8, s[12:15], s67 offen offset:0 lds
    v_fma_f32 v48, v48, v18, v19
    v_fma_f32 v49, v49, v18, v19
    v_fma_f32 v50, v50, v18, v19
    v_fma_f32 v51, v51, v18, v19
    v_fma_f32 v52, v52, v18, v19
    v_mfma_f32_32x32x16_bf16 a[16:31], a[68:71], v[32:35], 0
    ds_read_b64_tr_b16 a[100:101], v7 offset:2048
    ds_read_b64_tr_b16 a[102:103], v7 offset:2560
    v_fma_f32 v53, v53, v18, v19
    v_fma_f32 v54, v54, v18, v19
    v_fma_f32 v55, v55, v18, v19
    v_cvt_pk_bf16_f32 v40, v48, v49
    v_cvt_pk_bf16_f32 v41, v50, v51
    v_cvt_pk_bf16_f32 v42, v52, v53
    v_cvt_pk_bf16_f32 v43, v54, v55
    v_fma_f32 v56, v56, v18, v19
    v_mfma_f32_32x32x16_bf16 a[0:15], a[72:75], v[36:39], a[0:15]
    ds_read_b64_tr_b16 a[104:105], v6 offset:6144
    ds_read_b64_tr_b16 a[106:107], v6 offset:6656
    buffer_load_dwordx4 v9, s[12:15], s67 offen offset:1024 lds
    v_fma_f32 v57, v57, v18, v19
    v_fma_f32 v58, v58, v18, v19
    v_fma_f32 v59, v59, v18, v19
    v_fma_f32 v60, v60, v18, v19
    v_fma_f32 v61, v61, v18, v19
    v_fma_f32 v62, v62, v18, v19
    v_mfma_f32_32x32x16_bf16 a[16:31], a[76:79], v[36:39], a[16:31]
    ds_read_b64_tr_b16 a[108:109], v7 offset:6144
    ds_read_b64_tr_b16 a[110:111], v7 offset:6656
    v_fma_f32 v63, v63, v18, v19
    v_cvt_pk_bf16_f32 v44, v56, v57
    v_cvt_pk_bf16_f32 v45, v58, v59
    v_cvt_pk_bf16_f32 v46, v60, v61
    v_cvt_pk_bf16_f32 v47, v62, v63
    v_fma_f32 v64, v64, v18, v19
    v_fma_f32 v65, v65, v18, v19
    s_waitcnt lgkmcnt(8)
    v_mfma_f32_32x32x16_bf16 a[0:15], a[80:83], v[40:43], a[0:15]
    ds_read_b64_tr_b16 a[64:65], v6 offset:10240
    ds_read_b64_tr_b16 a[66:67], v6 offset:10752
    buffer_load_dwordx4 v10, s[16:19], s67 offen offset:2048 lds
    v_fma_f32 v66, v66, v18, v19
    v_fma_f32 v67, v67, v18, v19
    v_fma_f32 v68, v68, v18, v19
    v_fma_f32 v69, v69, v18, v19
    v_fma_f32 v70, v70, v18, v19
    v_fma_f32 v71, v71, v18, v19
    v_mfma_f32_32x32x16_bf16 a[16:31], a[84:87], v[40:43], a[16:31]
    ds_read_b64_tr_b16 a[68:69], v7 offset:10240
    ds_read_b64_tr_b16 a[70:71], v7 offset:10752
    buffer_load_dwordx4 v11, s[16:19], s67 offen offset:3072 lds
    s_add_u32 m0, s99, 0
    s_add_u32 s67, s67, 128
    v_cvt_pk_bf16_f32 v48, v64, v65
    v_cvt_pk_bf16_f32 v49, v66, v67
    v_cvt_pk_bf16_f32 v50, v68, v69
    v_cvt_pk_bf16_f32 v51, v70, v71
    v_mfma_f32_32x32x16_bf16 a[0:15], a[88:91], v[44:47], a[0:15]
    ds_read_b64_tr_b16 a[72:73], v6 offset:14336
    ds_read_b64_tr_b16 a[74:75], v6 offset:14848
    v_fma_f32 v72, v72, v18, v19
    v_fma_f32 v73, v73, v18, v19
    v_fma_f32 v74, v74, v18, v19
    v_fma_f32 v75, v75, v18, v19
    v_fma_f32 v76, v76, v18, v19
    v_fma_f32 v77, v77, v18, v19
    v_fma_f32 v78, v78, v18, v19
    v_fma_f32 v79, v79, v18, v19
    v_mfma_f32_32x32x16_bf16 a[16:31], a[92:95], v[44:47], a[16:31]
    ds_read_b64_tr_b16 a[76:77], v7 offset:14336
    ds_read_b64_tr_b16 a[78:79], v7 offset:14848
    v_cvt_pk_bf16_f32 v52, v72, v73
    v_cvt_pk_bf16_f32 v53, v74, v75
    v_cvt_pk_bf16_f32 v54, v76, v77
    v_cvt_pk_bf16_f32 v55, v78, v79
    v_fma_f32 v80, v80, v18, v19
    v_fma_f32 v81, v81, v18, v19
    v_fma_f32 v82, v82, v18, v19
    s_waitcnt lgkmcnt(8)
    v_mfma_f32_32x32x16_bf16 a[0:15], a[96:99], v[48:51], a[0:15]
    v_fma_f32 v83, v83, v18, v19
    v_fma_f32 v84, v84, v18, v19
    v_fma_f32 v85, v85, v18, v19
    v_fma_f32 v86, v86, v18, v19
    v_fma_f32 v87, v87, v18, v19
    v_cvt_pk_bf16_f32 v56, v80, v81
    v_cvt_pk_bf16_f32 v57, v82, v83
    v_cvt_pk_bf16_f32 v58, v84, v85
    v_cvt_pk_bf16_f32 v59, v86, v87
    v_fma_f32 v88, v88, v18, v19
    v_mfma_f32_32x32x16_bf16 a[16:31], a[100:103], v[48:51], a[16:31]
    s_waitcnt vmcnt(12) lgkmcnt(0)
    s_barrier
    buffer_load_dword a32, v22, s[20:23], 0 offen
    ds_read_b64_tr_b16 a[80:81], v6 offset:16384
    ds_read_b64_tr_b16 a[82:83], v6 offset:16896
    buffer_load_dwordx4 v12, s[8:11], s79 offen offset:0 lds
    v_fma_f32 v89, v89, v18, v19
    v_mfma_f32_32x32x16_bf16 a[0:15], a[104:107], v[52:55], a[0:15]
    ds_read_b64_tr_b16 a[84:85], v7 offset:16384
    ds_read_b64_tr_b16 a[86:87], v7 offset:16896
    ds_read_b64_tr_b16 a[88:89], v6 offset:20480
    v_fma_f32 v90, v90, v18, v19
    v_fma_f32 v91, v91, v18, v19
    v_fma_f32 v92, v92, v18, v19
    v_fma_f32 v93, v93, v18, v19
    v_fma_f32 v94, v94, v18, v19
    v_fma_f32 v95, v95, v18, v19
    v_cvt_pk_bf16_f32 v60, v88, v89
    v_mfma_f32_32x32x16_bf16 a[16:31], a[108:111], v[52:55], a[16:31]
    ds_read_b64_tr_b16 a[90:91], v6 offset:20992
    ds_read_b64_tr_b16 a[92:93], v7 offset:20480
    ds_read_b64_tr_b16 a[94:95], v7 offset:20992
    buffer_load_dwordx4 v13, s[8:11], s79 offen offset:1024 lds
    s_add_u32 m0, s80, 8192
    v_cvt_pk_bf16_f32 v61, v90, v91
    v_cvt_pk_bf16_f32 v62, v92, v93
    v_cvt_pk_bf16_f32 v63, v94, v95
    v_mfma_f32_32x32x16_bf16 a[0:15], a[64:67], v[56:59], a[0:15]
    ds_read_b64_tr_b16 a[96:97], v6 offset:24576
    ds_read_b64_tr_b16 a[98:99], v6 offset:25088
    v_fma_f32 v96, v96, v18, v19
    v_fma_f32 v97, v97, v18, v19
    v_fma_f32 v98, v98, v18, v19
    v_fma_f32 v99, v99, v18, v19
    v_fma_f32 v100, v100, v18, v19
    v_fma_f32 v101, v101, v18, v19
    v_fma_f32 v102, v102, v18, v19
    v_fma_f32 v103, v103, v18, v19
    v_mfma_f32_32x32x16_bf16 a[16:31], a[68:71], v[56:59], a[16:31]
    ds_read_b64_tr_b16 a[100:101], v7 offset:24576
    ds_read_b64_tr_b16 a[102:103], v7 offset:25088
    buffer_load_dwordx4 v8, s[12:15], s68 offen offset:0 lds
    v_cvt_pk_bf16_f32 v64, v96, v97
    v_cvt_pk_bf16_f32 v65, v98, v99
    v_cvt_pk_bf16_f32 v66, v100, v101
    v_cvt_pk_bf16_f32 v67, v102, v103
    v_fma_f32 v104, v104, v18, v19
    v_fma_f32 v105, v105, v18, v19
    v_mfma_f32_32x32x16_bf16 a[0:15], a[72:75], v[60:63], a[0:15]
    ds_read_b64_tr_b16 a[104:105], v6 offset:28672
    ds_read_b64_tr_b16 a[106:107], v6 offset:29184
    buffer_load_dwordx4 v9, s[12:15], s68 offen offset:1024 lds
    v_fma_f32 v106, v106, v18, v19
    v_fma_f32 v107, v107, v18, v19
    v_fma_f32 v108, v108, v18, v19
    v_fma_f32 v109, v109, v18, v19
    v_fma_f32 v110, v110, v18, v19
    v_fma_f32 v111, v111, v18, v19
    v_mfma_f32_32x32x16_bf16 a[16:31], a[76:79], v[60:63], a[16:31]
    ds_read_b64_tr_b16 a[108:109], v7 offset:28672
    ds_read_b64_tr_b16 a[110:111], v7 offset:29184
    v_cvt_pk_bf16_f32 v68, v104, v105
    v_cvt_pk_bf16_f32 v69, v106, v107
    v_cvt_pk_bf16_f32 v70, v108, v109
    v_cvt_pk_bf16_f32 v71, v110, v111
    v_fma_f32 v112, v112, v18, v19
    v_fma_f32 v113, v113, v18, v19
    v_fma_f32 v114, v114, v18, v19
    s_waitcnt lgkmcnt(8)
    v_mfma_f32_32x32x16_bf16 a[0:15], a[80:83], v[64:67], a[0:15]
    ds_read_b64_tr_b16 a[64:65], v6 offset:18432
    ds_read_b64_tr_b16 a[66:67], v6 offset:18944
    buffer_load_dwordx4 v10, s[16:19], s68 offen offset:2048 lds
    v_fma_f32 v115, v115, v18, v19
    v_fma_f32 v116, v116, v18, v19
    v_fma_f32 v117, v117, v18, v19
    v_fma_f32 v118, v118, v18, v19
    v_fma_f32 v119, v119, v18, v19
    v_cvt_pk_bf16_f32 v72, v112, v113
    v_mfma_f32_32x32x16_bf16 a[16:31], a[84:87], v[64:67], a[16:31]
    ds_read_b64_tr_b16 a[68:69], v7 offset:18432
    ds_read_b64_tr_b16 a[70:71], v7 offset:18944
    buffer_load_dwordx4 v11, s[16:19], s68 offen offset:3072 lds
    s_add_u32 m0, s80, 12288
    s_add_u32 s68, s68, 128
    v_cvt_pk_bf16_f32 v73, v114, v115
    v_cvt_pk_bf16_f32 v74, v116, v117
    v_cvt_pk_bf16_f32 v75, v118, v119
    v_fma_f32 v120, v120, v18, v19
    v_mfma_f32_32x32x16_bf16 a[0:15], a[88:91], v[68:71], a[0:15]
    ds_read_b64_tr_b16 a[72:73], v6 offset:22528
    ds_read_b64_tr_b16 a[74:75], v6 offset:23040
    v_fma_f32 v121, v121, v18, v19
    v_fma_f32 v122, v122, v18, v19
    v_fma_f32 v123, v123, v18, v19
    v_fma_f32 v124, v124, v18, v19
    v_fma_f32 v125, v125, v18, v19
    v_fma_f32 v126, v126, v18, v19
    v_fma_f32 v127, v127, v18, v19
    v_cvt_pk_bf16_f32 v76, v120, v121
    v_mfma_f32_32x32x16_bf16 a[16:31], a[92:95], v[68:71], a[16:31]
    ds_read_b64_tr_b16 a[76:77], v7 offset:22528
    ds_read_b64_tr_b16 a[78:79], v7 offset:23040
    buffer_load_dwordx4 v8, s[12:15], s69 offen offset:0 lds
    v_cvt_pk_bf16_f32 v77, v122, v123
    v_cvt_pk_bf16_f32 v78, v124, v125
    v_cvt_pk_bf16_f32 v79, v126, v127
    v_fma_f32 v128, v128, v18, v19
    v_fma_f32 v129, v129, v18, v19
    s_waitcnt lgkmcnt(8)
    v_mfma_f32_32x32x16_bf16 a[0:15], a[96:99], v[72:75], a[0:15]
    ds_read_b64_tr_b16 a[80:81], v6 offset:26624
    ds_read_b64_tr_b16 a[82:83], v6 offset:27136
    v_fma_f32 v130, v130, v18, v19
    v_fma_f32 v131, v131, v18, v19
    v_fma_f32 v132, v132, v18, v19
    v_fma_f32 v133, v133, v18, v19
    v_fma_f32 v134, v134, v18, v19
    v_fma_f32 v135, v135, v18, v19
    v_cvt_pk_bf16_f32 v80, v128, v129
    v_cvt_pk_bf16_f32 v81, v130, v131
    v_mfma_f32_32x32x16_bf16 a[16:31], a[100:103], v[72:75], a[16:31]
    ds_read_b64_tr_b16 a[84:85], v7 offset:26624
    ds_read_b64_tr_b16 a[86:87], v7 offset:27136
    buffer_load_dwordx4 v9, s[12:15], s69 offen offset:1024 lds
    v_cvt_pk_bf16_f32 v82, v132, v133
    v_cvt_pk_bf16_f32 v83, v134, v135
    v_fma_f32 v136, v136, v18, v19
    v_fma_f32 v137, v137, v18, v19
    v_fma_f32 v138, v138, v18, v19
    v_fma_f32 v139, v139, v18, v19
    v_mfma_f32_32x32x16_bf16 a[0:15], a[104:107], v[76:79], a[0:15]
    ds_read_b64_tr_b16 a[88:89], v6 offset:30720
    ds_read_b64_tr_b16 a[90:91], v6 offset:31232
    buffer_load_dwordx4 v10, s[16:19], s69 offen offset:2048 lds
    v_fma_f32 v140, v140, v18, v19
    v_fma_f32 v141, v141, v18, v19
    v_fma_f32 v142, v142, v18, v19
    v_fma_f32 v143, v143, v18, v19
    v_cvt_pk_bf16_f32 v84, v136, v137
    v_cvt_pk_bf16_f32 v85, v138, v139
    v_mfma_f32_32x32x16_bf16 a[16:31], a[108:111], v[76:79], a[16:31]
    ds_read_b64_tr_b16 a[92:93], v7 offset:30720
    ds_read_b64_tr_b16 a[94:95], v7 offset:31232
    v_cvt_pk_bf16_f32 v86, v140, v141
    v_cvt_pk_bf16_f32 v87, v142, v143
    v_fma_f32 v144, v144, v18, v19
    v_fma_f32 v145, v145, v18, v19
    v_fma_f32 v146, v146, v18, v19
    v_fma_f32 v147, v147, v18, v19
    v_fma_f32 v148, v148, v18, v19
    s_waitcnt lgkmcnt(8)
    v_mfma_f32_32x32x16_bf16 a[0:15], a[64:67], v[80:83], a[0:15]
    buffer_load_dwordx4 v11, s[16:19], s69 offen offset:3072 lds
    s_add_u32 m0, s99, 2048
    s_add_u32 s69, s69, 128
    v_fma_f32 v149, v149, v18, v19
    v_fma_f32 v150, v150, v18, v19
    v_fma_f32 v151, v151, v18, v19
    v_cvt_pk_bf16_f32 v88, v144, v145
    v_cvt_pk_bf16_f32 v89, v146, v147
    v_cvt_pk_bf16_f32 v90, v148, v149
    v_mfma_f32_32x32x16_bf16 a[16:31], a[68:71], v[80:83], a[16:31]
    s_waitcnt vmcnt(19) lgkmcnt(0)
    s_barrier
    ds_read_b64_tr_b16 a[96:97], v6 offset:32768
    ds_read_b64_tr_b16 a[98:99], v6 offset:33280
    s_add_u32 s84, s84, 917504
    buffer_load_dwordx4 v16, s[20:23], s84 offen lds
    v_cvt_pk_bf16_f32 v91, v150, v151
    v_fma_f32 v152, v152, v18, v19
    v_mfma_f32_32x32x16_bf16 a[0:15], a[72:75], v[84:87], a[0:15]
    ds_read_b64_tr_b16 a[100:101], v7 offset:32768
    ds_read_b64_tr_b16 a[102:103], v7 offset:33280
    ds_read_b64_tr_b16 a[104:105], v6 offset:36864
    v_fma_f32 v153, v153, v18, v19
    v_fma_f32 v154, v154, v18, v19
    v_fma_f32 v155, v155, v18, v19
    v_fma_f32 v156, v156, v18, v19
    v_fma_f32 v157, v157, v18, v19
    v_fma_f32 v158, v158, v18, v19
    v_fma_f32 v159, v159, v18, v19
    v_mfma_f32_32x32x16_bf16 a[16:31], a[76:79], v[84:87], a[16:31]
    ds_read_b64_tr_b16 a[106:107], v6 offset:37376
    ds_read_b64_tr_b16 a[108:109], v7 offset:36864
    ds_read_b64_tr_b16 a[110:111], v7 offset:37376
    buffer_load_dwordx4 v17, s[20:23], s84 offen offset:1024 lds
    s_add_u32 m0, s99, 16384
    s_add_u32 s84, s84, 114688
    v_cvt_pk_bf16_f32 v92, v152, v153
    v_cvt_pk_bf16_f32 v93, v154, v155
    v_cvt_pk_bf16_f32 v94, v156, v157
    v_mfma_f32_32x32x16_bf16 a[0:15], a[80:83], v[88:91], a[0:15]
    ds_read_b64_tr_b16 a[64:65], v6 offset:40960
    ds_read_b64_tr_b16 a[66:67], v6 offset:41472
    v_cvt_pk_bf16_f32 v95, v158, v159
    v_fma_f32 v160, v160, v18, v19
    v_fma_f32 v161, v161, v18, v19
    v_fma_f32 v162, v162, v18, v19
    v_fma_f32 v163, v163, v18, v19
    v_fma_f32 v164, v164, v18, v19
    v_fma_f32 v165, v165, v18, v19
    v_fma_f32 v166, v166, v18, v19
    v_fma_f32 v167, v167, v18, v19
    v_mfma_f32_32x32x16_bf16 a[16:31], a[84:87], v[88:91], a[16:31]
    ds_read_b64_tr_b16 a[68:69], v7 offset:40960
    ds_read_b64_tr_b16 a[70:71], v7 offset:41472
    buffer_load_dwordx4 v16, s[20:23], s84 offen lds
    v_cvt_pk_bf16_f32 v96, v160, v161
    v_cvt_pk_bf16_f32 v97, v162, v163
    v_cvt_pk_bf16_f32 v98, v164, v165
    v_cvt_pk_bf16_f32 v99, v166, v167
    v_fma_f32 v168, v168, v18, v19
    v_fma_f32 v169, v169, v18, v19
    v_fma_f32 v170, v170, v18, v19
    v_mfma_f32_32x32x16_bf16 a[0:15], a[88:91], v[92:95], a[0:15]
    ds_read_b64_tr_b16 a[72:73], v6 offset:45056
    ds_read_b64_tr_b16 a[74:75], v6 offset:45568
    buffer_load_dwordx4 v17, s[20:23], s84 offen offset:1024 lds
    s_add_u32 m0, s99, 18432
    s_add_u32 s84, s84, 114688
    v_fma_f32 v171, v171, v18, v19
    v_fma_f32 v172, v172, v18, v19
    v_fma_f32 v173, v173, v18, v19
    v_fma_f32 v174, v174, v18, v19
    v_fma_f32 v175, v175, v18, v19
    v_mfma_f32_32x32x16_bf16 a[16:31], a[92:95], v[92:95], a[16:31]
    ds_read_b64_tr_b16 a[76:77], v7 offset:45056
    ds_read_b64_tr_b16 a[78:79], v7 offset:45568
    v_cvt_pk_bf16_f32 v100, v168, v169
    v_cvt_pk_bf16_f32 v101, v170, v171
    v_cvt_pk_bf16_f32 v102, v172, v173
    v_cvt_pk_bf16_f32 v103, v174, v175
    v_fma_f32 v176, v176, v18, v19
    v_fma_f32 v177, v177, v18, v19
    v_fma_f32 v178, v178, v18, v19
    v_fma_f32 v179, v179, v18, v19
    s_waitcnt lgkmcnt(8)
    v_mfma_f32_32x32x16_bf16 a[0:15], a[96:99], v[96:99], a[0:15]
    ds_read_b64_tr_b16 a[80:81], v6 offset:34816
    ds_read_b64_tr_b16 a[82:83], v6 offset:35328
    buffer_load_dwordx4 v16, s[20:23], s84 offen lds
    v_fma_f32 v180, v180, v18, v19
    v_fma_f32 v181, v181, v18, v19
    v_fma_f32 v182, v182, v18, v19
    v_fma_f32 v183, v183, v18, v19
    v_cvt_pk_bf16_f32 v104, v176, v177
    v_cvt_pk_bf16_f32 v105, v178, v179
    v_cvt_pk_bf16_f32 v106, v180, v181
    v_mfma_f32_32x32x16_bf16 a[16:31], a[100:103], v[96:99], a[16:31]
    ds_read_b64_tr_b16 a[84:85], v7 offset:34816
    ds_read_b64_tr_b16 a[86:87], v7 offset:35328
    buffer_load_dwordx4 v17, s[20:23], s84 offen offset:1024 lds
    s_add_u32 m0, s80, 16384
    v_cvt_pk_bf16_f32 v107, v182, v183
    v_fma_f32 v184, v184, v18, v19
    v_fma_f32 v185, v185, v18, v19
    v_fma_f32 v186, v186, v18, v19
    v_fma_f32 v187, v187, v18, v19
    v_fma_f32 v188, v188, v18, v19
    v_mfma_f32_32x32x16_bf16 a[0:15], a[104:107], v[100:103], a[0:15]
    ds_read_b64_tr_b16 a[88:89], v6 offset:38912
    ds_read_b64_tr_b16 a[90:91], v6 offset:39424
    v_fma_f32 v189, v189, v18, v19
    v_fma_f32 v190, v190, v18, v19
    v_fma_f32 v191, v191, v18, v19
    v_cvt_pk_bf16_f32 v108, v184, v185
    v_cvt_pk_bf16_f32 v109, v186, v187
    v_cvt_pk_bf16_f32 v110, v188, v189
    v_cvt_pk_bf16_f32 v111, v190, v191
    v_fma_f32 v192, v192, v18, v19
    v_fma_f32 v193, v193, v18, v19
    v_mfma_f32_32x32x16_bf16 a[16:31], a[108:111], v[100:103], a[16:31]
    ds_read_b64_tr_b16 a[92:93], v7 offset:38912
    ds_read_b64_tr_b16 a[94:95], v7 offset:39424
    buffer_load_dwordx4 v8, s[12:15], s70 offen offset:0 lds
    v_fma_f32 v194, v194, v18, v19
    v_fma_f32 v195, v195, v18, v19
    v_fma_f32 v196, v196, v18, v19
    v_fma_f32 v197, v197, v18, v19
    v_fma_f32 v198, v198, v18, v19
    v_fma_f32 v199, v199, v18, v19
    s_waitcnt lgkmcnt(8)
    v_mfma_f32_32x32x16_bf16 a[0:15], a[64:67], v[104:107], a[0:15]
    ds_read_b64_tr_b16 a[96:97], v6 offset:43008
    ds_read_b64_tr_b16 a[98:99], v6 offset:43520
    v_cvt_pk_bf16_f32 v112, v192, v193
    v_cvt_pk_bf16_f32 v113, v194, v195
    v_cvt_pk_bf16_f32 v114, v196, v197
    v_cvt_pk_bf16_f32 v115, v198, v199
    v_fma_f32 v200, v200, v18, v19
    v_fma_f32 v201, v201, v18, v19
    v_fma_f32 v202, v202, v18, v19
    v_fma_f32 v203, v203, v18, v19
    v_fma_f32 v204, v204, v18, v19
    v_mfma_f32_32x32x16_bf16 a[16:31], a[68:71], v[104:107], a[16:31]
    ds_read_b64_tr_b16 a[100:101], v7 offset:43008
    ds_read_b64_tr_b16 a[102:103], v7 offset:43520
    buffer_load_dwordx4 v9, s[12:15], s70 offen offset:1024 lds
    v_fma_f32 v205, v205, v18, v19
    v_fma_f32 v206, v206, v18, v19
    v_fma_f32 v207, v207, v18, v19
    v_cvt_pk_bf16_f32 v116, v200, v201
    v_cvt_pk_bf16_f32 v117, v202, v203
    v_cvt_pk_bf16_f32 v118, v204, v205
    v_cvt_pk_bf16_f32 v119, v206, v207
    s_branch L_overG2
    .p2align 12
L_padG2:
    s_branch L_retGa
L_overG2:
    v_mfma_f32_32x32x16_bf16 a[0:15], a[72:75], v[108:111], a[0:15]
    ds_read_b64_tr_b16 a[104:105], v6 offset:47104
    ds_read_b64_tr_b16 a[106:107], v6 offset:47616
    buffer_load_dwordx4 v10, s[16:19], s70 offen offset:2048 lds
    v_fma_f32 v208, v208, v18, v19
    v_fma_f32 v209, v209, v18, v19
    v_fma_f32 v210, v210, v18, v19
    v_fma_f32 v211, v211, v18, v19
    v_fma_f32 v212, v212, v18, v19
    v_fma_f32 v213, v213, v18, v19
    v_fma_f32 v214, v214, v18, v19
    v_mfma_f32_32x32x16_bf16 a[16:31], a[76:79], v[108:111], a[16:31]
    ds_read_b64_tr_b16 a[108:109], v7 offset:47104
    ds_read_b64_tr_b16 a[110:111], v7 offset:47616
    v_fma_f32 v215, v215, v18, v19
    v_cvt_pk_bf16_f32 v120, v208, v209
    v_cvt_pk_bf16_f32 v121, v210, v211
    v_cvt_pk_bf16_f32 v122, v212, v213
    v_cvt_pk_bf16_f32 v123, v214, v215
    v_fma_f32 v216, v216, v18, v19
    v_fma_f32 v217, v217, v18, v19
    v_fma_f32 v218, v218, v18, v19
    s_waitcnt lgkmcnt(8)
    v_mfma_f32_32x32x16_bf16 a[0:15], a[80:83], v[112:115], a[0:15]
    buffer_load_dwordx4 v11, s[16:19], s70 offen offset:3072 lds
    s_add_u32 m0, s99, 32768
    s_add_u32 s70, s70, 128
    v_fma_f32 v219, v219, v18, v19
    v_fma_f32 v220, v220, v18, v19
    v_fma_f32 v221, v221, v18, v19
    v_fma_f32 v222, v222, v18, v19
    v_fma_f32 v223, v223, v18, v19
    v_cvt_pk_bf16_f32 v124, v216, v217
    v_cvt_pk_bf16_f32 v125, v218, v219
    v_mfma_f32_32x32x16_bf16 a[16:31], a[84:87], v[112:115], a[16:31]
    s_waitcnt vmcnt(14) lgkmcnt(0)
    s_barrier
    buffer_load_dword a33, v23, s[12:15], 0 offen
    buffer_load_dword a34, v23, s[16:19], 0 offen offset:2048
    v_lshrrev_b32 v31, 9, v23
    v_lshlrev_b32 v31, 7, v31
    global_load_dword a35, v31, s[38:39]
    ds_read_b64_tr_b16 a[64:65], v6 offset:0
    ds_read_b64_tr_b16 a[66:67], v6 offset:512
    s_add_u32 s84, s84, 114688
    buffer_load_dwordx4 v16, s[20:23], s84 offen lds
    v_mfma_f32_32x32x16_bf16 a[0:15], a[88:91], v[116:119], a[0:15]
    ds_read_b64_tr_b16 a[68:69], v7 offset:0
    ds_read_b64_tr_b16 a[70:71], v7 offset:512
    ds_read_b64_tr_b16 a[72:73], v6 offset:4096
    v_cvt_pk_bf16_f32 v126, v220, v221
    v_cvt_pk_bf16_f32 v127, v222, v223
    v_and_b32 v227, 0xffff0000, v229
    v_lshlrev_b32 v228, 16, v230
    v_and_b32 v229, 0xffff0000, v230
    v_lshlrev_b32 v230, 16, v231
    v_and_b32 v231, 0xffff0000, v231
    v_fma_f32 v224, v224, v18, v19
    v_mfma_f32_32x32x16_bf16 a[16:31], a[92:95], v[116:119], a[16:31]
    ds_read_b64_tr_b16 a[74:75], v6 offset:4608
    ds_read_b64_tr_b16 a[76:77], v7 offset:4096
    ds_read_b64_tr_b16 a[78:79], v7 offset:4608
    buffer_load_dwordx4 v17, s[20:23], s84 offen offset:1024 lds
    s_add_u32 m0, s99, 34816
    s_add_u32 s84, s84, 114688
    v_fma_f32 v225, v225, v18, v19
    v_fma_f32 v226, v226, v18, v19
    v_fma_f32 v227, v227, v18, v19
    v_mfma_f32_32x32x16_bf16 a[0:15], a[96:99], v[120:123], a[0:15]
    ds_read_b64_tr_b16 a[80:81], v6 offset:8192
    ds_read_b64_tr_b16 a[82:83], v6 offset:8704
    v_fma_f32 v228, v228, v18, v19
    v_fma_f32 v229, v229, v18, v19
    v_fma_f32 v230, v230, v18, v19
    v_fma_f32 v231, v231, v18, v19
    v_cvt_pk_bf16_f32 v128, v224, v225
    v_cvt_pk_bf16_f32 v129, v226, v227
    v_cvt_pk_bf16_f32 v130, v228, v229
    v_cvt_pk_bf16_f32 v131, v230, v231
    v_lshlrev_b32 v232, 16, v236
    v_mfma_f32_32x32x16_bf16 a[16:31], a[100:103], v[120:123], a[16:31]
    ds_read_b64_tr_b16 a[84:85], v7 offset:8192
    ds_read_b64_tr_b16 a[86:87], v7 offset:8704
    buffer_load_dwordx4 v16, s[20:23], s84 offen lds
    v_and_b32 v233, 0xffff0000, v236
    v_lshlrev_b32 v234, 16, v237
    v_and_b32 v235, 0xffff0000, v237
    v_lshlrev_b32 v236, 16, v238
    v_and_b32 v237, 0xffff0000, v238
    v_lshlrev_b32 v238, 16, v239
    v_and_b32 v239, 0xffff0000, v239
    v_mfma_f32_32x32x16_bf16 a[0:15], a[104:107], v[124:127], a[0:15]
    ds_read_b64_tr_b16 a[88:89], v6 offset:12288
    ds_read_b64_tr_b16 a[90:91], v6 offset:12800
    buffer_load_dwordx4 v17, s[20:23], s84 offen offset:1024 lds
    s_add_u32 m0, s80, 20480
    v_fma_f32 v232, v232, v18, v19
    v_fma_f32 v233, v233, v18, v19
    v_fma_f32 v234, v234, v18, v19
    v_fma_f32 v235, v235, v18, v19
    v_fma_f32 v236, v236, v18, v19
    v_fma_f32 v237, v237, v18, v19
    v_mfma_f32_32x32x16_bf16 a[16:31], a[108:111], v[124:127], a[16:31]
    ds_read_b64_tr_b16 a[92:93], v7 offset:12288
    ds_read_b64_tr_b16 a[94:95], v7 offset:12800
    v_fma_f32 v238, v238, v18, v19
    v_fma_f32 v239, v239, v18, v19
    v_cvt_pk_bf16_f32 v132, v232, v233
    v_cvt_pk_bf16_f32 v133, v234, v235
    v_cvt_pk_bf16_f32 v134, v236, v237
    v_cvt_pk_bf16_f32 v135, v238, v239
    v_lshlrev_b32 v240, 16, v244
    v_and_b32 v241, 0xffff0000, v244
    s_waitcnt lgkmcnt(8)
    v_mfma_f32_32x32x16_bf16 a[0:15], a[64:67], v[128:131], a[0:15]
    ds_read_b64_tr_b16 a[96:97], v2 offset:0
    ds_read_b64_tr_b16 a[98:99], v2 offset:512
    buffer_load_dwordx4 v8, s[12:15], s71 offen offset:0 lds
    v_lshlrev_b32 v242, 16, v245
    v_and_b32 v243, 0xffff0000, v245
    v_lshlrev_b32 v244, 16, v246
    v_and_b32 v245, 0xffff0000, v246
    v_lshlrev_b32 v246, 16, v247
    v_and_b32 v247, 0xffff0000, v247
    v_fma_f32 v240, v240, v18, v19
    v_mfma_f32_32x32x16_bf16 a[16:31], a[68:71], v[128:131], a[16:31]
    ds_read_b64_tr_b16 a[100:101], v3 offset:0
    ds_read_b64_tr_b16 a[102:103], v3 offset:512
    buffer_load_dwordx4 v9, s[12:15], s71 offen offset:1024 lds
    v_fma_f32 v241, v241, v18, v19
    v_fma_f32 v242, v242, v18, v19
    v_fma_f32 v243, v243, v18, v19
    v_fma_f32 v244, v244, v18, v19
    v_fma_f32 v245, v245, v18, v19
    v_fma_f32 v246, v246, v18, v19
    v_fma_f32 v247, v247, v18, v19
    v_mfma_f32_32x32x16_bf16 a[0:15], a[72:75], v[132:135], a[0:15]
    ds_read_b64_tr_b16 a[104:105], v4 offset:0
    ds_read_b64_tr_b16 a[106:107], v4 offset:512
    v_cvt_pk_bf16_f32 v136, v240, v241
    v_cvt_pk_bf16_f32 v137, v242, v243
    v_cvt_pk_bf16_f32 v138, v244, v245
    v_cvt_pk_bf16_f32 v139, v246, v247
    v_lshlrev_b32 v248, 16, v252
    v_and_b32 v249, 0xffff0000, v252
    v_lshlrev_b32 v250, 16, v253
    v_and_b32 v251, 0xffff0000, v253
    v_lshlrev_b32 v252, 16, v254
    v_mfma_f32_32x32x16_bf16 a[16:31], a[76:79], v[132:135], a[16:31]
    ds_read_b64_tr_b16 a[108:109], v5 offset:0
    ds_read_b64_tr_b16 a[110:111], v5 offset:512
    buffer_load_dwordx4 v10, s[16:19], s71 offen offset:2048 lds
    v_and_b32 v253, 0xffff0000, v254
    v_lshlrev_b32 v254, 16, v255
    v_and_b32 v255, 0xffff0000, v255
    v_fma_f32 v248, v248, v18, v19
    v_fma_f32 v249, v249, v18, v19
    v_fma_f32 v250, v250, v18, v19
    s_waitcnt lgkmcnt(8)
    v_mfma_f32_32x32x16_bf16 a[0:15], a[80:83], v[136:139], a[0:15]
    ds_read_b64_tr_b16 a[64:65], v2 offset:28672
    ds_read_b64_tr_b16 a[66:67], v2 offset:29184
    v_fma_f32 v251, v251, v18, v19
    v_fma_f32 v252, v252, v18, v19
    v_fma_f32 v253, v253, v18, v19
    v_fma_f32 v254, v254, v18, v19
    v_fma_f32 v255, v255, v18, v19
    v_cvt_pk_bf16_f32 v140, v248, v249
    v_cvt_pk_bf16_f32 v141, v250, v251
    v_cvt_pk_bf16_f32 v142, v252, v253
    v_cvt_pk_bf16_f32 v143, v254, v255
    v_mfma_f32_32x32x16_bf16 a[16:31], a[84:87], v[136:139], a[16:31]
    ds_read_b64_tr_b16 a[68:69], v3 offset:28672
    ds_read_b64_tr_b16 a[70:71], v3 offset:29184
    buffer_load_dwordx4 v11, s[16:19], s71 offen offset:3072 lds
    s_add_u32 m0, s80, 24576
    s_add_u32 s71, s71, 128
    v_mfma_f32_32x32x16_bf16 a[0:15], a[88:91], v[140:143], a[0:15]
    ds_read_b64_tr_b16 a[72:73], v4 offset:28672
    ds_read_b64_tr_b16 a[74:75], v4 offset:29184
    buffer_load_dwordx4 v8, s[12:15], s72 offen offset:0 lds
    v_add_u32 v24, 57344, v2
    v_add_u32 v25, 57344, v3
    v_add_u32 v26, 57344, v4
    v_mfma_f32_32x32x16_bf16 a[16:31], a[92:95], v[140:143], a[16:31]
    ds_read_b64_tr_b16 a[76:77], v5 offset:28672
    ds_read_b64_tr_b16 a[78:79], v5 offset:29184
    v_add_u32 v27, 57344, v5
    s_sub_u32 s1, s99, s80
    v_add_u32 v6, s1, v14
    v_add_u32 v7, s1, v15
    s_waitcnt lgkmcnt(8)
    v_mfma_f32_32x32x16_bf16 v[144:159], a[96:99], v[32:35], 0
    ds_read_b64_tr_b16 a[80:81], v24 offset:0
    ds_read_b64_tr_b16 a[82:83], v24 offset:512
    buffer_load_dwordx4 v9, s[12:15], s72 offen offset:1024 lds
    s_mov_b32 s73, s41
    s_mov_b32 s74, s42
    s_mov_b32 s75, s43
    v_mfma_f32_32x32x16_bf16 v[160:175], a[100:103], v[32:35], 0
    ds_read_b64_tr_b16 a[84:85], v25 offset:0
    ds_read_b64_tr_b16 a[86:87], v25 offset:512
    s_mov_b32 s79, s44
    s_mov_b32 s28, s38
    s_mov_b32 s29, s39
    s_mov_b32 s30, s48
    s_mov_b32 s31, s49
    v_mfma_f32_32x32x16_bf16 v[176:191], a[104:107], v[32:35], 0
    ds_read_b64_tr_b16 a[88:89], v26 offset:0
    ds_read_b64_tr_b16 a[90:91], v26 offset:512
    buffer_load_dwordx4 v10, s[16:19], s72 offen offset:2048 lds
    v_accvgpr_read_b32 v224, a0
    v_accvgpr_read_b32 v225, a1
    v_accvgpr_read_b32 v226, a2
    v_mfma_f32_32x32x16_bf16 v[192:207], a[108:111], v[32:35], 0
    ds_read_b64_tr_b16 a[92:93], v27 offset:0
    ds_read_b64_tr_b16 a[94:95], v27 offset:512
    v_accvgpr_read_b32 v227, a3
    v_accvgpr_read_b32 v228, a4
    v_accvgpr_read_b32 v229, a5
    s_waitcnt lgkmcnt(8) vmcnt(22)
    v_mfma_f32_32x32x16_bf16 v[144:159], a[64:67], v[36:39], v[144:159]
    ds_read_b64_tr_b16 a[96:97], v24 offset:28672
    ds_read_b64_tr_b16 a[98:99], v24 offset:29184
    buffer_load_dwordx4 v11, s[16:19], s72 offen offset:3072 lds
    s_add_u32 m0, s99, 2048
    s_add_u32 s72, s72, 128
    s_mov_b32 s76, 0
    s_load_dword s76, s[32:33], 0
    ds_read_b64_tr_b16 a[112:113], v6 offset:2048
    ds_read_b64_tr_b16 a[114:115], v6 offset:3072
    v_mfma_f32_32x32x16_bf16 v[160:175], a[68:71], v[36:39], v[160:175]
    ds_read_b64_tr_b16 a[100:101], v25 offset:28672
    ds_read_b64_tr_b16 a[102:103], v25 offset:29184
    ds_read_b64_tr_b16 a[116:117], v7 offset:2048
    ds_read_b64_tr_b16 a[118:119], v7 offset:3072
    v_accvgpr_read_b32 v230, a6
    v_accvgpr_read_b32 v231, a7
    v_cvt_pk_bf16_f32 v224, v224, v225
    v_mfma_f32_32x32x16_bf16 v[176:191], a[72:75], v[36:39], v[176:191]
    ds_read_b64_tr_b16 a[104:105], v26 offset:28672
    ds_read_b64_tr_b16 a[106:107], v26 offset:29184
    v_cvt_pk_bf16_f32 v225, v226, v227
    v_cvt_pk_bf16_f32 v226, v228, v229
    v_cvt_pk_bf16_f32 v227, v230, v231
    v_accvgpr_read_b32 v232, a8
    v_accvgpr_read_b32 v233, a9
    v_mfma_f32_32x32x16_bf16 v[192:207], a[76:79], v[36:39], v[192:207]
    ds_read_b64_tr_b16 a[108:109], v27 offset:28672
    ds_read_b64_tr_b16 a[110:111], v27 offset:29184
    v_accvgpr_read_b32 v234, a10
    v_accvgpr_read_b32 v235, a11
    v_accvgpr_read_b32 v236, a12
    s_waitcnt lgkmcnt(12) vmcnt(21)
    v_mfma_f32_32x32x16_bf16 v[144:159], a[80:83], v[40:43], v[144:159]
    ds_read_b64_tr_b16 a[64:65], v2 offset:4096
    ds_read_b64_tr_b16 a[66:67], v2 offset:4608
    ds_read_b64_tr_b16 a[120:121], v6 offset:16384
    ds_read_b64_tr_b16 a[122:123], v6 offset:17408
    v_accvgpr_read_b32 v237, a13
    v_accvgpr_read_b32 v238, a14
    v_accvgpr_read_b32 v239, a15
    v_mfma_f32_32x32x16_bf16 v[160:175], a[84:87], v[40:43], v[160:175]
    ds_read_b64_tr_b16 a[68:69], v3 offset:4096
    ds_read_b64_tr_b16 a[70:71], v3 offset:4608
    ds_read_b64_tr_b16 a[124:125], v7 offset:16384
    ds_read_b64_tr_b16 a[126:127], v7 offset:17408
    s_waitcnt lgkmcnt(12)
    s_add_u32 s84, s84, 114688
    buffer_load_dwordx4 v16, s[20:23], s84 offen lds
    v_mfma_f32_32x32x16_bf16 v[176:191], a[88:91], v[40:43], v[176:191]
    ds_read_b64_tr_b16 a[72:73], v4 offset:4096
    ds_read_b64_tr_b16 a[74:75], v4 offset:4608
    v_cvt_pk_bf16_f32 v232, v232, v233
    v_cvt_pk_bf16_f32 v233, v234, v235
    v_cvt_pk_bf16_f32 v234, v236, v237
    v_cvt_pk_bf16_f32 v235, v238, v239
    s_mov_b32 s34, 0xffffffff
    v_mfma_f32_32x32x16_bf16 v[192:207], a[92:95], v[40:43], v[192:207]
    ds_read_b64_tr_b16 a[76:77], v5 offset:4096
    ds_read_b64_tr_b16 a[78:79], v5 offset:4608
    buffer_load_dwordx4 v17, s[20:23], s84 offen offset:1024 lds
    s_add_u32 m0, s99, 16384
    s_mov_b32 s35, 0xfffffff0
    s_waitcnt lgkmcnt(12) vmcnt(21)
    v_mfma_f32_32x32x16_bf16 v[144:159], a[96:99], v[44:47], v[144:159]
    ds_read_b64_tr_b16 a[80:81], v2 offset:32768
    ds_read_b64_tr_b16 a[82:83], v2 offset:33280
    ds_read_b64_tr_b16 a[128:129], v6 offset:18432
    ds_read_b64_tr_b16 a[130:131], v6 offset:19456
    v_permlane32_swap_b32 v224, v226
    s_mov_b32 s36, 0xfffffffe
    v_mfma_f32_32x32x16_bf16 v[160:175], a[100:103], v[44:47], v[160:175]
    ds_read_b64_tr_b16 a[84:85], v3 offset:32768
    ds_read_b64_tr_b16 a[86:87], v3 offset:33280
    ds_read_b64_tr_b16 a[132:133], v7 offset:18432
    ds_read_b64_tr_b16 a[134:135], v7 offset:19456
    s_waitcnt lgkmcnt(12)
    s_add_u32 s84, s84, 4293533696
    buffer_load_dwordx4 v16, s[20:23], s84 offen lds
    v_mfma_f32_32x32x16_bf16 v[176:191], a[104:107], v[44:47], v[176:191]
    ds_read_b64_tr_b16 a[88:89], v4 offset:32768
    ds_read_b64_tr_b16 a[90:91], v4 offset:33280
    v_permlane32_swap_b32 v225, v227
    v_permlane32_swap_b32 v232, v234
    v_permlane32_swap_b32 v233, v235
    v_mfma_f32_32x32x16_bf16 v[192:207], a[108:111], v[44:47], v[192:207]
    ds_read_b64_tr_b16 a[92:93], v5 offset:32768
    ds_read_b64_tr_b16 a[94:95], v5 offset:33280
    buffer_load_dwordx4 v17, s[20:23], s84 offen offset:1024 lds
    s_add_u32 m0, s99, 18432
    v_accvgpr_read_b32 v240, a16
    s_waitcnt lgkmcnt(12) vmcnt(14)
    v_mfma_f32_32x32x16_bf16 v[144:159], a[64:67], v[48:51], v[144:159]
    ds_read_b64_tr_b16 a[96:97], v24 offset:4096
    ds_read_b64_tr_b16 a[98:99], v24 offset:4608
    ds_read_b64_tr_b16 a[136:137], v6 offset:32768
    ds_read_b64_tr_b16 a[138:139], v6 offset:33792
    v_accvgpr_read_b32 v241, a17
    v_accvgpr_read_b32 v242, a18
    v_accvgpr_read_b32 v243, a19
    v_accvgpr_read_b32 v244, a20
    v_mfma_f32_32x32x16_bf16 v[160:175], a[68:71], v[48:51], v[160:175]
    ds_read_b64_tr_b16 a[100:101], v25 offset:4096
    ds_read_b64_tr_b16 a[102:103], v25 offset:4608
    ds_read_b64_tr_b16 a[140:141], v7 offset:32768
    ds_read_b64_tr_b16 a[142:143], v7 offset:33792
    s_waitcnt lgkmcnt(12)
    s_add_u32 s84, s84, 114688
    buffer_load_dwordx4 v16, s[20:23], s84 offen lds
    v_mfma_f32_32x32x16_bf16 v[176:191], a[72:75], v[48:51], v[176:191]
    ds_read_b64_tr_b16 a[104:105], v26 offset:4096
    ds_read_b64_tr_b16 a[106:107], v26 offset:4608
    v_accvgpr_read_b32 v245, a21
    v_accvgpr_read_b32 v246, a22
    v_accvgpr_read_b32 v247, a23
    v_cvt_pk_bf16_f32 v240, v240, v241
    v_cvt_pk_bf16_f32 v241, v242, v243
    v_cvt_pk_bf16_f32 v242, v244, v245
    v_mfma_f32_32x32x16_bf16 v[192:207], a[76:79], v[48:51], v[192:207]
    ds_read_b64_tr_b16 a[108:109], v27 offset:4096
    ds_read_b64_tr_b16 a[110:111], v27 offset:4608
    buffer_load_dwordx4 v17, s[20:23], s84 offen offset:1024 lds
    s_add_u32 m0, s99, 32768
    v_cvt_pk_bf16_f32 v243, v246, v247
    s_waitcnt lgkmcnt(12) vmcnt(14)
    v_mfma_f32_32x32x16_bf16 v[144:159], a[80:83], v[52:55], v[144:159]
    ds_read_b64_tr_b16 a[64:65], v24 offset:32768
    ds_read_b64_tr_b16 a[66:67], v24 offset:33280
    ds_read_b64_tr_b16 a[144:145], v6 offset:34816
    ds_read_b64_tr_b16 a[146:147], v6 offset:35840
    v_accvgpr_read_b32 v248, a24
    v_accvgpr_read_b32 v249, a25
    v_accvgpr_read_b32 v250, a26
    v_accvgpr_read_b32 v251, a27
    v_mfma_f32_32x32x16_bf16 v[160:175], a[84:87], v[52:55], v[160:175]
    ds_read_b64_tr_b16 a[68:69], v25 offset:32768
    ds_read_b64_tr_b16 a[70:71], v25 offset:33280
    ds_read_b64_tr_b16 a[148:149], v7 offset:34816
    ds_read_b64_tr_b16 a[150:151], v7 offset:35840
    buffer_store_dwordx4 v[224:227], v1, s[24:27], s82 offen offset:0 sc1
    v_accvgpr_read_b32 v252, a28
    v_accvgpr_read_b32 v253, a29
    v_mfma_f32_32x32x16_bf16 v[176:191], a[88:91], v[52:55], v[176:191]
    ds_read_b64_tr_b16 a[72:73], v26 offset:32768
    ds_read_b64_tr_b16 a[74:75], v26 offset:33280
    v_accvgpr_read_b32 v254, a30
    v_accvgpr_read_b32 v255, a31
    v_cvt_pk_bf16_f32 v248, v248, v249
    v_cvt_pk_bf16_f32 v249, v250, v251
    v_cvt_pk_bf16_f32 v250, v252, v253
    v_cvt_pk_bf16_f32 v251, v254, v255
    v_mfma_f32_32x32x16_bf16 v[192:207], a[92:95], v[52:55], v[192:207]
    ds_read_b64_tr_b16 a[76:77], v27 offset:32768
    ds_read_b64_tr_b16 a[78:79], v27 offset:33280
    buffer_store_dwordx4 v[232:235], v1, s[24:27], s82 offen offset:1024 sc1
    v_permlane32_swap_b32 v240, v242
    s_mov_b32 s37, 0xffffffe0
    s_waitcnt lgkmcnt(12)
    v_mfma_f32_32x32x16_bf16 v[144:159], a[96:99], v[56:59], v[144:159]
    ds_read_b64_tr_b16 a[80:81], v2 offset:8192
    ds_read_b64_tr_b16 a[82:83], v2 offset:8704
    v_permlane32_swap_b32 v241, v243
    v_permlane32_swap_b32 v248, v250
    v_permlane32_swap_b32 v249, v251
    v_mfma_f32_32x32x16_bf16 v[160:175], a[100:103], v[56:59], v[160:175]
    ds_read_b64_tr_b16 a[84:85], v3 offset:8192
    ds_read_b64_tr_b16 a[86:87], v3 offset:8704
    buffer_store_dwordx4 v[240:243], v1, s[24:27], s82 offen offset:2048 sc1
    s_mov_b32 s38, 0xfffffffc
    s_mov_b32 s39, 0xffffffc0
    v_mfma_f32_32x32x16_bf16 v[176:191], a[104:107], v[56:59], v[176:191]
    ds_read_b64_tr_b16 a[88:89], v4 offset:8192
    ds_read_b64_tr_b16 a[90:91], v4 offset:8704
    s_mov_b32 s40, 0xfffffff8
    s_mov_b32 s41, 0xffffff80
    s_mov_b32 s42, 0xffffff00
    s_mov_b32 s43, 0xfffff000
    v_mfma_f32_32x32x16_bf16 v[192:207], a[108:111], v[56:59], v[192:207]
    ds_read_b64_tr_b16 a[92:93], v5 offset:8192
    ds_read_b64_tr_b16 a[94:95], v5 offset:8704
    buffer_store_dwordx4 v[248:251], v1, s[24:27], s82 offen offset:3072 sc1
    s_add_u32 s84, s84, 114688
    s_waitcnt lgkmcnt(8)
    v_mfma_f32_32x32x16_bf16 v[144:159], a[64:67], v[60:63], v[144:159]
    ds_read_b64_tr_b16 a[96:97], v2 offset:36864
    ds_read_b64_tr_b16 a[98:99], v2 offset:37376
    s_mov_b32 s44, 0xfffffe00
    s_mov_b32 s45, 0xffffe000
    s_mov_b32 s46, 0xfffffc00
    s_mov_b32 s47, 0xffffc000
    v_mfma_f32_32x32x16_bf16 v[160:175], a[68:71], v[60:63], v[160:175]
    ds_read_b64_tr_b16 a[100:101], v3 offset:36864
    ds_read_b64_tr_b16 a[102:103], v3 offset:37376
    buffer_load_dwordx4 v16, s[20:23], s84 offen lds
    s_mov_b32 s48, 0xfffff800
    s_mov_b32 s49, 0xffff8000
    v_mfma_f32_32x32x16_bf16 v[176:191], a[72:75], v[60:63], v[176:191]
    ds_read_b64_tr_b16 a[104:105], v4 offset:36864
    ds_read_b64_tr_b16 a[106:107], v4 offset:37376
    s_mov_b32 s50, 0xffff0000
    s_mov_b32 s51, 0xfff00000
    v_and_b32 v30, 32, v0
    v_lshlrev_b32 v30, 1, v30
    v_mfma_f32_32x32x16_bf16 v[192:207], a[76:79], v[60:63], v[192:207]
    ds_read_b64_tr_b16 a[108:109], v5 offset:36864
    ds_read_b64_tr_b16 a[110:111], v5 offset:37376
    buffer_load_dwordx4 v17, s[20:23], s84 offen offset:1024 lds
    s_add_u32 m0, s99, 34816
    s_waitcnt lgkmcnt(8) vmcnt(10)
    v_mfma_f32_32x32x16_bf16 v[144:159], a[80:83], v[64:67], v[144:159]
    ds_read_b64_tr_b16 a[64:65], v24 offset:8192
    ds_read_b64_tr_b16 a[66:67], v24 offset:8704
    ds_read_b64_tr_b16 a[152:153], v6 offset:2048
    ds_read_b64_tr_b16 a[154:155], v6 offset:3072
    s_cmp_lg_u32 s76, 0x1010101
    s_cbranch_scc1 L_slow_dbgG
L_back_dbgG:
    v_mfma_f32_32x32x16_bf16 v[160:175], a[84:87], v[64:67], v[160:175]
    ds_read_b64_tr_b16 a[68:69], v25 offset:8192
    ds_read_b64_tr_b16 a[70:71], v25 offset:8704
    ds_read_b64_tr_b16 a[156:157], v7 offset:2048
    ds_read_b64_tr_b16 a[158:159], v7 offset:3072
    s_add_u32 s84, s84, 114688
    buffer_load_dwordx4 v16, s[20:23], s84 offen lds
    v_mfma_f32_32x32x16_bf16 v[176:191], a[88:91], v[64:67], v[176:191]
    ds_read_b64_tr_b16 a[72:73], v26 offset:8192
    ds_read_b64_tr_b16 a[74:75], v26 offset:8704
    v_xor_b32 v22, v1, v30
    v_xor_b32 v23, 128, v22
    v_and_b32 v30, 512, v1
    v_mfma_f32_32x32x16_bf16 v[192:207], a[92:95], v[64:67], v[192:207]
    ds_read_b64_tr_b16 a[76:77], v27 offset:8192
    ds_read_b64_tr_b16 a[78:79], v27 offset:8704
    buffer_load_dwordx4 v17, s[20:23], s84 offen offset:1024 lds
    s_add_u32 m0, s99, 2048
    s_waitcnt lgkmcnt(12) vmcnt(10)
    v_mfma_f32_32x32x16_bf16 v[144:159], a[96:99], v[68:71], v[144:159]
    ds_read_b64_tr_b16 a[80:81], v24 offset:36864
    ds_read_b64_tr_b16 a[82:83], v24 offset:37376
    ds_read_b64_tr_b16 a[160:161], v6 offset:16384
    ds_read_b64_tr_b16 a[162:163], v6 offset:17408
    v_mfma_f32_32x32x16_bf16 v[160:175], a[100:103], v[68:71], v[160:175]
    ds_read_b64_tr_b16 a[84:85], v25 offset:36864
    ds_read_b64_tr_b16 a[86:87], v25 offset:37376
    ds_read_b64_tr_b16 a[164:165], v7 offset:16384
    ds_read_b64_tr_b16 a[166:167], v7 offset:17408
    s_waitcnt lgkmcnt(12)
    s_add_u32 s84, s84, 114688
    buffer_load_dwordx4 v16, s[20:23], s84 offen lds
    v_mfma_f32_32x32x16_bf16 v[176:191], a[104:107], v[68:71], v[176:191]
    ds_read_b64_tr_b16 a[88:89], v26 offset:36864
    ds_read_b64_tr_b16 a[90:91], v26 offset:37376
    s_cmp_ge_u32 s52, 1
    s_cselect_b64 vcc, -1, 0
    v_cndmask_b32 v13, v30, v23, vcc
    v_cndmask_b32 v12, v30, v22, vcc
    v_mfma_f32_32x32x16_bf16 v[192:207], a[108:111], v[68:71], v[192:207]
    ds_read_b64_tr_b16 a[92:93], v27 offset:36864
    ds_read_b64_tr_b16 a[94:95], v27 offset:37376
    buffer_load_dwordx4 v17, s[20:23], s84 offen offset:1024 lds
    s_add_u32 m0, s80, 0
    s_waitcnt lgkmcnt(12)
    v_mfma_f32_32x32x16_bf16 v[144:159], a[64:67], v[72:75], v[144:159]
    s_cmp_ge_u32 s52, 2
    s_cselect_b64 vcc, -1, 0
    v_cndmask_b32 v31, v30, v23, vcc
    v_cndmask_b32 v30, v30, v22, vcc
    v_mfma_f32_32x32x16_bf16 v[160:175], a[68:71], v[72:75], v[160:175]
    s_waitcnt lgkmcnt(0)
    s_barrier
    ds_read_b64_tr_b16 a[96:97], v2 offset:12288
    ds_read_b64_tr_b16 a[98:99], v2 offset:12800
    buffer_load_dwordx4 v8, s[12:15], s66 offen offset:0 lds
    v_mfma_f32_32x32x16_bf16 v[176:191], a[72:75], v[72:75], v[176:191]
    ds_read_b64_tr_b16 a[100:101], v2 offset:40960
    ds_read_b64_tr_b16 a[102:103], v2 offset:41472
    ds_read_b64_tr_b16 a[104:105], v24 offset:12288
    v_mfma_f32_32x32x16_bf16 v[192:207], a[76:79], v[72:75], v[192:207]
    ds_read_b64_tr_b16 a[106:107], v24 offset:12800
    ds_read_b64_tr_b16 a[108:109], v24 offset:40960
    ds_read_b64_tr_b16 a[110:111], v24 offset:41472
    buffer_load_dwordx4 v9, s[12:15], s66 offen offset:1024 lds
    v_mfma_f32_32x32x16_bf16 v[144:159], a[80:83], v[76:79], v[144:159]
    ds_read_b64_tr_b16 a[64:65], v2 offset:16384
    ds_read_b64_tr_b16 a[66:67], v2 offset:16896
    v_mfma_f32_32x32x16_bf16 v[160:175], a[84:87], v[76:79], v[160:175]
    ds_read_b64_tr_b16 a[68:69], v2 offset:45056
    ds_read_b64_tr_b16 a[70:71], v2 offset:45568
    buffer_load_dwordx4 v10, s[16:19], s66 offen offset:2048 lds
    v_mfma_f32_32x32x16_bf16 v[176:191], a[88:91], v[76:79], v[176:191]
    ds_read_b64_tr_b16 a[72:73], v24 offset:16384
    ds_read_b64_tr_b16 a[74:75], v24 offset:16896
    v_mfma_f32_32x32x16_bf16 v[192:207], a[92:95], v[76:79], v[192:207]
    ds_read_b64_tr_b16 a[76:77], v24 offset:45056
    ds_read_b64_tr_b16 a[78:79], v24 offset:45568
    buffer_load_dwordx4 v11, s[16:19], s66 offen offset:3072 lds
    s_add_u32 m0, s80, 4096
    s_waitcnt lgkmcnt(8) vmcnt(14)
    v_mfma_f32_32x32x16_bf16 v[144:159], a[96:99], v[80:83], v[144:159]
    ds_read_b64_tr_b16 a[80:81], v2 offset:20480
    ds_read_b64_tr_b16 a[82:83], v2 offset:20992
    ds_read_b64_tr_b16 a[168:169], v6 offset:18432
    ds_read_b64_tr_b16 a[170:171], v6 offset:19456
    v_mfma_f32_32x32x16_bf16 v[144:159], a[100:103], v[84:87], v[144:159]
    s_cmp_eq_u32 s99, 0
    s_cbranch_scc1 L_padG5
    s_cmp_eq_u32 s99, 4096
    s_cbranch_scc1 L_padG6
L_retGb:
    ds_read_b64_tr_b16 a[84:85], v2 offset:49152
    ds_read_b64_tr_b16 a[86:87], v2 offset:49664
    ds_read_b64_tr_b16 a[172:173], v7 offset:18432
    ds_read_b64_tr_b16 a[174:175], v7 offset:19456
    buffer_load_dwordx4 v8, s[12:15], s67 offen offset:0 lds
    v_mfma_f32_32x32x16_bf16 v[144:159], a[104:107], v[88:91], v[144:159]
    ds_read_b64_tr_b16 a[88:89], v24 offset:20480
    ds_read_b64_tr_b16 a[90:91], v24 offset:20992
    v_mfma_f32_32x32x16_bf16 v[144:159], a[108:111], v[92:95], v[144:159]
    ds_read_b64_tr_b16 a[92:93], v24 offset:49152
    ds_read_b64_tr_b16 a[94:95], v24 offset:49664
    buffer_load_dwordx4 v9, s[12:15], s67 offen offset:1024 lds
    s_waitcnt lgkmcnt(12)
    v_mfma_f32_32x32x16_bf16 v[144:159], a[64:67], v[96:99], v[144:159]
    ds_read_b64_tr_b16 a[96:97], v2 offset:24576
    ds_read_b64_tr_b16 a[98:99], v2 offset:25088
    v_mfma_f32_32x32x16_bf16 v[144:159], a[68:71], v[100:103], v[144:159]
    ds_read_b64_tr_b16 a[100:101], v2 offset:53248
    ds_read_b64_tr_b16 a[102:103], v2 offset:53760
    buffer_load_dwordx4 v10, s[16:19], s67 offen offset:2048 lds
    v_mfma_f32_32x32x16_bf16 v[144:159], a[72:75], v[104:107], v[144:159]
    ds_read_b64_tr_b16 a[104:105], v24 offset:24576
    ds_read_b64_tr_b16 a[106:107], v24 offset:25088
    s_branch L_overG3
    .p2align 12
L_padG3:
    s_branch L_retGa
L_overG3:
    v_mfma_f32_32x32x16_bf16 v[144:159], a[76:79], v[108:111], v[144:159]
    ds_read_b64_tr_b16 a[108:109], v24 offset:53248
    ds_read_b64_tr_b16 a[110:111], v24 offset:53760
    buffer_load_dwordx4 v11, s[16:19], s67 offen offset:3072 lds
    s_add_u32 m0, s80, 8192
    s_waitcnt lgkmcnt(8)
    v_mfma_f32_32x32x16_bf16 v[144:159], a[80:83], v[112:115], v[144:159]
    ds_read_b64_tr_b16 a[64:65], v3 offset:12288
    ds_read_b64_tr_b16 a[66:67], v3 offset:12800
    s_waitcnt vmcnt(14)
    s_buffer_atomic_or s75, s[24:27], s79 offset:0
    v_mfma_f32_32x32x16_bf16 v[144:159], a[84:87], v[116:119], v[144:159]
    ds_read_b64_tr_b16 a[68:69], v3 offset:40960
    ds_read_b64_tr_b16 a[70:71], v3 offset:41472
    v_mfma_f32_32x32x16_bf16 v[144:159], a[88:91], v[120:123], v[144:159]
    ds_read_b64_tr_b16 a[72:73], v25 offset:12288
    ds_read_b64_tr_b16 a[74:75], v25 offset:12800
    v_mfma_f32_32x32x16_bf16 v[144:159], a[92:95], v[124:127], v[144:159]
    ds_read_b64_tr_b16 a[76:77], v25 offset:40960
    ds_read_b64_tr_b16 a[78:79], v25 offset:41472
    s_waitcnt lgkmcnt(8) vmcnt(12)
    v_mfma_f32_32x32x16_bf16 v[144:159], a[96:99], v[128:131], v[144:159]
    ds_read_b64_tr_b16 a[80:81], v3 offset:16384
    ds_read_b64_tr_b16 a[82:83], v3 offset:16896
    ds_read_b64_tr_b16 a[176:177], v6 offset:32768
    ds_read_b64_tr_b16 a[178:179], v6 offset:33792
    v_mfma_f32_32x32x16_bf16 v[144:159], a[100:103], v[132:135], v[144:159]
    ds_read_b64_tr_b16 a[84:85], v3 offset:45056
    ds_read_b64_tr_b16 a[86:87], v3 offset:45568
    ds_read_b64_tr_b16 a[180:181], v7 offset:32768
    ds_read_b64_tr_b16 a[182:183], v7 offset:33792
    buffer_load_dwordx4 v8, s[12:15], s68 offen offset:0 lds
    v_mfma_f32_32x32x16_bf16 v[144:159], a[104:107], v[136:139], v[144:159]
    ds_read_b64_tr_b16 a[88:89], v25 offset:16384
    ds_read_b64_tr_b16 a[90:91], v25 offset:16896
    v_mfma_f32_32x32x16_bf16 v[144:159], a[108:111], v[140:143], v[144:159]
    ds_read_b64_tr_b16 a[92:93], v25 offset:45056
    ds_read_b64_tr_b16 a[94:95], v25 offset:45568
    buffer_load_dwordx4 v9, s[12:15], s68 offen offset:1024 lds
    s_waitcnt lgkmcnt(12) vmcnt(12)
    v_mfma_f32_32x32x16_bf16 v[160:175], a[64:67], v[80:83], v[160:175]
    ds_read_b64_tr_b16 a[96:97], v3 offset:20480
    ds_read_b64_tr_b16 a[98:99], v3 offset:20992
    v_mfma_f32_32x32x16_bf16 v[160:175], a[68:71], v[84:87], v[160:175]
    ds_read_b64_tr_b16 a[100:101], v3 offset:49152
    ds_read_b64_tr_b16 a[102:103], v3 offset:49664
    buffer_load_dwordx4 v10, s[16:19], s68 offen offset:2048 lds
    v_mfma_f32_32x32x16_bf16 v[160:175], a[72:75], v[88:91], v[160:175]
    ds_read_b64_tr_b16 a[104:105], v25 offset:20480
    ds_read_b64_tr_b16 a[106:107], v25 offset:20992
    v_mul_f32 v152, v144, v152
    v_mul_f32 v153, v145, v153
    v_mul_f32 v154, v146, v154
    v_mul_f32 v155, v147, v155
    v_exp_f32 v144, -v144
    v_mfma_f32_32x32x16_bf16 v[160:175], a[76:79], v[92:95], v[160:175]
    ds_read_b64_tr_b16 a[108:109], v25 offset:49152
    ds_read_b64_tr_b16 a[110:111], v25 offset:49664
    buffer_load_dwordx4 v11, s[16:19], s68 offen offset:3072 lds
    s_add_u32 m0, s99, 16384
    ds_read_b64_tr_b16 a[184:185], v6 offset:34816
    ds_read_b64_tr_b16 a[186:187], v6 offset:35840
    s_waitcnt lgkmcnt(10) vmcnt(12)
    v_mfma_f32_32x32x16_bf16 v[160:175], a[80:83], v[96:99], v[160:175]
    ds_read_b64_tr_b16 a[64:65], v3 offset:24576
    ds_read_b64_tr_b16 a[66:67], v3 offset:25088
    ds_read_b64_tr_b16 a[188:189], v7 offset:34816
    ds_read_b64_tr_b16 a[190:191], v7 offset:35840
    s_add_u32 s84, s84, 114688
    v_exp_f32 v145, -v145
    v_mfma_f32_32x32x16_bf16 v[160:175], a[84:87], v[100:103], v[160:175]
    ds_read_b64_tr_b16 a[68:69], v3 offset:53248
    ds_read_b64_tr_b16 a[70:71], v3 offset:53760
    buffer_load_dwordx4 v16, s[20:23], s84 offen lds
    v_exp_f32 v146, -v146
    v_exp_f32 v147, -v147
    v_mfma_f32_32x32x16_bf16 v[160:175], a[88:91], v[104:107], v[160:175]
    ds_read_b64_tr_b16 a[72:73], v25 offset:24576
    ds_read_b64_tr_b16 a[74:75], v25 offset:25088
    v_fma_f32 v144, v144, s0, s0
    v_fma_f32 v145, v145, s0, s0
    v_fma_f32 v146, v146, s0, s0
    v_fma_f32 v147, v147, s0, s0
    v_rcp_f32 v144, v144
    v_mfma_f32_32x32x16_bf16 v[160:175], a[92:95], v[108:111], v[160:175]
    ds_read_b64_tr_b16 a[76:77], v25 offset:53248
    ds_read_b64_tr_b16 a[78:79], v25 offset:53760
    buffer_load_dwordx4 v17, s[20:23], s84 offen offset:1024 lds
    s_add_u32 m0, s99, 18432
    ds_read_b64_tr_b16 a[192:193], v6 offset:2048
    ds_read_b64_tr_b16 a[194:195], v6 offset:3072
    s_waitcnt lgkmcnt(14)
    v_mfma_f32_32x32x16_bf16 v[160:175], a[96:99], v[112:115], v[160:175]
    ds_read_b64_tr_b16 a[80:81], v4 offset:12288
    ds_read_b64_tr_b16 a[82:83], v4 offset:12800
    ds_read_b64_tr_b16 a[196:197], v7 offset:2048
    ds_read_b64_tr_b16 a[198:199], v7 offset:3072
    s_add_u32 s84, s84, 4294336512
    v_rcp_f32 v145, v145
    v_mfma_f32_32x32x16_bf16 v[160:175], a[100:103], v[116:119], v[160:175]
    ds_read_b64_tr_b16 a[84:85], v4 offset:40960
    ds_read_b64_tr_b16 a[86:87], v4 offset:41472
    buffer_load_dwordx4 v16, s[20:23], s84 offen lds
    v_rcp_f32 v146, v146
    v_rcp_f32 v147, v147
    v_mfma_f32_32x32x16_bf16 v[160:175], a[104:107], v[120:123], v[160:175]
    ds_read_b64_tr_b16 a[88:89], v26 offset:12288
    ds_read_b64_tr_b16 a[90:91], v26 offset:12800
    v_mul_f32 v152, v144, v152
    v_mul_f32 v153, v145, v153
    v_mul_f32 v154, v146, v154
    v_mul_f32 v155, v147, v155
    v_cvt_pk_bf16_f32 v224, v152, v153
    v_cvt_pk_bf16_f32 v225, v154, v155
    v_mfma_f32_32x32x16_bf16 v[160:175], a[108:111], v[124:127], v[160:175]
    ds_read_b64_tr_b16 a[92:93], v26 offset:40960
    ds_read_b64_tr_b16 a[94:95], v26 offset:41472
    buffer_load_dwordx4 v17, s[20:23], s84 offen offset:1024 lds
    s_add_u32 m0, s99, 0
    s_add_u32 s84, s84, 114688
    v_mul_f32 v156, v148, v156
    s_waitcnt lgkmcnt(12)
    v_mfma_f32_32x32x16_bf16 v[160:175], a[64:67], v[128:131], v[160:175]
    ds_read_b64_tr_b16 a[96:97], v4 offset:16384
    ds_read_b64_tr_b16 a[98:99], v4 offset:16896
    v_mul_f32 v157, v149, v157
    v_mul_f32 v158, v150, v158
    v_mul_f32 v159, v151, v159
    v_exp_f32 v148, -v148
    v_mfma_f32_32x32x16_bf16 v[160:175], a[68:71], v[132:135], v[160:175]
    ds_read_b64_tr_b16 a[100:101], v4 offset:45056
    ds_read_b64_tr_b16 a[102:103], v4 offset:45568
    buffer_load_dwordx4 v16, s[20:23], s84 offen lds
    v_exp_f32 v149, -v149
    v_exp_f32 v150, -v150
    v_mfma_f32_32x32x16_bf16 v[160:175], a[72:75], v[136:139], v[160:175]
    ds_read_b64_tr_b16 a[104:105], v26 offset:16384
    ds_read_b64_tr_b16 a[106:107], v26 offset:16896
    v_exp_f32 v151, -v151
    v_fma_f32 v148, v148, s0, s0
    v_fma_f32 v149, v149, s0, s0
    v_fma_f32 v150, v150, s0, s0
    v_fma_f32 v151, v151, s0, s0
    v_mfma_f32_32x32x16_bf16 v[160:175], a[76:79], v[140:143], v[160:175]
    ds_read_b64_tr_b16 a[108:109], v26 offset:45056
    ds_read_b64_tr_b16 a[110:111], v26 offset:45568
    buffer_load_dwordx4 v17, s[20:23], s84 offen offset:1024 lds
    s_add_u32 m0, s99, 32768
    s_add_u32 s84, s84, 114688
    s_waitcnt lgkmcnt(8)
    v_mfma_f32_32x32x16_bf16 v[176:191], a[80:83], v[80:83], v[176:191]
    ds_read_b64_tr_b16 a[64:65], v4 offset:20480
    ds_read_b64_tr_b16 a[66:67], v4 offset:20992
    v_rcp_f32 v148, v148
    v_rcp_f32 v149, v149
    v_rcp_f32 v150, v150
    v_mfma_f32_32x32x16_bf16 v[176:191], a[84:87], v[84:87], v[176:191]
    ds_read_b64_tr_b16 a[68:69], v4 offset:49152
    ds_read_b64_tr_b16 a[70:71], v4 offset:49664
    buffer_load_dwordx4 v16, s[20:23], s84 offen lds
    v_rcp_f32 v151, v151
    v_mul_f32 v156, v148, v156
    v_mul_f32 v157, v149, v157
    v_mfma_f32_32x32x16_bf16 v[176:191], a[88:91], v[88:91], v[176:191]
    ds_read_b64_tr_b16 a[72:73], v26 offset:20480
    ds_read_b64_tr_b16 a[74:75], v26 offset:20992
    v_mul_f32 v158, v150, v158
    v_mul_f32 v159, v151, v159
    v_cvt_pk_bf16_f32 v226, v156, v157
    v_cvt_pk_bf16_f32 v227, v158, v159
    v_mul_f32 v168, v160, v168
    v_mul_f32 v169, v161, v169
    v_mfma_f32_32x32x16_bf16 v[176:191], a[92:95], v[92:95], v[176:191]
    ds_read_b64_tr_b16 a[76:77], v26 offset:49152
    ds_read_b64_tr_b16 a[78:79], v26 offset:49664
    buffer_load_dwordx4 v17, s[20:23], s84 offen offset:1024 lds
    s_add_u32 m0, s99, 34816
    s_add_u32 s84, s84, 114688
    v_mul_f32 v170, v162, v170
    s_waitcnt lgkmcnt(8)
    v_mfma_f32_32x32x16_bf16 v[176:191], a[96:99], v[96:99], v[176:191]
    ds_read_b64_tr_b16 a[80:81], v4 offset:24576
    ds_read_b64_tr_b16 a[82:83], v4 offset:25088
    v_mul_f32 v171, v163, v171
    v_exp_f32 v160, -v160
    v_exp_f32 v161, -v161
    v_mfma_f32_32x32x16_bf16 v[176:191], a[100:103], v[100:103], v[176:191]
    ds_read_b64_tr_b16 a[84:85], v4 offset:53248
    ds_read_b64_tr_b16 a[86:87], v4 offset:53760
    buffer_load_dwordx4 v16, s[20:23], s84 offen lds
    v_exp_f32 v162, -v162
    v_exp_f32 v163, -v163
    v_mfma_f32_32x32x16_bf16 v[176:191], a[104:107], v[104:107], v[176:191]
    ds_read_b64_tr_b16 a[88:89], v26 offset:24576
    ds_read_b64_tr_b16 a[90:91], v26 offset:25088
    v_fma_f32 v160, v160, s0, s0
    v_fma_f32 v161, v161, s0, s0
    v_fma_f32 v162, v162, s0, s0
    v_fma_f32 v163, v163, s0, s0
    v_rcp_f32 v160, v160
    v_mfma_f32_32x32x16_bf16 v[176:191], a[108:111], v[108:111], v[176:191]
    ds_read_b64_tr_b16 a[92:93], v26 offset:53248
    ds_read_b64_tr_b16 a[94:95], v26 offset:53760
    buffer_load_dwordx4 v17, s[20:23], s84 offen offset:1024 lds
    s_add_u32 m0, s99, 2048
    s_waitcnt lgkmcnt(8) vmcnt(8)
    v_mfma_f32_32x32x16_bf16 v[176:191], a[64:67], v[112:115], v[176:191]
    ds_read_b64_tr_b16 a[96:97], v5 offset:12288
    ds_read_b64_tr_b16 a[98:99], v5 offset:12800
    v_rcp_f32 v161, v161
    v_rcp_f32 v162, v162
    v_rcp_f32 v163, v163
    v_mfma_f32_32x32x16_bf16 v[176:191], a[68:71], v[116:119], v[176:191]
    ds_read_b64_tr_b16 a[100:101], v5 offset:40960
    ds_read_b64_tr_b16 a[102:103], v5 offset:41472
    buffer_store_dwordx4 v[224:227], v1, s[24:27], s81 offen offset:0 sc1
    s_add_u32 s84, s84, 114688
    v_mul_f32 v168, v160, v168
    v_mul_f32 v169, v161, v169
    v_mfma_f32_32x32x16_bf16 v[176:191], a[72:75], v[120:123], v[176:191]
    ds_read_b64_tr_b16 a[104:105], v27 offset:12288
    ds_read_b64_tr_b16 a[106:107], v27 offset:12800
    v_mul_f32 v170, v162, v170
    v_mul_f32 v171, v163, v171
    v_cvt_pk_bf16_f32 v228, v168, v169
    v_cvt_pk_bf16_f32 v229, v170, v171
    v_mul_f32 v172, v164, v172
    v_mul_f32 v173, v165, v173
    v_mfma_f32_32x32x16_bf16 v[176:191], a[76:79], v[124:127], v[176:191]
    ds_read_b64_tr_b16 a[108:109], v27 offset:40960
    ds_read_b64_tr_b16 a[110:111], v27 offset:41472
    buffer_load_dwordx4 v16, s[20:23], s84 offen lds
    v_mul_f32 v174, v166, v174
    v_mul_f32 v175, v167, v175
    s_waitcnt lgkmcnt(8) vmcnt(8)
    v_mfma_f32_32x32x16_bf16 v[176:191], a[80:83], v[128:131], v[176:191]
    ds_read_b64_tr_b16 a[64:65], v5 offset:16384
    ds_read_b64_tr_b16 a[66:67], v5 offset:16896
    v_exp_f32 v164, -v164
    v_exp_f32 v165, -v165
    v_exp_f32 v166, -v166
    v_mfma_f32_32x32x16_bf16 v[176:191], a[84:87], v[132:135], v[176:191]
    ds_read_b64_tr_b16 a[68:69], v5 offset:45056
    ds_read_b64_tr_b16 a[70:71], v5 offset:45568
    buffer_load_dwordx4 v17, s[20:23], s84 offen offset:1024 lds
    s_add_u32 m0, s99, 16384
    ds_read_b64_tr_b16 a[200:201], v6 offset:16384
    ds_read_b64_tr_b16 a[202:203], v6 offset:17408
    v_mfma_f32_32x32x16_bf16 v[176:191], a[88:91], v[136:139], v[176:191]
    ds_read_b64_tr_b16 a[72:73], v27 offset:16384
    ds_read_b64_tr_b16 a[74:75], v27 offset:16896
    ds_read_b64_tr_b16 a[204:205], v7 offset:16384
    ds_read_b64_tr_b16 a[206:207], v7 offset:17408
    v_exp_f32 v167, -v167
    v_fma_f32 v164, v164, s0, s0
    v_fma_f32 v165, v165, s0, s0
    v_fma_f32 v166, v166, s0, s0
    v_mfma_f32_32x32x16_bf16 v[176:191], a[92:95], v[140:143], v[176:191]
    ds_read_b64_tr_b16 a[76:77], v27 offset:45056
    ds_read_b64_tr_b16 a[78:79], v27 offset:45568
    ds_read_b64_tr_b16 a[0:1], v6 offset:18432
    ds_read_b64_tr_b16 a[2:3], v6 offset:19456
    v_fma_f32 v167, v167, s0, s0
    v_rcp_f32 v164, v164
    s_waitcnt lgkmcnt(14) vmcnt(7)
    v_mfma_f32_32x32x16_bf16 v[192:207], a[96:99], v[80:83], v[192:207]
    ds_read_b64_tr_b16 a[80:81], v5 offset:20480
    ds_read_b64_tr_b16 a[82:83], v5 offset:20992
    ds_read_b64_tr_b16 a[4:5], v7 offset:18432
    ds_read_b64_tr_b16 a[6:7], v7 offset:19456
    s_waitcnt lgkmcnt(8)
    s_add_u32 s84, s84, 114688
    buffer_load_dwordx4 v16, s[20:23], s84 offen lds
    v_mfma_f32_32x32x16_bf16 v[192:207], a[100:103], v[84:87], v[192:207]
    ds_read_b64_tr_b16 a[84:85], v5 offset:49152
    ds_read_b64_tr_b16 a[86:87], v5 offset:49664
    v_rcp_f32 v165, v165
    v_rcp_f32 v166, v166
    v_rcp_f32 v167, v167
    v_mul_f32 v172, v164, v172
    v_mfma_f32_32x32x16_bf16 v[192:207], a[104:107], v[88:91], v[192:207]
    ds_read_b64_tr_b16 a[88:89], v27 offset:20480
    ds_read_b64_tr_b16 a[90:91], v27 offset:20992
    buffer_load_dwordx4 v17, s[20:23], s84 offen offset:1024 lds
    s_add_u32 m0, s99, 18432
    ds_read_b64_tr_b16 a[8:9], v6 offset:0
    ds_read_b64_tr_b16 a[10:11], v6 offset:1024
    v_mul_f32 v184, v176, v184
    v_mul_f32 v185, v177, v185
    v_mfma_f32_32x32x16_bf16 v[192:207], a[108:111], v[92:95], v[192:207]
    ds_read_b64_tr_b16 a[92:93], v27 offset:49152
    ds_read_b64_tr_b16 a[94:95], v27 offset:49664
    ds_read_b64_tr_b16 a[12:13], v7 offset:0
    ds_read_b64_tr_b16 a[14:15], v7 offset:1024
    s_waitcnt lgkmcnt(10)
    s_add_u32 s84, s84, 114688
    v_mul_f32 v186, v178, v186
    v_mul_f32 v187, v179, v187
    v_mfma_f32_32x32x16_bf16 v[192:207], a[64:67], v[96:99], v[192:207]
    ds_read_b64_tr_b16 a[96:97], v5 offset:24576
    ds_read_b64_tr_b16 a[98:99], v5 offset:25088
    buffer_load_dwordx4 v16, s[20:23], s84 offen lds
    v_exp_f32 v176, -v176
    v_exp_f32 v177, -v177
    v_mul_f32 v173, v165, v173
    v_mfma_f32_32x32x16_bf16 v[192:207], a[68:71], v[100:103], v[192:207]
    ds_read_b64_tr_b16 a[100:101], v5 offset:53248
    ds_read_b64_tr_b16 a[102:103], v5 offset:53760
    v_exp_f32 v178, -v178
    v_exp_f32 v179, -v179
    v_fma_f32 v176, v176, s0, s0
    v_fma_f32 v177, v177, s0, s0
    v_fma_f32 v178, v178, s0, s0
    v_mfma_f32_32x32x16_bf16 v[192:207], a[72:75], v[104:107], v[192:207]
    ds_read_b64_tr_b16 a[104:105], v27 offset:24576
    ds_read_b64_tr_b16 a[106:107], v27 offset:25088
    buffer_load_dwordx4 v17, s[20:23], s84 offen offset:1024 lds
    s_add_u32 m0, s99, 0
    s_waitcnt lgkmcnt(6)
    s_add_u32 s84, s84, 114688
    v_fma_f32 v179, v179, s0, s0
    v_mul_f32 v174, v166, v174
    v_mfma_f32_32x32x16_bf16 v[192:207], a[76:79], v[108:111], v[192:207]
    ds_read_b64_tr_b16 a[108:109], v27 offset:53248
    ds_read_b64_tr_b16 a[110:111], v27 offset:53760
    v_rcp_f32 v176, v176
    v_rcp_f32 v177, v177
    v_rcp_f32 v178, v178
    v_mfma_f32_32x32x16_bf16 v[192:207], a[80:83], v[112:115], v[192:207]
    buffer_load_dwordx4 v16, s[20:23], s84 offen lds
    v_rcp_f32 v179, v179
    v_mul_f32 v184, v176, v184
    v_mul_f32 v185, v177, v185
    v_mul_f32 v186, v178, v186
    v_mul_f32 v187, v179, v187
    v_cvt_pk_bf16_f32 v232, v184, v185
    v_mfma_f32_32x32x16_bf16 v[192:207], a[84:87], v[116:119], v[192:207]
    s_waitcnt lgkmcnt(0)
    s_barrier
    ds_read_b64_tr_b16 a[64:65], v2 offset:0
    ds_read_b64_tr_b16 a[66:67], v2 offset:512
    v_cvt_pk_bf16_f32 v233, v186, v187
    v_mul_f32 v188, v180, v188
    v_mul_f32 v189, v181, v189
    v_mul_f32 v190, v182, v190
    v_mfma_f32_32x32x16_bf16 v[192:207], a[88:91], v[120:123], v[192:207]
    ds_read_b64_tr_b16 a[68:69], v3 offset:0
    ds_read_b64_tr_b16 a[70:71], v3 offset:512
    ds_read_b64_tr_b16 a[72:73], v4 offset:0
    buffer_load_dwordx4 v17, s[20:23], s84 offen offset:1024 lds
    s_add_u32 m0, s80, 12288
    v_mul_f32 v191, v183, v191
    v_exp_f32 v180, -v180
    v_mfma_f32_32x32x16_bf16 v[192:207], a[92:95], v[124:127], v[192:207]
    ds_read_b64_tr_b16 a[74:75], v4 offset:512
    ds_read_b64_tr_b16 a[76:77], v5 offset:0
    ds_read_b64_tr_b16 a[78:79], v5 offset:512
    v_exp_f32 v181, -v181
    v_mul_f32 v175, v167, v175
    v_cvt_pk_bf16_f32 v230, v172, v173
    v_cvt_pk_bf16_f32 v231, v174, v175
    v_mfma_f32_32x32x16_bf16 v[192:207], a[96:99], v[128:131], v[192:207]
    ds_read_b64_tr_b16 a[80:81], v2 offset:28672
    ds_read_b64_tr_b16 a[82:83], v2 offset:29184
    buffer_store_dwordx4 v[228:231], v1, s[24:27], s81 offen offset:1024 sc1
    v_exp_f32 v182, -v182
    v_mfma_f32_32x32x16_bf16 v[192:207], a[100:103], v[132:135], v[192:207]
    ds_read_b64_tr_b16 a[84:85], v3 offset:28672
    ds_read_b64_tr_b16 a[86:87], v3 offset:29184
    v_exp_f32 v183, -v183
    v_fma_f32 v180, v180, s0, s0
    v_fma_f32 v181, v181, s0, s0
    v_fma_f32 v182, v182, s0, s0
    v_mfma_f32_32x32x16_bf16 v[192:207], a[104:107], v[136:139], v[192:207]
    ds_read_b64_tr_b16 a[88:89], v4 offset:28672
    ds_read_b64_tr_b16 a[90:91], v4 offset:29184
    buffer_load_dwordx4 v8, s[12:15], s69 offen offset:0 lds
    v_fma_f32 v183, v183, s0, s0
    v_rcp_f32 v180, v180
    v_mfma_f32_32x32x16_bf16 v[192:207], a[108:111], v[140:143], v[192:207]
    ds_read_b64_tr_b16 a[92:93], v5 offset:28672
    ds_read_b64_tr_b16 a[94:95], v5 offset:29184
    v_rcp_f32 v181, v181
    v_rcp_f32 v182, v182
    s_waitcnt lgkmcnt(8)
    v_mfma_f32_32x32x16_bf16 v[144:159], a[64:67], v[32:35], 0
    ds_read_b64_tr_b16 a[96:97], v24 offset:0
    ds_read_b64_tr_b16 a[98:99], v24 offset:512
    buffer_load_dwordx4 v9, s[12:15], s69 offen offset:1024 lds
    v_rcp_f32 v183, v183
    v_mul_f32 v188, v180, v188
    v_mfma_f32_32x32x16_bf16 v[160:175], a[68:71], v[32:35], 0
    ds_read_b64_tr_b16 a[100:101], v25 offset:0
    ds_read_b64_tr_b16 a[102:103], v25 offset:512
    v_mul_f32 v189, v181, v189
    v_mul_f32 v190, v182, v190
    v_mul_f32 v191, v183, v191
    v_cvt_pk_bf16_f32 v234, v188, v189
    v_cvt_pk_bf16_f32 v235, v190, v191
    v_mfma_f32_32x32x16_bf16 v[176:191], a[72:75], v[32:35], 0
    ds_read_b64_tr_b16 a[104:105], v26 offset:0
    ds_read_b64_tr_b16 a[106:107], v26 offset:512
    buffer_load_dwordx4 v10, s[16:19], s69 offen offset:2048 lds
    v_mul_f32 v200, v192, v200
    v_mul_f32 v201, v193, v201
    v_mfma_f32_32x32x16_bf16 v[208:223], a[76:79], v[32:35], 0
    ds_read_b64_tr_b16 a[108:109], v27 offset:0
    ds_read_b64_tr_b16 a[110:111], v27 offset:512
    v_mul_f32 v202, v194, v202
    v_mul_f32 v203, v195, v203
    s_waitcnt lgkmcnt(8)
    v_mfma_f32_32x32x16_bf16 v[144:159], a[80:83], v[36:39], v[144:159]
    ds_read_b64_tr_b16 a[64:65], v24 offset:28672
    ds_read_b64_tr_b16 a[66:67], v24 offset:29184
    buffer_load_dwordx4 v11, s[16:19], s69 offen offset:3072 lds
    s_add_u32 m0, s80, 16384
    v_mfma_f32_32x32x16_bf16 v[160:175], a[84:87], v[36:39], v[160:175]
    ds_read_b64_tr_b16 a[68:69], v25 offset:28672
    ds_read_b64_tr_b16 a[70:71], v25 offset:29184
    v_exp_f32 v192, -v192
    v_exp_f32 v193, -v193
    v_mfma_f32_32x32x16_bf16 v[176:191], a[88:91], v[36:39], v[176:191]
    ds_read_b64_tr_b16 a[72:73], v26 offset:28672
    ds_read_b64_tr_b16 a[74:75], v26 offset:29184
    buffer_load_dwordx4 v8, s[12:15], s70 offen offset:0 lds
    v_exp_f32 v194, -v194
    v_mfma_f32_32x32x16_bf16 v[208:223], a[92:95], v[36:39], v[208:223]
    ds_read_b64_tr_b16 a[76:77], v27 offset:28672
    ds_read_b64_tr_b16 a[78:79], v27 offset:29184
    v_exp_f32 v195, -v195
    s_waitcnt lgkmcnt(8) vmcnt(17)
    v_mfma_f32_32x32x16_bf16 v[144:159], a[96:99], v[40:43], v[144:159]
    ds_read_b64_tr_b16 a[80:81], v2 offset:4096
    ds_read_b64_tr_b16 a[82:83], v2 offset:4608
    buffer_load_dwordx4 v9, s[12:15], s70 offen offset:1024 lds
    v_fma_f32 v192, v192, s0, s0
    v_fma_f32 v193, v193, s0, s0
    v_mfma_f32_32x32x16_bf16 v[160:175], a[100:103], v[40:43], v[160:175]
    ds_read_b64_tr_b16 a[84:85], v3 offset:4096
    ds_read_b64_tr_b16 a[86:87], v3 offset:4608
    v_fma_f32 v194, v194, s0, s0
    v_fma_f32 v195, v195, s0, s0
    v_rcp_f32 v192, v192
    v_mfma_f32_32x32x16_bf16 v[176:191], a[104:107], v[40:43], v[176:191]
    ds_read_b64_tr_b16 a[88:89], v4 offset:4096
    ds_read_b64_tr_b16 a[90:91], v4 offset:4608
    buffer_store_dwordx4 v[232:235], v1, s[24:27], s81 offen offset:2048 sc1
    v_rcp_f32 v193, v193
    v_mfma_f32_32x32x16_bf16 v[208:223], a[108:111], v[40:43], v[208:223]
    ds_read_b64_tr_b16 a[92:93], v5 offset:4096
    ds_read_b64_tr_b16 a[94:95], v5 offset:4608
    v_rcp_f32 v194, v194
    s_waitcnt lgkmcnt(8)
    v_mfma_f32_32x32x16_bf16 v[144:159], a[64:67], v[44:47], v[144:159]
    ds_read_b64_tr_b16 a[96:97], v2 offset:32768
    ds_read_b64_tr_b16 a[98:99], v2 offset:33280
    buffer_load_dwordx4 v10, s[16:19], s70 offen offset:2048 lds
    v_rcp_f32 v195, v195
    v_mfma_f32_32x32x16_bf16 v[160:175], a[68:71], v[44:47], v[160:175]
    ds_read_b64_tr_b16 a[100:101], v3 offset:32768
    ds_read_b64_tr_b16 a[102:103], v3 offset:33280
    v_mul_f32 v200, v192, v200
    v_mul_f32 v201, v193, v201
    v_mul_f32 v202, v194, v202
    v_mul_f32 v203, v195, v203
    v_mfma_f32_32x32x16_bf16 v[176:191], a[72:75], v[44:47], v[176:191]
    ds_read_b64_tr_b16 a[104:105], v4 offset:32768
    ds_read_b64_tr_b16 a[106:107], v4 offset:33280
    buffer_load_dwordx4 v11, s[16:19], s70 offen offset:3072 lds
    s_add_u32 m0, s80, 20480
    ds_read_b64_tr_b16 a[16:17], v6 offset:32768
    ds_read_b64_tr_b16 a[18:19], v6 offset:33792
    v_mfma_f32_32x32x16_bf16 v[208:223], a[76:79], v[44:47], v[208:223]
    ds_read_b64_tr_b16 a[108:109], v5 offset:32768
    ds_read_b64_tr_b16 a[110:111], v5 offset:33280
    ds_read_b64_tr_b16 a[20:21], v7 offset:32768
    ds_read_b64_tr_b16 a[22:23], v7 offset:33792
    s_waitcnt lgkmcnt(12) vmcnt(19)
    v_mfma_f32_32x32x16_bf16 v[144:159], a[80:83], v[48:51], v[144:159]
    ds_read_b64_tr_b16 a[64:65], v24 offset:4096
    ds_read_b64_tr_b16 a[66:67], v24 offset:4608
    buffer_load_dwordx4 v8, s[12:15], s71 offen offset:0 lds
    v_cvt_pk_bf16_f32 v236, v200, v201
    v_cvt_pk_bf16_f32 v237, v202, v203
    v_mfma_f32_32x32x16_bf16 v[160:175], a[84:87], v[48:51], v[160:175]
    ds_read_b64_tr_b16 a[68:69], v25 offset:4096
    ds_read_b64_tr_b16 a[70:71], v25 offset:4608
    v_mul_f32 v204, v196, v204
    v_mul_f32 v205, v197, v205
    v_mul_f32 v206, v198, v206
    v_mul_f32 v207, v199, v207
    v_mfma_f32_32x32x16_bf16 v[176:191], a[88:91], v[48:51], v[176:191]
    ds_read_b64_tr_b16 a[72:73], v26 offset:4096
    ds_read_b64_tr_b16 a[74:75], v26 offset:4608
    buffer_load_dwordx4 v9, s[12:15], s71 offen offset:1024 lds
    v_exp_f32 v196, -v196
    v_mfma_f32_32x32x16_bf16 v[208:223], a[92:95], v[48:51], v[208:223]
    ds_read_b64_tr_b16 a[76:77], v27 offset:4096
    ds_read_b64_tr_b16 a[78:79], v27 offset:4608
    v_exp_f32 v197, -v197
    s_waitcnt lgkmcnt(10)
    v_mfma_f32_32x32x16_bf16 v[144:159], a[96:99], v[52:55], v[144:159]
    ds_read_b64_tr_b16 a[80:81], v24 offset:32768
    ds_read_b64_tr_b16 a[82:83], v24 offset:33280
    buffer_load_dwordx4 v10, s[16:19], s71 offen offset:2048 lds
    v_exp_f32 v198, -v198
    v_mfma_f32_32x32x16_bf16 v[160:175], a[100:103], v[52:55], v[160:175]
    ds_read_b64_tr_b16 a[84:85], v25 offset:32768
    ds_read_b64_tr_b16 a[86:87], v25 offset:33280
    v_exp_f32 v199, -v199
    v_fma_f32 v196, v196, s0, s0
    v_fma_f32 v197, v197, s0, s0
    v_mfma_f32_32x32x16_bf16 v[176:191], a[104:107], v[52:55], v[176:191]
    ds_read_b64_tr_b16 a[88:89], v26 offset:32768
    ds_read_b64_tr_b16 a[90:91], v26 offset:33280
    buffer_load_dwordx4 v11, s[16:19], s71 offen offset:3072 lds
    s_add_u32 m0, s80, 24576
    ds_read_b64_tr_b16 a[24:25], v6 offset:34816
    ds_read_b64_tr_b16 a[26:27], v6 offset:35840
    v_mfma_f32_32x32x16_bf16 v[208:223], a[108:111], v[52:55], v[208:223]
    ds_read_b64_tr_b16 a[92:93], v27 offset:32768
    ds_read_b64_tr_b16 a[94:95], v27 offset:33280
    ds_read_b64_tr_b16 a[28:29], v7 offset:34816
    ds_read_b64_tr_b16 a[30:31], v7 offset:35840
    s_waitcnt lgkmcnt(12) vmcnt(20)
    v_mfma_f32_32x32x16_bf16 v[144:159], a[64:67], v[56:59], v[144:159]
    ds_read_b64_tr_b16 a[96:97], v2 offset:8192
    ds_read_b64_tr_b16 a[98:99], v2 offset:8704
    buffer_load_dwordx4 v8, s[12:15], s72 offen offset:0 lds
    v_fma_f32 v198, v198, s0, s0
    v_fma_f32 v199, v199, s0, s0
    v_mfma_f32_32x32x16_bf16 v[160:175], a[68:71], v[56:59], v[160:175]
    ds_read_b64_tr_b16 a[100:101], v3 offset:8192
    ds_read_b64_tr_b16 a[102:103], v3 offset:8704
    v_rcp_f32 v196, v196
    v_rcp_f32 v197, v197
    v_mfma_f32_32x32x16_bf16 v[176:191], a[72:75], v[56:59], v[176:191]
    ds_read_b64_tr_b16 a[104:105], v4 offset:8192
    ds_read_b64_tr_b16 a[106:107], v4 offset:8704
    buffer_load_dwordx4 v9, s[12:15], s72 offen offset:1024 lds
    v_rcp_f32 v198, v198
    v_mfma_f32_32x32x16_bf16 v[208:223], a[76:79], v[56:59], v[208:223]
    ds_read_b64_tr_b16 a[108:109], v5 offset:8192
    ds_read_b64_tr_b16 a[110:111], v5 offset:8704
    v_rcp_f32 v199, v199
    s_waitcnt lgkmcnt(10) vmcnt(20)
    v_mfma_f32_32x32x16_bf16 v[144:159], a[80:83], v[60:63], v[144:159]
    ds_read_b64_tr_b16 a[64:65], v2 offset:36864
    ds_read_b64_tr_b16 a[66:67], v2 offset:37376
    buffer_load_dwordx4 v10, s[16:19], s72 offen offset:2048 lds
    v_mul_f32 v204, v196, v204
    v_mul_f32 v205, v197, v205
    v_mfma_f32_32x32x16_bf16 v[160:175], a[84:87], v[60:63], v[160:175]
    ds_read_b64_tr_b16 a[68:69], v3 offset:36864
    ds_read_b64_tr_b16 a[70:71], v3 offset:37376
    v_mul_f32 v206, v198, v206
    v_mul_f32 v207, v199, v207
    v_cvt_pk_bf16_f32 v238, v204, v205
    v_cvt_pk_bf16_f32 v239, v206, v207
    v_mfma_f32_32x32x16_bf16 v[176:191], a[88:91], v[60:63], v[176:191]
    ds_read_b64_tr_b16 a[72:73], v4 offset:36864
    ds_read_b64_tr_b16 a[74:75], v4 offset:37376
    buffer_load_dwordx4 v11, s[16:19], s72 offen offset:3072 lds
    ds_read_b64_tr_b16 a[32:33], v6 offset:2048
    ds_read_b64_tr_b16 a[34:35], v6 offset:3072
    v_mfma_f32_32x32x16_bf16 v[208:223], a[92:95], v[60:63], v[208:223]
    ds_read_b64_tr_b16 a[76:77], v5 offset:36864
    ds_read_b64_tr_b16 a[78:79], v5 offset:37376
    ds_read_b64_tr_b16 a[36:37], v7 offset:2048
    ds_read_b64_tr_b16 a[38:39], v7 offset:3072
    s_mov_b64 s[76:77], 0
    s_buffer_load_dwordx2 s[76:77], s[24:27], s74 offset:0
    s_waitcnt lgkmcnt(12) vmcnt(20)
    s_branch L_overG4
    .p2align 12
L_padG4:
    s_branch L_retGa
L_overG4:
    v_mfma_f32_32x32x16_bf16 v[144:159], a[96:99], v[64:67], v[144:159]
    ds_read_b64_tr_b16 a[80:81], v24 offset:8192
    ds_read_b64_tr_b16 a[82:83], v24 offset:8704
    buffer_store_dwordx4 v[236:239], v1, s[24:27], s81 offen offset:3072 sc1
    s_add_u32 s81, s81, 4096
    ds_read_b64_tr_b16 a[40:41], v6 offset:16384
    ds_read_b64_tr_b16 a[42:43], v6 offset:17408
    v_mfma_f32_32x32x16_bf16 v[160:175], a[100:103], v[64:67], v[160:175]
    ds_read_b64_tr_b16 a[84:85], v25 offset:8192
    ds_read_b64_tr_b16 a[86:87], v25 offset:8704
    ds_read_b64_tr_b16 a[44:45], v7 offset:16384
    ds_read_b64_tr_b16 a[46:47], v7 offset:17408
    s_mov_b32 s12, s28
    s_mov_b32 s13, s29
    v_mfma_f32_32x32x16_bf16 v[176:191], a[104:107], v[64:67], v[176:191]
    ds_read_b64_tr_b16 a[88:89], v26 offset:8192
    ds_read_b64_tr_b16 a[90:91], v26 offset:8704
    ds_read_b64_tr_b16 a[48:49], v6 offset:18432
    ds_read_b64_tr_b16 a[50:51], v6 offset:19456
    s_mov_b32 s14, 401408
    s_mov_b32 s16, s30
    v_mfma_f32_32x32x16_bf16 v[208:223], a[108:111], v[64:67], v[208:223]
    ds_read_b64_tr_b16 a[92:93], v27 offset:8192
    ds_read_b64_tr_b16 a[94:95], v27 offset:8704
    ds_read_b64_tr_b16 a[52:53], v7 offset:18432
    ds_read_b64_tr_b16 a[54:55], v7 offset:19456
    s_waitcnt lgkmcnt(15) vmcnt(19)
    v_mfma_f32_32x32x16_bf16 v[144:159], a[64:67], v[68:71], v[144:159]
    ds_read_b64_tr_b16 a[96:97], v24 offset:36864
    ds_read_b64_tr_b16 a[98:99], v24 offset:37376
    ds_read_b64_tr_b16 a[56:57], v6 offset:0
    ds_read_b64_tr_b16 a[58:59], v6 offset:1024
    s_mov_b32 s17, s31
    s_mov_b32 s18, 1835008
    v_mfma_f32_32x32x16_bf16 v[160:175], a[68:71], v[68:71], v[160:175]
    ds_read_b64_tr_b16 a[100:101], v25 offset:36864
    ds_read_b64_tr_b16 a[102:103], v25 offset:37376
    ds_read_b64_tr_b16 a[60:61], v7 offset:0
    ds_read_b64_tr_b16 a[62:63], v7 offset:1024
    s_lshr_b32 s69, s99, 12
    s_mul_i32 s75, s69, 100352
    v_mfma_f32_32x32x16_bf16 v[176:191], a[72:75], v[68:71], v[176:191]
    ds_read_b64_tr_b16 a[104:105], v26 offset:36864
    ds_read_b64_tr_b16 a[106:107], v26 offset:37376
    s_lshl_b32 s70, s101, 7
    s_add_u32 s75, s75, s70
    s_and_b32 s71, s69, 1
    s_lshr_b32 s72, s69, 1
    v_mfma_f32_32x32x16_bf16 v[208:223], a[76:79], v[68:71], v[208:223]
    ds_read_b64_tr_b16 a[108:109], v27 offset:36864
    ds_read_b64_tr_b16 a[110:111], v27 offset:37376
    s_and_b32 vcc_hi, s76, s77
    s_andn2_b32 vcc_hi, s90, vcc_hi
    s_cbranch_scc1 L_slow_kvG
L_back_kvG:
    s_waitcnt lgkmcnt(14)
    v_mfma_f32_32x32x16_bf16 v[144:159], a[80:83], v[72:75], v[144:159]
    s_lshl2_add_u32 s66, s100, s72
    s_lshl1_add_u32 s66, s71, s66
    s_lshl_b32 s66, s66, 14
    s_add_u32 s66, s66, 14680064
    s_lshl4_add_u32 s68, s72, s71
    s_lshl_b32 s68, 0x5555, s68
    s_lshl2_add_u32 s72, s100, s69
    v_mfma_f32_32x32x16_bf16 v[160:175], a[84:87], v[72:75], v[160:175]
    s_waitcnt vmcnt(9) lgkmcnt(0)
    s_barrier
    ds_read_b64_tr_b16 a[64:65], v2 offset:12288
    ds_read_b64_tr_b16 a[66:67], v2 offset:12800
    s_lshr_b32 s1, s99, 1
    s_add_u32 m0, s1, 0
    s_nop 0
    buffer_load_dwordx4 v30, s[24:27], s85 offen sc1 lds
    v_mfma_f32_32x32x16_bf16 v[176:191], a[88:91], v[72:75], v[176:191]
    ds_read_b64_tr_b16 a[68:69], v2 offset:40960
    ds_read_b64_tr_b16 a[70:71], v2 offset:41472
    ds_read_b64_tr_b16 a[72:73], v24 offset:12288
    s_mul_i32 s67, s72, 14336
    s_add_u32 s67, s67, s70
    s_lshl_b32 s100, s100, 7
    v_lshrrev_b32 v207, 5, v0
    v_mfma_f32_32x32x16_bf16 v[208:223], a[92:95], v[72:75], v[208:223]
    ds_read_b64_tr_b16 a[74:75], v24 offset:12800
    ds_read_b64_tr_b16 a[76:77], v24 offset:40960
    ds_read_b64_tr_b16 a[78:79], v24 offset:41472
    buffer_load_dwordx4 v31, s[24:27], s85 offen offset:1024 sc1 lds
    s_add_u32 m0, s1, 8192
    v_mfma_f32_32x32x16_bf16 v[144:159], a[96:99], v[76:79], v[144:159]
    ds_read_b64_tr_b16 a[80:81], v2 offset:16384
    ds_read_b64_tr_b16 a[82:83], v2 offset:16896
    s_bitcmp1_b32 s53, 0
    s_cselect_b32 s61, 0, 1544
    s_lshr_b32 s60, s99, 1
    s_add_u32 s60, s60, 24576
    s_add_u32 s61, s60, s61
    v_mfma_f32_32x32x16_bf16 v[160:175], a[100:103], v[76:79], v[160:175]
    ds_read_b64_tr_b16 a[84:85], v2 offset:45056
    ds_read_b64_tr_b16 a[86:87], v2 offset:45568
    buffer_load_dwordx4 v12, s[24:27], s86 offen sc1 lds
    v_and_b32 v9, 0x1f0, v1
    v_add_u32 v9, s61, v9
    v_lshrrev_b32 v18, 5, v0
    v_mfma_f32_32x32x16_bf16 v[176:191], a[104:107], v[76:79], v[176:191]
    ds_read_b64_tr_b16 a[88:89], v24 offset:16384
    ds_read_b64_tr_b16 a[90:91], v24 offset:16896
    v_lshl_add_u32 v8, v18, 13, v9
    v_add_u32 v9, 16384, v9
    v_add_u32 v18, s52, v18
    v_mad_u32_u24 v207, v207, 36, 32
    v_sub_u32 v207, v207, v0
    v_mfma_f32_32x32x16_bf16 v[208:223], a[108:111], v[76:79], v[208:223]
    ds_read_b64_tr_b16 a[92:93], v24 offset:45056
    ds_read_b64_tr_b16 a[94:95], v24 offset:45568
    buffer_load_dwordx4 v13, s[24:27], s86 offen offset:1024 sc1 lds
    s_add_u32 m0, s1, 16384
    v_mul_u32_u24 v207, 0x10001, v207
    s_waitcnt lgkmcnt(8)
    v_mfma_f32_32x32x16_bf16 v[144:159], a[64:67], v[80:83], v[144:159]
    v_cmp_le_u32 vcc, 2, v18
    v_mov_b32 v11, 0x3f803f80
    s_nop 0
    v_cndmask_b32 v10, 0, v11, vcc
    v_bfe_u32 v7, v0, 1, 1
    v_bfe_u32 v18, v0, 4, 1
    v_lshl_add_u32 v7, v18, 1, v7
    v_mfma_f32_32x32x16_bf16 v[144:159], a[68:71], v[84:87], v[144:159]
    s_waitcnt vmcnt(5) lgkmcnt(0)
    s_barrier
    ds_read_b64_tr_b16 a[96:97], v2 offset:20480
    ds_read_b64_tr_b16 a[98:99], v2 offset:20992
    buffer_load_dwordx4 v22, s[24:27], s87 offen sc1 lds
    v_mfma_f32_32x32x16_bf16 v[144:159], a[72:75], v[88:91], v[144:159]
    ds_read_b64_tr_b16 a[100:101], v2 offset:49152
    ds_read_b64_tr_b16 a[102:103], v2 offset:49664
    ds_read_b64_tr_b16 a[104:105], v24 offset:20480
    v_bfe_u32 v6, v0, 2, 2
    v_lshrrev_b32 v18, 5, v0
    v_lshl_add_u32 v6, v18, 2, v6
    v_lshlrev_b32 v18, 2, v7
    v_mfma_f32_32x32x16_bf16 v[144:159], a[76:79], v[92:95], v[144:159]
    ds_read_b64_tr_b16 a[106:107], v24 offset:20992
    ds_read_b64_tr_b16 a[108:109], v24 offset:49152
    ds_read_b64_tr_b16 a[110:111], v24 offset:49664
    buffer_load_dwordx4 v23, s[24:27], s87 offen offset:1024 sc1 lds
    s_add_u32 m0, s1, 24576
    s_mov_b32 s78, 0
    s_buffer_load_dword s78, s[24:27], s73 offset:2048
    v_mfma_f32_32x32x16_bf16 v[144:159], a[80:83], v[96:99], v[144:159]
    ds_read_b64_tr_b16 a[64:65], v2 offset:24576
    ds_read_b64_tr_b16 a[66:67], v2 offset:25088
    v_xor_b32 v6, v6, v18
    v_lshlrev_b32 v6, 4, v6
    v_lshl_add_u32 v6, v7, 9, v6
    v_and_b32 v18, 1, v0
    v_lshl_add_u32 v6, v18, 3, v6
    v_mfma_f32_32x32x16_bf16 v[144:159], a[84:87], v[100:103], v[144:159]
    ds_read_b64_tr_b16 a[68:69], v2 offset:53248
    ds_read_b64_tr_b16 a[70:71], v2 offset:53760
    buffer_load_dwordx4 v22, s[24:27], s88 offen sc1 lds
    v_add_u32 v6, s60, v6
    v_xor_b32 v7, 128, v6
    s_and_b32 s60, s55, 1
    v_mfma_f32_32x32x16_bf16 v[144:159], a[88:91], v[104:107], v[144:159]
    ds_read_b64_tr_b16 a[72:73], v24 offset:24576
    ds_read_b64_tr_b16 a[74:75], v24 offset:25088
    s_mul_i32 s61, s60, 114688
    v_add_u32 v18, s61, v1
    s_sub_u32 s61, 114688, s61
    v_add_u32 v19, s61, v1
    v_add_u32 v207, -1, v207
    v_mfma_f32_32x32x16_bf16 v[144:159], a[92:95], v[108:111], v[144:159]
    ds_read_b64_tr_b16 a[76:77], v24 offset:53248
    ds_read_b64_tr_b16 a[78:79], v24 offset:53760
    buffer_load_dwordx4 v23, s[24:27], s88 offen offset:1024 sc1 lds
    s_add_u32 m0, s1, 32768
    v_pk_sub_i16 v200, v207, 32 op_sel_hi:[1,0]
    s_waitcnt lgkmcnt(8)
    v_mfma_f32_32x32x16_bf16 v[144:159], a[96:99], v[112:115], v[144:159]
    ds_read_b64_tr_b16 a[80:81], v3 offset:12288
    ds_read_b64_tr_b16 a[82:83], v3 offset:12800
    v_pk_sub_i16 v201, v207, 30 op_sel_hi:[1,0]
    s_mov_b32 s52, 0xfffe0000
    v_pk_sub_i16 v202, v207, 24 op_sel_hi:[1,0]
    s_mov_b32 s53, 0xffe00000
    v_pk_sub_i16 v203, v207, 22 op_sel_hi:[1,0]
    v_mfma_f32_32x32x16_bf16 v[144:159], a[100:103], v[116:119], v[144:159]
    ds_read_b64_tr_b16 a[84:85], v3 offset:40960
    ds_read_b64_tr_b16 a[86:87], v3 offset:41472
    s_waitcnt vmcnt(8)
    s_buffer_atomic_or s91, s[24:27], s83 offset:4096
    buffer_load_dwordx4 v22, s[24:27], s89 offen sc1 lds
    s_mov_b32 s54, 0xfffc0000
    v_mfma_f32_32x32x16_bf16 v[144:159], a[104:107], v[120:123], v[144:159]
    ds_read_b64_tr_b16 a[88:89], v25 offset:12288
    ds_read_b64_tr_b16 a[90:91], v25 offset:12800
    v_pk_sub_i16 v204, v207, 16 op_sel_hi:[1,0]
    s_mov_b32 s55, 0xffc00000
    v_pk_sub_i16 v205, v207, 14 op_sel_hi:[1,0]
    s_mov_b32 s56, 0xfff80000
    v_pk_sub_i16 v206, v207, 8 op_sel_hi:[1,0]
    v_mfma_f32_32x32x16_bf16 v[144:159], a[108:111], v[124:127], v[144:159]
    ds_read_b64_tr_b16 a[92:93], v25 offset:40960
    ds_read_b64_tr_b16 a[94:95], v25 offset:41472
    buffer_load_dwordx4 v23, s[24:27], s89 offen offset:1024 sc1 lds
    s_add_u32 m0, s1, 40960
    s_add_u32 s88, s87, 28672
    s_waitcnt lgkmcnt(8)
    v_mfma_f32_32x32x16_bf16 v[144:159], a[64:67], v[128:131], v[144:159]
    ds_read_b64_tr_b16 a[96:97], v3 offset:16384
    ds_read_b64_tr_b16 a[98:99], v3 offset:16896
    s_mov_b32 s57, 0xff800000
    v_pk_sub_i16 v207, v207, 6 op_sel_hi:[1,0]
    s_mov_b32 s58, 0xff000000
    v_pk_ashrrev_i16 v200, 15, v200 op_sel_hi:[0,1]
    s_mov_b32 s59, 0xf0000000
    v_mfma_f32_32x32x16_bf16 v[144:159], a[68:71], v[132:135], v[144:159]
    ds_read_b64_tr_b16 a[100:101], v3 offset:45056
    ds_read_b64_tr_b16 a[102:103], v3 offset:45568
    buffer_load_dwordx4 v22, s[24:27], s88 offen sc1 lds
    v_pk_ashrrev_i16 v201, 15, v201 op_sel_hi:[0,1]
    s_mov_b32 s60, 0xfe000000
    v_pk_ashrrev_i16 v202, 15, v202 op_sel_hi:[0,1]
    v_mfma_f32_32x32x16_bf16 v[144:159], a[72:75], v[136:139], v[144:159]
    ds_read_b64_tr_b16 a[104:105], v25 offset:16384
    ds_read_b64_tr_b16 a[106:107], v25 offset:16896
    s_mov_b32 s61, 0xe0000000
    v_pk_ashrrev_i16 v203, 15, v203 op_sel_hi:[0,1]
    s_mov_b32 s62, 0xfc000000
    v_pk_ashrrev_i16 v204, 15, v204 op_sel_hi:[0,1]
    s_mov_b32 s63, 0xc0000000
    v_mfma_f32_32x32x16_bf16 v[144:159], a[76:79], v[140:143], v[144:159]
    ds_read_b64_tr_b16 a[108:109], v25 offset:45056
    ds_read_b64_tr_b16 a[110:111], v25 offset:45568
    buffer_load_dwordx4 v23, s[24:27], s88 offen offset:1024 sc1 lds
    s_add_u32 m0, s80, 0
    v_add_u32 v22, s1, v22
    v_add_u32 v23, s1, v23
    s_waitcnt lgkmcnt(8)
    v_mfma_f32_32x32x16_bf16 v[160:175], a[80:83], v[80:83], v[160:175]
    ds_read_b64_tr_b16 a[64:65], v3 offset:20480
    ds_read_b64_tr_b16 a[66:67], v3 offset:20992
    s_andn2_b32 vcc_hi, s96, s78
    s_cbranch_scc1 L_slow_qG
L_back_qG:
    s_sub_u32 s1, s87, 28672
    v_pk_ashrrev_i16 v205, 15, v205 op_sel_hi:[0,1]
    s_mov_b32 s64, 0xf8000000
    v_mfma_f32_32x32x16_bf16 v[160:175], a[84:87], v[84:87], v[160:175]
    ds_read_b64_tr_b16 a[68:69], v3 offset:49152
    ds_read_b64_tr_b16 a[70:71], v3 offset:49664
    buffer_load_dwordx4 v[192:195], v1, s[24:27], s1 offen offset:0 sc1
    v_pk_ashrrev_i16 v206, 15, v206 op_sel_hi:[0,1]
    s_mov_b32 s65, 0x80000000
    v_pk_ashrrev_i16 v207, 15, v207 op_sel_hi:[0,1]
    v_mfma_f32_32x32x16_bf16 v[160:175], a[88:91], v[88:91], v[160:175]
    ds_read_b64_tr_b16 a[72:73], v25 offset:20480
    ds_read_b64_tr_b16 a[74:75], v25 offset:20992
    v_mul_f32 v152, v144, v152
    v_mul_f32 v153, v145, v153
    v_mul_f32 v154, v146, v154
    v_mul_f32 v155, v147, v155
    v_mfma_f32_32x32x16_bf16 v[160:175], a[92:95], v[92:95], v[160:175]
    ds_read_b64_tr_b16 a[76:77], v25 offset:49152
    ds_read_b64_tr_b16 a[78:79], v25 offset:49664
    buffer_load_dwordx4 v[196:199], v1, s[24:27], s1 offen offset:1024 sc1
    s_add_u32 s84, s84, 4294909952
    s_waitcnt lgkmcnt(8)
    v_mfma_f32_32x32x16_bf16 v[160:175], a[96:99], v[96:99], v[160:175]
    ds_read_b64_tr_b16 a[80:81], v3 offset:24576
    ds_read_b64_tr_b16 a[82:83], v3 offset:25088
    v_exp_f32 v144, -v144
    v_exp_f32 v145, -v145
    v_mfma_f32_32x32x16_bf16 v[160:175], a[100:103], v[100:103], v[160:175]
    ds_read_b64_tr_b16 a[84:85], v3 offset:53248
    ds_read_b64_tr_b16 a[86:87], v3 offset:53760
    buffer_load_dwordx4 v16, s[20:23], s84 offen lds
    v_exp_f32 v146, -v146
    v_mfma_f32_32x32x16_bf16 v[160:175], a[104:107], v[104:107], v[160:175]
    ds_read_b64_tr_b16 a[88:89], v25 offset:24576
    ds_read_b64_tr_b16 a[90:91], v25 offset:25088
    v_exp_f32 v147, -v147
    v_fma_f32 v144, v144, s0, s0
    v_fma_f32 v145, v145, s0, s0
    v_fma_f32 v146, v146, s0, s0
    v_mfma_f32_32x32x16_bf16 v[160:175], a[108:111], v[108:111], v[160:175]
    ds_read_b64_tr_b16 a[92:93], v25 offset:53248
    ds_read_b64_tr_b16 a[94:95], v25 offset:53760
    buffer_load_dwordx4 v17, s[20:23], s84 offen offset:1024 lds
    s_add_u32 m0, s80, 2048
    s_add_u32 s84, s84, 114688
    v_fma_f32 v147, v147, s0, s0
    s_waitcnt lgkmcnt(8)
    v_mfma_f32_32x32x16_bf16 v[160:175], a[64:67], v[112:115], v[160:175]
    ds_read_b64_tr_b16 a[96:97], v4 offset:12288
    ds_read_b64_tr_b16 a[98:99], v4 offset:12800
    v_rcp_f32 v144, v144
    v_rcp_f32 v145, v145
    v_mfma_f32_32x32x16_bf16 v[160:175], a[68:71], v[116:119], v[160:175]
    ds_read_b64_tr_b16 a[100:101], v4 offset:40960
    ds_read_b64_tr_b16 a[102:103], v4 offset:41472
    buffer_load_dwordx4 v16, s[20:23], s84 offen lds
    v_rcp_f32 v146, v146
    v_mfma_f32_32x32x16_bf16 v[160:175], a[72:75], v[120:123], v[160:175]
    ds_read_b64_tr_b16 a[104:105], v26 offset:12288
    ds_read_b64_tr_b16 a[106:107], v26 offset:12800
    v_rcp_f32 v147, v147
    v_mul_f32 v152, v144, v152
    v_mul_f32 v153, v145, v153
    v_mul_f32 v154, v146, v154
    v_mfma_f32_32x32x16_bf16 v[160:175], a[76:79], v[124:127], v[160:175]
    ds_read_b64_tr_b16 a[108:109], v26 offset:40960
    ds_read_b64_tr_b16 a[110:111], v26 offset:41472
    buffer_load_dwordx4 v17, s[20:23], s84 offen offset:1024 lds
    s_add_u32 m0, s80, 4096
    s_add_u32 s84, s84, 114688
    v_mul_f32 v155, v147, v155
    s_waitcnt lgkmcnt(8)
    v_mfma_f32_32x32x16_bf16 v[160:175], a[80:83], v[128:131], v[160:175]
    ds_read_b64_tr_b16 a[64:65], v4 offset:16384
    ds_read_b64_tr_b16 a[66:67], v4 offset:16896
    v_cvt_pk_bf16_f32 v144, v152, v153
    v_cvt_pk_bf16_f32 v145, v154, v155
    v_mul_f32 v156, v148, v156
    v_mul_f32 v157, v149, v157
    v_mul_f32 v158, v150, v158
    v_mul_f32 v159, v151, v159
    v_mfma_f32_32x32x16_bf16 v[160:175], a[84:87], v[132:135], v[160:175]
    ds_read_b64_tr_b16 a[68:69], v4 offset:45056
    ds_read_b64_tr_b16 a[70:71], v4 offset:45568
    buffer_load_dwordx4 v16, s[20:23], s84 offen lds
    v_exp_f32 v148, -v148
    v_exp_f32 v149, -v149
    v_mfma_f32_32x32x16_bf16 v[160:175], a[88:91], v[136:139], v[160:175]
    ds_read_b64_tr_b16 a[72:73], v26 offset:16384
    ds_read_b64_tr_b16 a[74:75], v26 offset:16896
    v_exp_f32 v150, -v150
    v_exp_f32 v151, -v151
    v_fma_f32 v148, v148, s0, s0
    v_fma_f32 v149, v149, s0, s0
    v_mfma_f32_32x32x16_bf16 v[160:175], a[92:95], v[140:143], v[160:175]
    ds_read_b64_tr_b16 a[76:77], v26 offset:45056
    ds_read_b64_tr_b16 a[78:79], v26 offset:45568
    buffer_load_dwordx4 v17, s[20:23], s84 offen offset:1024 lds
    s_add_u32 m0, s80, 6144
    s_add_u32 s84, s84, 114688
    v_fma_f32 v150, v150, s0, s0
    s_waitcnt lgkmcnt(8)
    v_mfma_f32_32x32x16_bf16 v[176:191], a[96:99], v[80:83], v[176:191]
    ds_read_b64_tr_b16 a[80:81], v4 offset:20480
    ds_read_b64_tr_b16 a[82:83], v4 offset:20992
    v_fma_f32 v151, v151, s0, s0
    v_rcp_f32 v148, v148
    v_rcp_f32 v149, v149
    v_mfma_f32_32x32x16_bf16 v[176:191], a[100:103], v[84:87], v[176:191]
    ds_read_b64_tr_b16 a[84:85], v4 offset:49152
    ds_read_b64_tr_b16 a[86:87], v4 offset:49664
    buffer_load_dwordx4 v16, s[20:23], s84 offen lds
    v_rcp_f32 v150, v150
    v_rcp_f32 v151, v151
    v_mfma_f32_32x32x16_bf16 v[176:191], a[104:107], v[88:91], v[176:191]
    ds_read_b64_tr_b16 a[88:89], v26 offset:20480
    ds_read_b64_tr_b16 a[90:91], v26 offset:20992
    v_mul_f32 v168, v160, v168
    v_mul_f32 v169, v161, v169
    v_mul_f32 v170, v162, v170
    v_mul_f32 v171, v163, v171
    v_exp_f32 v160, -v160
    v_mfma_f32_32x32x16_bf16 v[176:191], a[108:111], v[92:95], v[176:191]
    ds_read_b64_tr_b16 a[92:93], v26 offset:49152
    ds_read_b64_tr_b16 a[94:95], v26 offset:49664
    buffer_load_dwordx4 v17, s[20:23], s84 offen offset:1024 lds
    s_add_u32 m0, s80, 8192
    s_add_u32 s84, s84, 114688
    v_mul_f32 v156, v148, v156
    s_waitcnt lgkmcnt(8)
    v_mfma_f32_32x32x16_bf16 v[176:191], a[64:67], v[96:99], v[176:191]
    ds_read_b64_tr_b16 a[96:97], v4 offset:24576
    ds_read_b64_tr_b16 a[98:99], v4 offset:25088
    v_exp_f32 v161, -v161
    v_exp_f32 v162, -v162
    v_exp_f32 v163, -v163
    v_mfma_f32_32x32x16_bf16 v[176:191], a[68:71], v[100:103], v[176:191]
    ds_read_b64_tr_b16 a[100:101], v4 offset:53248
    ds_read_b64_tr_b16 a[102:103], v4 offset:53760
    buffer_load_dwordx4 v16, s[20:23], s84 offen lds
    v_fma_f32 v160, v160, s0, s0
    v_fma_f32 v161, v161, s0, s0
    v_fma_f32 v162, v162, s0, s0
    v_fma_f32 v163, v163, s0, s0
    v_mfma_f32_32x32x16_bf16 v[176:191], a[72:75], v[104:107], v[176:191]
    ds_read_b64_tr_b16 a[104:105], v26 offset:24576
    ds_read_b64_tr_b16 a[106:107], v26 offset:25088
    v_rcp_f32 v160, v160
    v_rcp_f32 v161, v161
    v_rcp_f32 v162, v162
    v_mfma_f32_32x32x16_bf16 v[176:191], a[76:79], v[108:111], v[176:191]
    ds_read_b64_tr_b16 a[108:109], v26 offset:53248
    ds_read_b64_tr_b16 a[110:111], v26 offset:53760
    buffer_load_dwordx4 v17, s[20:23], s84 offen offset:1024 lds
    s_add_u32 m0, s80, 10240
    s_add_u32 s84, s84, 114688
    v_mul_f32 v157, v149, v157
    s_waitcnt lgkmcnt(8)
    v_mfma_f32_32x32x16_bf16 v[176:191], a[80:83], v[112:115], v[176:191]
    ds_read_b64_tr_b16 a[64:65], v5 offset:12288
    ds_read_b64_tr_b16 a[66:67], v5 offset:12800
    v_rcp_f32 v163, v163
    v_mul_f32 v168, v160, v168
    v_mul_f32 v169, v161, v169
    v_mul_f32 v170, v162, v170
    v_mul_f32 v171, v163, v171
    v_mfma_f32_32x32x16_bf16 v[176:191], a[84:87], v[116:119], v[176:191]
    ds_read_b64_tr_b16 a[68:69], v5 offset:40960
    ds_read_b64_tr_b16 a[70:71], v5 offset:41472
    buffer_load_dwordx4 v16, s[20:23], s84 offen lds
    v_cvt_pk_bf16_f32 v160, v168, v169
    v_cvt_pk_bf16_f32 v161, v170, v171
    v_mul_f32 v172, v164, v172
    v_mul_f32 v173, v165, v173
    v_mfma_f32_32x32x16_bf16 v[176:191], a[88:91], v[120:123], v[176:191]
    ds_read_b64_tr_b16 a[72:73], v27 offset:12288
    ds_read_b64_tr_b16 a[74:75], v27 offset:12800
    v_mul_f32 v174, v166, v174
    v_mul_f32 v175, v167, v175
    v_exp_f32 v164, -v164
    v_mul_f32 v158, v150, v158
    v_mul_f32 v159, v151, v159
    v_mfma_f32_32x32x16_bf16 v[176:191], a[92:95], v[124:127], v[176:191]
    ds_read_b64_tr_b16 a[76:77], v27 offset:40960
    ds_read_b64_tr_b16 a[78:79], v27 offset:41472
    buffer_load_dwordx4 v17, s[20:23], s84 offen offset:1024 lds
    s_mov_b32 s76, 0
    s_buffer_load_dword s76, s[24:27], s100 offset:4096
    v_cvt_pk_bf16_f32 v146, v156, v157
    s_waitcnt lgkmcnt(8)
    v_mfma_f32_32x32x16_bf16 v[176:191], a[96:99], v[128:131], v[176:191]
    ds_read_b64_tr_b16 a[80:81], v5 offset:16384
    ds_read_b64_tr_b16 a[82:83], v5 offset:16896
    v_exp_f32 v165, -v165
    v_cvt_pk_bf16_f32 v147, v158, v159
    v_exp_f32 v166, -v166
    v_mfma_f32_32x32x16_bf16 v[176:191], a[100:103], v[132:135], v[176:191]
    ds_read_b64_tr_b16 a[84:85], v5 offset:45056
    ds_read_b64_tr_b16 a[86:87], v5 offset:45568
    v_exp_f32 v167, -v167
    v_fma_f32 v164, v164, s0, s0
    v_fma_f32 v165, v165, s0, s0
    v_fma_f32 v166, v166, s0, s0
    v_fma_f32 v167, v167, s0, s0
    v_mfma_f32_32x32x16_bf16 v[176:191], a[104:107], v[136:139], v[176:191]
    ds_read_b64_tr_b16 a[88:89], v27 offset:16384
    ds_read_b64_tr_b16 a[90:91], v27 offset:16896
    v_rcp_f32 v164, v164
    v_rcp_f32 v165, v165
    v_rcp_f32 v166, v166
    v_mfma_f32_32x32x16_bf16 v[176:191], a[108:111], v[140:143], v[176:191]
    ds_read_b64_tr_b16 a[92:93], v27 offset:45056
    ds_read_b64_tr_b16 a[94:95], v27 offset:45568
    v_rcp_f32 v167, v167
    v_mul_f32 v172, v164, v172
    v_mul_f32 v173, v165, v173
    v_mul_f32 v174, v166, v174
    s_waitcnt lgkmcnt(8)
    v_mfma_f32_32x32x16_bf16 v[208:223], a[64:67], v[80:83], v[208:223]
    ds_read_b64_tr_b16 a[96:97], v5 offset:20480
    ds_read_b64_tr_b16 a[98:99], v5 offset:20992
    s_waitcnt vmcnt(14)
    ds_write_b32 v8, v10
    ds_write_b32 v9, v11
    buffer_store_dwordx4 v[144:147], v1, s[24:27], s81 offen offset:0 sc1
    v_mfma_f32_32x32x16_bf16 v[208:223], a[68:71], v[84:87], v[208:223]
    ds_read_b64_tr_b16 a[100:101], v5 offset:49152
    ds_read_b64_tr_b16 a[102:103], v5 offset:49664
    v_mul_f32 v175, v167, v175
    v_cvt_pk_bf16_f32 v162, v172, v173
    v_cvt_pk_bf16_f32 v163, v174, v175
    v_mfma_f32_32x32x16_bf16 v[208:223], a[72:75], v[88:91], v[208:223]
    ds_read_b64_tr_b16 a[104:105], v27 offset:20480
    ds_read_b64_tr_b16 a[106:107], v27 offset:20992
    s_andn2_b32 vcc_hi, 0xfffffff, s76
    s_cbranch_scc1 L_slow_haG
L_back_haG:
    buffer_load_dwordx4 v[32:35], v18, s[24:27], s97 offen sc1
    v_mul_f32 v184, v176, v184
    v_mul_f32 v185, v177, v185
    v_mfma_f32_32x32x16_bf16 v[208:223], a[76:79], v[92:95], v[208:223]
    ds_read_b64_tr_b16 a[108:109], v27 offset:49152
    ds_read_b64_tr_b16 a[110:111], v27 offset:49664
    v_mul_f32 v186, v178, v186
    v_mul_f32 v187, v179, v187
    v_exp_f32 v176, -v176
    s_waitcnt lgkmcnt(10)
    v_mfma_f32_32x32x16_bf16 v[208:223], a[80:83], v[96:99], v[208:223]
    ds_read_b64_tr_b16 a[64:65], v5 offset:24576
    ds_read_b64_tr_b16 a[66:67], v5 offset:25088
    buffer_load_dwordx4 v[36:39], v19, s[24:27], s97 offen sc1
    v_exp_f32 v177, -v177
    v_exp_f32 v178, -v178
    v_mfma_f32_32x32x16_bf16 v[208:223], a[84:87], v[100:103], v[208:223]
    ds_read_b64_tr_b16 a[68:69], v5 offset:53248
    ds_read_b64_tr_b16 a[70:71], v5 offset:53760
    v_exp_f32 v179, -v179
    v_fma_f32 v176, v176, s0, s0
    v_fma_f32 v177, v177, s0, s0
    v_fma_f32 v178, v178, s0, s0
    v_fma_f32 v179, v179, s0, s0
    v_mfma_f32_32x32x16_bf16 v[208:223], a[88:91], v[104:107], v[208:223]
    ds_read_b64_tr_b16 a[72:73], v27 offset:24576
    ds_read_b64_tr_b16 a[74:75], v27 offset:25088
    buffer_store_dwordx4 v[160:163], v1, s[24:27], s81 offen offset:1024 sc1
    s_add_u32 s97, s97, 8192
    v_rcp_f32 v176, v176
    v_mfma_f32_32x32x16_bf16 v[208:223], a[92:95], v[108:111], v[208:223]
    ds_read_b64_tr_b16 a[76:77], v27 offset:53248
    ds_read_b64_tr_b16 a[78:79], v27 offset:53760
    v_rcp_f32 v177, v177
    v_rcp_f32 v178, v178
    s_waitcnt lgkmcnt(8)
    v_mfma_f32_32x32x16_bf16 v[208:223], a[96:99], v[112:115], v[208:223]
    buffer_load_dwordx4 v[40:43], v18, s[24:27], s97 offen sc1
    v_rcp_f32 v179, v179
    v_mul_f32 v184, v176, v184
    v_mul_f32 v185, v177, v185
    v_mul_f32 v186, v178, v186
    v_mul_f32 v187, v179, v187
    v_mfma_f32_32x32x16_bf16 v[208:223], a[100:103], v[116:119], v[208:223]
    s_waitcnt lgkmcnt(0)
    s_barrier
    ds_read_b128 a[208:211], v22 offset:0
    ds_read_b128 a[212:215], v23 offset:1024
    ds_read_b128 a[216:219], v22 offset:16384
    ds_read_b128 a[220:223], v23 offset:17408
    v_cvt_pk_bf16_f32 v72, v184, v185
    v_mfma_f32_32x32x16_bf16 v[208:223], a[104:107], v[120:123], v[208:223]
    ds_read_b128 a[80:83], v22 offset:2048
    ds_read_b128 a[84:87], v23 offset:3072
    ds_read_b128 a[88:91], v22 offset:4096
    ds_read_b128 a[92:95], v23 offset:5120
    buffer_load_dwordx4 v[44:47], v19, s[24:27], s97 offen sc1
    s_add_u32 s97, s97, 8192
    v_cvt_pk_bf16_f32 v73, v186, v187
    v_mfma_f32_32x32x16_bf16 v[208:223], a[108:111], v[124:127], v[208:223]
    ds_read_b128 a[240:243], v22 offset:14336
    ds_read_b128 a[244:247], v23 offset:15360
    v_mul_f32 v188, v180, v188
    v_mul_f32 v189, v181, v189
    v_mul_f32 v190, v182, v190
    v_mul_f32 v191, v183, v191
    s_waitcnt vmcnt(18)
    v_mfma_f32_32x32x16_bf16 v[208:223], a[64:67], v[128:131], v[208:223]
    ds_read_b128 a[96:99], v22 offset:10240
    ds_read_b128 a[100:103], v23 offset:11264
    ds_read_b128 a[104:107], v22 offset:12288
    ds_read_b128 a[108:111], v23 offset:13312
    buffer_load_dwordx4 v[48:51], v18, s[24:27], s97 offen sc1
    v_exp_f32 v180, -v180
    v_mfma_f32_32x32x16_bf16 v[208:223], a[68:71], v[132:135], v[208:223]
    v_exp_f32 v181, -v181
    v_exp_f32 v182, -v182
    v_exp_f32 v183, -v183
    v_cndmask_b32 v192, v192, 0, s[92:93]
    v_fma_f32 v180, v180, s0, s0
    v_cndmask_b32 v193, v193, 0, s[92:93]
    v_mfma_f32_32x32x16_bf16 v[208:223], a[72:75], v[136:139], v[208:223]
    buffer_load_dwordx4 v[52:55], v19, s[24:27], s97 offen sc1
    v_fma_f32 v181, v181, s0, s0
    v_cndmask_b32 v198, v198, 0, s[94:95]
    v_fma_f32 v182, v182, s0, s0
    v_cndmask_b32 v199, v199, 0, s[94:95]
    v_fma_f32 v183, v183, s0, s0
    v_rcp_f32 v180, v180
    v_mfma_f32_32x32x16_bf16 v[208:223], a[76:79], v[140:143], v[208:223]
    ds_read_b128 a[64:67], v22 offset:6144
    ds_read_b128 a[68:71], v23 offset:7168
    ds_read_b128 a[72:75], v22 offset:8192
    ds_read_b128 a[76:79], v23 offset:9216
    v_rcp_f32 v181, v181
    v_rcp_f32 v182, v182
    s_waitcnt lgkmcnt(15)
    v_mfma_f32_32x32x16_bf16 v[144:159], a[208:211], v[192:195], 0
    v_rcp_f32 v183, v183
    v_mul_f32 v188, v180, v188
    v_mul_f32 v189, v181, v189
    v_mul_f32 v190, v182, v190
    v_mul_f32 v191, v183, v191
    v_cvt_pk_bf16_f32 v74, v188, v189
    v_cvt_pk_bf16_f32 v75, v190, v191
    v_mfma_f32_32x32x16_bf16 v[144:159], a[212:215], v[196:199], v[144:159]
    ds_read_b64_tr_b16 a[208:209], v6 offset:0
    s_branch L_overG5
    .p2align 12
L_padG5:
    s_branch L_retGb
L_overG5:
    ds_read_b64_tr_b16 a[210:211], v7 offset:0
    ds_read_b64_tr_b16 a[212:213], v6 offset:256
    ds_read_b64_tr_b16 a[214:215], v7 offset:256
    v_mul_f32 v216, v208, v216
    v_mul_f32 v217, v209, v217
    v_mul_f32 v218, v210, v218
    v_mul_f32 v219, v211, v219
    v_exp_f32 v208, -v208
    v_exp_f32 v209, -v209
    v_exp_f32 v210, -v210
    v_exp_f32 v211, -v211
    v_fma_f32 v208, v208, s0, s0
    v_fma_f32 v209, v209, s0, s0
    v_fma_f32 v210, v210, s0, s0
    v_fma_f32 v211, v211, s0, s0
    v_rcp_f32 v208, v208
    s_waitcnt lgkmcnt(15)
    v_mfma_f32_32x32x16_bf16 v[160:175], a[216:219], v[192:195], 0
    v_rcp_f32 v209, v209
    v_rcp_f32 v210, v210
    v_rcp_f32 v211, v211
    v_mul_f32 v216, v208, v216
    v_mul_f32 v217, v209, v217
    v_mul_f32 v218, v210, v218
    v_mul_f32 v219, v211, v219
    v_cvt_pk_bf16_f32 v76, v216, v217
    v_cvt_pk_bf16_f32 v77, v218, v219
    v_mul_f32 v220, v212, v220
    v_mul_f32 v221, v213, v221
    v_mul_f32 v222, v214, v222
    v_mul_f32 v223, v215, v223
    v_exp_f32 v212, -v212
    v_exp_f32 v213, -v213
    v_exp_f32 v214, -v214
    v_mfma_f32_32x32x16_bf16 v[160:175], a[220:223], v[196:199], v[160:175]
    ds_read_b64_tr_b16 a[216:217], v6 offset:16384
    ds_read_b64_tr_b16 a[218:219], v7 offset:16384
    ds_read_b64_tr_b16 a[220:221], v6 offset:16640
    ds_read_b64_tr_b16 a[222:223], v7 offset:16640
    v_exp_f32 v215, -v215
    v_fma_f32 v212, v212, s0, s0
    v_fma_f32 v213, v213, s0, s0
    v_fma_f32 v214, v214, s0, s0
    v_fma_f32 v215, v215, s0, s0
    v_rcp_f32 v212, v212
    v_rcp_f32 v213, v213
    v_rcp_f32 v214, v214
    v_rcp_f32 v215, v215
    v_mul_f32 v220, v212, v220
    v_mul_f32 v221, v213, v221
    v_mul_f32 v222, v214, v222
    v_mul_f32 v223, v215, v223
    v_cvt_pk_bf16_f32 v78, v220, v221
    v_cvt_pk_bf16_f32 v79, v222, v223
    buffer_store_dwordx4 v[72:75], v1, s[24:27], s81 offen offset:2048 sc1
    v_cndmask_b32 v144, v144, v160, s[34:35]
    v_cndmask_b32 v145, v145, v161, s[36:37]
    v_cndmask_b32 v146, v146, v162, s[38:39]
    v_cndmask_b32 v147, v147, v163, s[40:41]
    v_cndmask_b32 v148, v148, v164, s[42:43]
    v_cndmask_b32 v149, v149, v165, s[44:45]
    v_cndmask_b32 v150, v150, v166, s[46:47]
    v_cndmask_b32 v151, v151, v167, s[48:49]
    v_max3_f32 v2, v144, v145, v144
    v_max3_f32 v3, v146, v147, v146
    v_cndmask_b32 v152, v152, v168, s[50:51]
    v_cndmask_b32 v153, v153, v169, s[52:53]
    v_cndmask_b32 v154, v154, v170, s[54:55]
    v_cndmask_b32 v155, v155, v171, s[56:57]
    v_max3_f32 v2, v148, v149, v2
    v_max3_f32 v3, v150, v151, v3
    v_cndmask_b32 v156, v156, v172, s[58:59]
    v_cndmask_b32 v157, v157, v173, s[60:61]
    v_cndmask_b32 v158, v158, v174, s[62:63]
    v_cndmask_b32 v159, v159, v175, s[64:65]
    v_max3_f32 v2, v152, v153, v2
    v_max3_f32 v3, v154, v155, v3
    v_max3_f32 v2, v156, v157, v2
    v_max3_f32 v3, v158, v159, v3
    v_max_f32 v2, v2, v3
    v_mov_b32 v3, v2
    buffer_store_dwordx4 v[76:79], v1, s[24:27], s81 offen offset:3072 sc1
    s_nop 0
    v_permlane32_swap_b32 v2, v3
    v_max_f32 v2, v2, v3
    v_sub_f32 v208, 0xc2c00000, v2
    v_mov_b32 v209, v208
    v_mov_b32 v210, v208
    v_mov_b32 v211, v208
    v_mov_b32 v212, v208
    v_mov_b32 v213, v208
    v_mov_b32 v214, v208
    v_mov_b32 v215, v208
    v_mov_b32 v216, v208
    v_mov_b32 v217, v208
    v_mov_b32 v218, v208
    v_mov_b32 v219, v208
    v_mov_b32 v220, v208
    v_mov_b32 v221, v208
    v_mov_b32 v222, v208
    v_mov_b32 v223, v208
    v_add_f32 v144, v144, v208
    v_add_f32 v145, v145, v208
    v_add_f32 v146, v146, v208
    v_add_f32 v147, v147, v208
    v_add_f32 v148, v148, v208
    v_add_f32 v149, v149, v208
    v_add_f32 v150, v150, v208
    v_add_f32 v151, v151, v208
    v_add_f32 v152, v152, v208
    v_add_f32 v153, v153, v208
    v_add_f32 v154, v154, v208
    v_add_f32 v155, v155, v208
    v_add_f32 v156, v156, v208
    v_add_f32 v157, v157, v208
    v_add_f32 v158, v158, v208
    v_add_f32 v159, v159, v208
    v_exp_f32 v144, v144
    v_exp_f32 v145, v145
    v_exp_f32 v146, v146
    v_exp_f32 v147, v147
    v_mfma_f32_32x32x16_bf16 v[176:191], a[80:83], v[192:195], v[208:223]
    ds_read_b64_tr_b16 a[80:81], v6 offset:2048
    s_add_u32 s97, s97, 8192
    buffer_load_dwordx4 v[56:59], v18, s[24:27], s97 offen sc1
    v_exp_f32 v148, v148
    v_exp_f32 v149, v149
    v_exp_f32 v150, v150
    v_exp_f32 v151, v151
    v_cvt_pk_bf16_f32 v224, v144, v145
    v_cvt_pk_bf16_f32 v225, v146, v147
    v_mfma_f32_32x32x16_bf16 v[176:191], a[84:87], v[196:199], v[176:191]
    ds_read_b64_tr_b16 a[82:83], v7 offset:2048
    buffer_load_dwordx4 v[60:63], v19, s[24:27], s97 offen sc1
    v_exp_f32 v152, v152
    v_exp_f32 v153, v153
    v_exp_f32 v154, v154
    v_exp_f32 v155, v155
    v_cvt_pk_bf16_f32 v226, v148, v149
    v_cvt_pk_bf16_f32 v227, v150, v151
    v_mfma_f32_32x32x16_bf16 v[160:175], a[88:91], v[192:195], v[208:223]
    ds_read_b64_tr_b16 a[84:85], v6 offset:2304
    s_add_u32 s97, s97, 8192
    buffer_load_dwordx4 v[64:67], v18, s[24:27], s97 offen sc1
    v_exp_f32 v156, v156
    v_exp_f32 v157, v157
    v_exp_f32 v158, v158
    v_exp_f32 v159, v159
    v_cvt_pk_bf16_f32 v228, v152, v153
    v_cvt_pk_bf16_f32 v229, v154, v155
    s_waitcnt lgkmcnt(15)
    v_mfma_f32_32x32x16_bf16 v[160:175], a[92:95], v[196:199], v[160:175]
    ds_read_b64_tr_b16 a[86:87], v7 offset:2304
    buffer_load_dwordx4 v[68:71], v19, s[24:27], s97 offen sc1
    ds_read_b64_tr_b16 a[88:89], v6 offset:4096
    ds_read_b64_tr_b16 a[90:91], v7 offset:4096
    ds_read_b64_tr_b16 a[92:93], v6 offset:4352
    ds_read_b64_tr_b16 a[94:95], v7 offset:4352
    v_cvt_pk_bf16_f32 v230, v156, v157
    v_cvt_pk_bf16_f32 v231, v158, v159
    v_and_b32 v232, v200, v224
    v_and_b32 v233, v201, v225
    v_and_b32 v234, v202, v226
    v_and_b32 v235, v203, v227
    v_and_b32 v236, v204, v228
    v_and_b32 v237, v205, v229
    v_and_b32 v238, v206, v230
    v_and_b32 v239, v207, v231
    v_xor_b32 v224, v232, v224
    v_xor_b32 v225, v233, v225
    v_xor_b32 v226, v234, v226
    v_xor_b32 v227, v235, v227
    v_xor_b32 v228, v236, v228
    v_xor_b32 v229, v237, v229
    v_xor_b32 v230, v238, v230
    v_xor_b32 v231, v239, v231
    v_exp_f32 v176, v176
    v_exp_f32 v177, v177
    v_exp_f32 v178, v178
    v_exp_f32 v179, v179
    s_waitcnt lgkmcnt(8)
    v_mfma_f32_32x32x16_bf16 v[240:255], a[208:211], v[224:227], 0
    s_add_u32 s97, s97, 8192
    buffer_load_dwordx4 v[72:75], v18, s[24:27], s97 offen sc1
    v_exp_f32 v180, v180
    v_exp_f32 v181, v181
    v_exp_f32 v182, v182
    v_exp_f32 v183, v183
    v_cvt_pk_bf16_f32 v200, v176, v177
    v_cvt_pk_bf16_f32 v201, v178, v179
    v_mfma_f32_32x32x16_bf16 v[240:255], a[212:215], v[228:231], v[240:255]
    buffer_load_dwordx4 v[76:79], v19, s[24:27], s97 offen sc1
    v_exp_f32 v184, v184
    v_exp_f32 v185, v185
    v_exp_f32 v186, v186
    v_exp_f32 v187, v187
    v_cvt_pk_bf16_f32 v202, v180, v181
    v_cvt_pk_bf16_f32 v203, v182, v183
    v_mfma_f32_32x32x16_bf16 v[240:255], a[216:219], v[232:235], v[240:255]
    s_add_u32 s97, s97, 8192
    buffer_load_dwordx4 v[80:83], v18, s[24:27], s97 offen sc1
    v_exp_f32 v188, v188
    v_exp_f32 v189, v189
    v_exp_f32 v190, v190
    v_exp_f32 v191, v191
    v_cvt_pk_bf16_f32 v204, v184, v185
    v_cvt_pk_bf16_f32 v205, v186, v187
    v_mfma_f32_32x32x16_bf16 v[240:255], a[220:223], v[236:239], v[240:255]
    buffer_load_dwordx4 v[84:87], v19, s[24:27], s97 offen sc1
    v_cvt_pk_bf16_f32 v206, v188, v189
    v_cvt_pk_bf16_f32 v207, v190, v191
    v_exp_f32 v160, v160
    v_exp_f32 v161, v161
    v_exp_f32 v162, v162
    v_exp_f32 v163, v163
    v_mfma_f32_32x32x16_bf16 v[144:159], a[64:67], v[192:195], v[208:223]
    ds_read_b64_tr_b16 a[64:65], v6 offset:6144
    s_add_u32 s97, s97, 8192
    buffer_load_dwordx4 v[88:91], v18, s[24:27], s97 offen sc1
    v_exp_f32 v164, v164
    v_exp_f32 v165, v165
    v_exp_f32 v166, v166
    v_exp_f32 v167, v167
    v_cvt_pk_bf16_f32 v224, v160, v161
    v_cvt_pk_bf16_f32 v225, v162, v163
    v_mfma_f32_32x32x16_bf16 v[144:159], a[68:71], v[196:199], v[144:159]
    ds_read_b64_tr_b16 a[66:67], v7 offset:6144
    buffer_load_dwordx4 v[92:95], v19, s[24:27], s97 offen sc1
    v_exp_f32 v168, v168
    v_exp_f32 v169, v169
    v_exp_f32 v170, v170
    v_exp_f32 v171, v171
    v_cvt_pk_bf16_f32 v226, v164, v165
    v_cvt_pk_bf16_f32 v227, v166, v167
    s_waitcnt lgkmcnt(6)
    v_mfma_f32_32x32x16_bf16 v[240:255], a[80:83], v[200:203], v[240:255]
    ds_read_b64_tr_b16 a[68:69], v6 offset:6400
    s_add_u32 s97, s97, 8192
    buffer_load_dwordx4 v[96:99], v18, s[24:27], s97 offen sc1
    v_exp_f32 v172, v172
    v_exp_f32 v173, v173
    v_exp_f32 v174, v174
    v_exp_f32 v175, v175
    v_cvt_pk_bf16_f32 v228, v168, v169
    v_cvt_pk_bf16_f32 v229, v170, v171
    v_mfma_f32_32x32x16_bf16 v[240:255], a[84:87], v[204:207], v[240:255]
    ds_read_b64_tr_b16 a[70:71], v7 offset:6400
    buffer_load_dwordx4 v[100:103], v19, s[24:27], s97 offen sc1
    v_cvt_pk_bf16_f32 v230, v172, v173
    v_cvt_pk_bf16_f32 v231, v174, v175
    s_waitcnt vmcnt(12)
    s_buffer_atomic_or s91, s[24:27], s83 offset:8192
    v_exp_f32 v144, v144
    v_exp_f32 v145, v145
    v_exp_f32 v146, v146
    v_exp_f32 v147, v147
    v_mfma_f32_32x32x16_bf16 v[176:191], a[72:75], v[192:195], v[208:223]
    ds_read_b64_tr_b16 a[72:73], v6 offset:8192
    s_add_u32 s97, s97, 8192
    buffer_load_dwordx4 v[104:107], v18, s[24:27], s97 offen sc1
    v_exp_f32 v148, v148
    v_exp_f32 v149, v149
    v_exp_f32 v150, v150
    v_exp_f32 v151, v151
    v_cvt_pk_bf16_f32 v200, v144, v145
    v_cvt_pk_bf16_f32 v201, v146, v147
    v_mfma_f32_32x32x16_bf16 v[176:191], a[76:79], v[196:199], v[176:191]
    ds_read_b64_tr_b16 a[74:75], v7 offset:8192
    buffer_load_dwordx4 v[108:111], v19, s[24:27], s97 offen sc1
    v_exp_f32 v152, v152
    v_exp_f32 v153, v153
    v_exp_f32 v154, v154
    v_exp_f32 v155, v155
    v_cvt_pk_bf16_f32 v202, v148, v149
    v_cvt_pk_bf16_f32 v203, v150, v151
    s_waitcnt lgkmcnt(6)
    v_mfma_f32_32x32x16_bf16 v[240:255], a[88:91], v[224:227], v[240:255]
    ds_read_b64_tr_b16 a[76:77], v6 offset:8448
    s_add_u32 s97, s97, 8192
    buffer_load_dwordx4 v[112:115], v18, s[24:27], s97 offen sc1
    v_exp_f32 v156, v156
    v_exp_f32 v157, v157
    v_exp_f32 v158, v158
    v_exp_f32 v159, v159
    v_cvt_pk_bf16_f32 v204, v152, v153
    v_cvt_pk_bf16_f32 v205, v154, v155
    v_mfma_f32_32x32x16_bf16 v[240:255], a[92:95], v[228:231], v[240:255]
    ds_read_b64_tr_b16 a[78:79], v7 offset:8448
    buffer_load_dwordx4 v[116:119], v19, s[24:27], s97 offen sc1
    v_cvt_pk_bf16_f32 v206, v156, v157
    v_cvt_pk_bf16_f32 v207, v158, v159
    v_exp_f32 v176, v176
    v_exp_f32 v177, v177
    v_exp_f32 v178, v178
    v_exp_f32 v179, v179
    v_mfma_f32_32x32x16_bf16 v[160:175], a[96:99], v[192:195], v[208:223]
    ds_read_b64_tr_b16 a[96:97], v6 offset:10240
    s_add_u32 s97, s97, 8192
    buffer_load_dwordx4 v[120:123], v18, s[24:27], s97 offen sc1
    v_exp_f32 v180, v180
    v_exp_f32 v181, v181
    v_exp_f32 v182, v182
    v_exp_f32 v183, v183
    v_cvt_pk_bf16_f32 v224, v176, v177
    v_cvt_pk_bf16_f32 v225, v178, v179
    v_mfma_f32_32x32x16_bf16 v[160:175], a[100:103], v[196:199], v[160:175]
    ds_read_b64_tr_b16 a[98:99], v7 offset:10240
    buffer_load_dwordx4 v[124:127], v19, s[24:27], s97 offen sc1
    v_exp_f32 v184, v184
    v_exp_f32 v185, v185
    v_exp_f32 v186, v186
    v_exp_f32 v187, v187
    v_cvt_pk_bf16_f32 v226, v180, v181
    v_cvt_pk_bf16_f32 v227, v182, v183
    s_waitcnt lgkmcnt(6)
    v_mfma_f32_32x32x16_bf16 v[240:255], a[64:67], v[200:203], v[240:255]
    ds_read_b64_tr_b16 a[100:101], v6 offset:10496
    s_add_u32 s97, s97, 8192
    buffer_load_dwordx4 v[128:131], v18, s[24:27], s97 offen sc1
    v_exp_f32 v188, v188
    v_exp_f32 v189, v189
    v_exp_f32 v190, v190
    v_exp_f32 v191, v191
    v_cvt_pk_bf16_f32 v228, v184, v185
    v_cvt_pk_bf16_f32 v229, v186, v187
    v_mfma_f32_32x32x16_bf16 v[240:255], a[68:71], v[204:207], v[240:255]
    ds_read_b64_tr_b16 a[102:103], v7 offset:10496
    buffer_load_dwordx4 v[132:135], v19, s[24:27], s97 offen sc1
    v_cvt_pk_bf16_f32 v230, v188, v189
    v_cvt_pk_bf16_f32 v231, v190, v191
    v_exp_f32 v160, v160
    v_exp_f32 v161, v161
    v_exp_f32 v162, v162
    v_exp_f32 v163, v163
    v_mfma_f32_32x32x16_bf16 v[144:159], a[104:107], v[192:195], v[208:223]
    ds_read_b64_tr_b16 a[104:105], v6 offset:12288
    s_add_u32 s97, s97, 8192
    buffer_load_dwordx4 v[136:139], v18, s[24:27], s97 offen sc1
    v_exp_f32 v164, v164
    v_exp_f32 v165, v165
    v_exp_f32 v166, v166
    v_exp_f32 v167, v167
    v_cvt_pk_bf16_f32 v200, v160, v161
    v_cvt_pk_bf16_f32 v201, v162, v163
    v_mfma_f32_32x32x16_bf16 v[144:159], a[108:111], v[196:199], v[144:159]
    ds_read_b64_tr_b16 a[106:107], v7 offset:12288
    buffer_load_dwordx4 v[140:143], v19, s[24:27], s97 offen sc1
    v_exp_f32 v168, v168
    v_exp_f32 v169, v169
    v_exp_f32 v170, v170
    v_exp_f32 v171, v171
    v_cvt_pk_bf16_f32 v202, v164, v165
    v_cvt_pk_bf16_f32 v203, v166, v167
    s_waitcnt lgkmcnt(6)
    v_mfma_f32_32x32x16_bf16 v[240:255], a[72:75], v[224:227], v[240:255]
    ds_read_b64_tr_b16 a[108:109], v6 offset:12544
    s_add_u32 m0, s80, 12288
    s_add_u32 s84, s84, 114688
    buffer_load_dwordx4 v16, s[20:23], s84 offen lds
    v_exp_f32 v172, v172
    v_exp_f32 v173, v173
    v_exp_f32 v174, v174
    v_exp_f32 v175, v175
    v_cvt_pk_bf16_f32 v204, v168, v169
    v_cvt_pk_bf16_f32 v205, v170, v171
    v_mfma_f32_32x32x16_bf16 v[240:255], a[76:79], v[228:231], v[240:255]
    ds_read_b64_tr_b16 a[110:111], v7 offset:12544
    buffer_load_dwordx4 v17, s[20:23], s84 offen offset:1024 lds
    v_cvt_pk_bf16_f32 v206, v172, v173
    v_cvt_pk_bf16_f32 v207, v174, v175
    v_exp_f32 v144, v144
    v_exp_f32 v145, v145
    v_exp_f32 v146, v146
    v_exp_f32 v147, v147
    v_mfma_f32_32x32x16_bf16 v[176:191], a[240:243], v[192:195], v[208:223]
    ds_read_b64_tr_b16 a[240:241], v6 offset:14336
    s_add_u32 m0, s80, 14336
    s_add_u32 s84, s84, 114688
    buffer_load_dwordx4 v16, s[20:23], s84 offen lds
    v_exp_f32 v148, v148
    v_exp_f32 v149, v149
    v_exp_f32 v150, v150
    v_exp_f32 v151, v151
    v_cvt_pk_bf16_f32 v224, v144, v145
    v_cvt_pk_bf16_f32 v225, v146, v147
    v_mfma_f32_32x32x16_bf16 v[176:191], a[244:247], v[196:199], v[176:191]
    ds_read_b64_tr_b16 a[242:243], v7 offset:14336
    buffer_load_dwordx4 v17, s[20:23], s84 offen offset:1024 lds
    v_exp_f32 v152, v152
    v_exp_f32 v153, v153
    v_exp_f32 v154, v154
    v_exp_f32 v155, v155
    v_cvt_pk_bf16_f32 v226, v148, v149
    v_cvt_pk_bf16_f32 v227, v150, v151
    s_waitcnt lgkmcnt(6)
    v_mfma_f32_32x32x16_bf16 v[240:255], a[96:99], v[200:203], v[240:255]
    ds_read_b64_tr_b16 a[244:245], v6 offset:14592
    s_add_u32 m0, s80, 16384
    s_nop 0
    buffer_load_dwordx4 v16, s[12:15], s75 offen lds
    v_exp_f32 v156, v156
    v_exp_f32 v157, v157
    v_exp_f32 v158, v158
    v_exp_f32 v159, v159
    v_cvt_pk_bf16_f32 v228, v152, v153
    v_cvt_pk_bf16_f32 v229, v154, v155
    v_mfma_f32_32x32x16_bf16 v[240:255], a[100:103], v[204:207], v[240:255]
    ds_read_b64_tr_b16 a[246:247], v7 offset:14592
    buffer_load_dwordx4 v17, s[12:15], s75 offen offset:1024 lds
    v_cvt_pk_bf16_f32 v230, v156, v157
    v_cvt_pk_bf16_f32 v231, v158, v159
    v_exp_f32 v176, v176
    v_exp_f32 v177, v177
    v_exp_f32 v178, v178
    v_exp_f32 v179, v179
    s_waitcnt lgkmcnt(4)
    v_mfma_f32_32x32x16_bf16 v[240:255], a[104:107], v[224:227], v[240:255]
    s_add_u32 m0, s80, 18432
    s_add_u32 s75, s75, 14336
    buffer_load_dwordx4 v16, s[12:15], s75 offen lds
    v_exp_f32 v180, v180
    v_exp_f32 v181, v181
    v_exp_f32 v182, v182
    v_exp_f32 v183, v183
    v_cvt_pk_bf16_f32 v200, v176, v177
    v_cvt_pk_bf16_f32 v201, v178, v179
    v_mfma_f32_32x32x16_bf16 v[240:255], a[108:111], v[228:231], v[240:255]
    buffer_load_dwordx4 v17, s[12:15], s75 offen offset:1024 lds
    v_exp_f32 v184, v184
    v_exp_f32 v185, v185
    v_exp_f32 v186, v186
    v_exp_f32 v187, v187
    v_cvt_pk_bf16_f32 v202, v180, v181
    v_cvt_pk_bf16_f32 v203, v182, v183
    s_add_u32 m0, s80, 20480
    s_add_u32 s75, s75, 7168
    buffer_load_dwordx4 v16, s[12:15], s75 offen lds
    v_exp_f32 v188, v188
    v_exp_f32 v189, v189
    v_exp_f32 v190, v190
    v_exp_f32 v191, v191
    v_cvt_pk_bf16_f32 v204, v184, v185
    v_cvt_pk_bf16_f32 v205, v186, v187
    buffer_load_dwordx4 v17, s[12:15], s75 offen offset:1024 lds
    v_cvt_pk_bf16_f32 v206, v188, v189
    v_cvt_pk_bf16_f32 v207, v190, v191
    s_add_u32 m0, s80, 22528
    s_add_u32 s75, s75, 14336
    buffer_load_dwordx4 v16, s[12:15], s75 offen lds
    buffer_load_dwordx4 v17, s[12:15], s75 offen offset:1024 lds
    s_waitcnt lgkmcnt(0)
    v_mfma_f32_32x32x16_bf16 v[240:255], a[240:243], v[200:203], v[240:255]
    s_add_u32 m0, s80, 24576
    s_mov_b32 s77, 0
    s_buffer_load_dword s77, s[24:27], s100 offset:8192
    s_add_u32 s75, s75, 14336
    buffer_load_dwordx4 v16, s[12:15], s75 offen lds
    v_mfma_f32_32x32x16_bf16 v[240:255], a[244:247], v[204:207], v[240:255]
    v_mfma_f32_32x32x16_bf16 v[144:159], a[0:3], v[32:35], 0
    buffer_load_dwordx4 v17, s[12:15], s75 offen offset:1024 lds
    s_add_u32 m0, s80, 26624
    s_add_u32 s75, s75, 14336
    v_mfma_f32_32x32x16_bf16 a[224:239], a[0:3], v[36:39], 0
    v_mfma_f32_32x32x16_bf16 a[64:79], a[4:7], v[32:35], 0
    buffer_load_dwordx4 v16, s[12:15], s75 offen lds
    v_cndmask_b32 v2, 0, v240, s[92:93]
    v_cndmask_b32 v2, v2, v252, s[94:95]
    v_mov_b32 v3, v2
    v_maximum3_f32 v4, |v240|, |v241|, |v242|
    v_maximum3_f32 v4, v4, |v243|, |v244|
    v_permlane32_swap_b32 v2, v3
    v_mfma_f32_32x32x16_bf16 a[80:95], a[4:7], v[36:39], 0
    v_add_f32 v2, v2, v3
    v_rcp_f32 v2, v2
    v_maximum3_f32 v4, v4, |v245|, |v246|
    v_maximum3_f32 v4, v4, |v247|, |v248|
    v_maximum3_f32 v4, v4, |v249|, |v250|
    v_maximum3_f32 v4, v4, |v251|, |v252|
    v_maximum3_f32 v4, v4, |v253|, |v254|
    v_mfma_f32_32x32x16_bf16 v[144:159], a[8:11], v[40:43], v[144:159]
    ds_read_b64_tr_b16 a[96:97], v14 offset:0
    buffer_load_dwordx4 v17, s[12:15], s75 offen offset:1024 lds
    s_add_u32 m0, s80, 0
    v_mul_f32 v3, 0x49800000, v2
    v_maximum3_f32 v4, v4, |v255|, v3
    v_cmp_ngt_f32 vcc, 0x7b800000, v4
    s_cbranch_vccnz L_slowattG
L_backattG:
    v_mul_f32 v2, 0x3ef5fdf0, v2
    v_cndmask_b32 v3, v2, 0, s[92:93]
    v_mfma_f32_32x32x16_bf16 a[224:239], a[8:11], v[44:47], a[224:239]
    ds_read_b64_tr_b16 a[98:99], v14 offset:1024
    v_cndmask_b32 v4, v2, 0, s[94:95]
    v_mul_f32 v244, v2, v244
    v_mul_f32 v245, v2, v245
    v_mul_f32 v246, v2, v246
    v_mul_f32 v247, v2, v247
    v_mul_f32 v248, v2, v248
    v_mul_f32 v249, v2, v249
    v_mul_f32 v250, v2, v250
    v_mul_f32 v251, v2, v251
    v_mfma_f32_32x32x16_bf16 a[64:79], a[12:15], v[40:43], a[64:79]
    ds_read_b64_tr_b16 a[100:101], v15 offset:0
    v_mul_f32 v240, v3, v240
    v_mul_f32 v241, v3, v241
    v_mul_f32 v242, v3, v242
    v_mul_f32 v243, v3, v243
    v_mul_f32 v252, v4, v252
    v_mul_f32 v253, v4, v253
    v_mul_f32 v254, v4, v254
    v_mul_f32 v255, v4, v255
    v_cvt_pk_bf16_f32 v232, v240, v241
    v_mfma_f32_32x32x16_bf16 a[80:95], a[12:15], v[44:47], a[80:95]
    ds_read_b64_tr_b16 a[102:103], v15 offset:1024
    v_cvt_pk_bf16_f32 v233, v242, v243
    v_cvt_pk_bf16_f32 v234, v244, v245
    v_cvt_pk_bf16_f32 v235, v246, v247
    v_cvt_pk_bf16_f32 v236, v248, v249
    v_cvt_pk_bf16_f32 v237, v250, v251
    v_cvt_pk_bf16_f32 v238, v252, v253
    v_cvt_pk_bf16_f32 v239, v254, v255
    v_mfma_f32_32x32x16_bf16 v[144:159], a[16:19], v[48:51], v[144:159]
    ds_read_b64_tr_b16 a[104:105], v14 offset:2048
    buffer_store_dwordx4 v[232:235], v1, s[24:27], s98 offen offset:0 sc1
    v_mfma_f32_32x32x16_bf16 a[224:239], a[16:19], v[52:55], a[224:239]
    ds_read_b64_tr_b16 a[106:107], v14 offset:3072
    v_mfma_f32_32x32x16_bf16 a[64:79], a[20:23], v[48:51], a[64:79]
    ds_read_b64_tr_b16 a[108:109], v15 offset:2048
    buffer_store_dwordx4 v[236:239], v1, s[24:27], s98 offen offset:1024 sc1
    v_mfma_f32_32x32x16_bf16 a[80:95], a[20:23], v[52:55], a[80:95]
    ds_read_b64_tr_b16 a[110:111], v15 offset:3072
    s_waitcnt vmcnt(38)
    v_mfma_f32_32x32x16_bf16 v[144:159], a[24:27], v[56:59], v[144:159]
    s_waitcnt lgkmcnt(0)
    s_add_u32 s75, s75, 7168
    buffer_load_dwordx4 v16, s[12:15], s75 offen lds
    v_lshrrev_b32 v30, 3, v0
    v_mul_u32_u24 v12, 896, v30
    v_mfma_f32_32x32x16_bf16 a[224:239], a[24:27], v[60:63], a[224:239]
    v_lshrrev_b32 v30, 4, v0
    v_xor_b32 v30, v0, v30
    v_and_b32 v30, 7, v30
    v_lshl_add_u32 v12, v30, 4, v12
    v_xor_b32 v13, 64, v12
    v_add_u32 v13, 6144, v13
    v_mfma_f32_32x32x16_bf16 a[64:79], a[28:31], v[56:59], a[64:79]
    buffer_load_dwordx4 v17, s[12:15], s75 offen offset:1024 lds
    s_add_u32 m0, s80, 2048
    s_add_u32 s75, s75, 14336
    s_mul_i32 s72, s71, 28672
    v_subrev_u32 v8, s72, v14
    v_mfma_f32_32x32x16_bf16 a[80:95], a[28:31], v[60:63], a[80:95]
    v_subrev_u32 v9, s72, v15
    s_lshl_b32 s72, s72, 1
    s_add_u32 s72, s72, 53248
    s_lshr_b32 s73, s69, 1
    s_lshl_b32 s73, s73, 2
    s_waitcnt vmcnt(38)
    v_mfma_f32_32x32x16_bf16 v[144:159], a[32:35], v[64:67], v[144:159]
    buffer_load_dwordx4 v16, s[12:15], s75 offen lds
    v_bfe_u32 v30, v0, 1, 3
    v_xor_b32 v30, s73, v30
    v_lshl_add_u32 v10, v30, 4, s72
    v_and_b32 v30, 15, v0
    v_mfma_f32_32x32x16_bf16 a[224:239], a[32:35], v[68:71], a[224:239]
    v_lshl_add_u32 v10, v30, 7, v10
    v_lshrrev_b32 v30, 5, v0
    v_lshl_add_u32 v10, v30, 3, v10
    v_bfe_u32 v30, v0, 4, 1
    v_mul_u32_u24 v30, 28672, v30
    v_add_u32 v10, v10, v30
    v_mfma_f32_32x32x16_bf16 a[64:79], a[36:39], v[64:67], a[64:79]
    buffer_load_dwordx4 v17, s[12:15], s75 offen offset:1024 lds
    s_add_u32 m0, s80, 4096
    v_xor_b32 v11, 16, v10
    v_xor_b32 v22, 32, v10
    v_xor_b32 v23, 48, v10
    v_mfma_f32_32x32x16_bf16 a[80:95], a[36:39], v[68:71], a[80:95]
    s_xor_b32 s72, s69, 1
    s_mul_i32 s72, s72, 12288
    s_add_u32 s72, s72, 0
    v_add_u32 v24, s72, v1
    s_xor_b32 s72, s69, 2
    s_waitcnt vmcnt(38)
    v_mfma_f32_32x32x16_bf16 v[144:159], a[40:43], v[72:75], v[144:159]
    s_andn2_b32 vcc_hi, 0xfffffff, s77
    s_cbranch_scc1 L_slow_hb
L_back_hb:
    s_add_u32 s97, s97, 4294864896
    buffer_load_dwordx4 v[32:35], v18, s[24:27], s97 offen sc1
    s_mul_i32 s72, s72, 12288
    v_mfma_f32_32x32x16_bf16 a[224:239], a[40:43], v[76:79], a[224:239]
    s_add_u32 s72, s72, 4096
    v_add_u32 v25, s72, v1
    s_xor_b32 s72, s69, 3
    s_mul_i32 s72, s72, 12288
    s_add_u32 s72, s72, 8192
    v_add_u32 v26, s72, v1
    v_mfma_f32_32x32x16_bf16 a[64:79], a[44:47], v[72:75], a[64:79]
    buffer_load_dwordx4 v[36:39], v19, s[24:27], s97 offen sc1
    s_add_u32 s97, s97, 8192
    s_mul_i32 s72, s69, 12288
    v_add_u32 v5, s72, v1
    v_add_u32 v6, s80, v1
    v_mfma_f32_32x32x16_bf16 a[80:95], a[44:47], v[76:79], a[80:95]
    s_xor_b32 s72, s69, 2
    s_mul_i32 s72, s72, 28672
    s_add_u32 s72, s72, 49152
    v_add_u32 v7, s72, v1
    v_and_b32 v30, 31, v0
    s_waitcnt vmcnt(38)
    v_mfma_f32_32x32x16_bf16 v[144:159], a[48:51], v[80:83], v[144:159]
    buffer_load_dwordx4 v[40:43], v18, s[24:27], s97 offen sc1
    v_mul_u32_u24 v27, 896, v30
    v_lshrrev_b32 v30, 5, v0
    v_lshl_add_u32 v27, v30, 4, v27
    s_mul_i32 s72, s69, 14336
    v_mfma_f32_32x32x16_bf16 a[224:239], a[48:51], v[84:87], a[224:239]
    s_sub_u32 s74, s67, s72
    s_mul_i32 s72, s71, 28672
    s_add_u32 s74, s74, s72
    s_lshl4_add_u32 s74, s73, s74
    v_mfma_f32_32x32x16_bf16 a[64:79], a[52:55], v[80:83], a[64:79]
    buffer_load_dwordx4 v[44:47], v19, s[24:27], s97 offen sc1
    s_add_u32 s97, s97, 8192
    v_mfma_f32_32x32x16_bf16 a[80:95], a[52:55], v[84:87], a[80:95]
    s_waitcnt vmcnt(38)
    v_mfma_f32_32x32x16_bf16 v[144:159], a[56:59], v[88:91], v[144:159]
    buffer_load_dwordx4 v[48:51], v18, s[24:27], s97 offen sc1
    v_mfma_f32_32x32x16_bf16 a[224:239], a[56:59], v[92:95], a[224:239]
    v_mfma_f32_32x32x16_bf16 a[64:79], a[60:63], v[88:91], a[64:79]
    buffer_load_dwordx4 v[52:55], v19, s[24:27], s97 offen sc1
    s_add_u32 s97, s97, 8192
    v_mfma_f32_32x32x16_bf16 a[80:95], a[60:63], v[92:95], a[80:95]
    s_waitcnt vmcnt(38)
    v_mfma_f32_32x32x16_bf16 v[144:159], a[112:115], v[96:99], v[144:159]
    buffer_load_dwordx4 v[56:59], v18, s[24:27], s97 offen sc1
    v_mfma_f32_32x32x16_bf16 a[224:239], a[112:115], v[100:103], a[224:239]
    v_mfma_f32_32x32x16_bf16 a[64:79], a[116:119], v[96:99], a[64:79]
    buffer_load_dwordx4 v[60:63], v19, s[24:27], s97 offen sc1
    s_waitcnt vmcnt(12)
    s_buffer_atomic_or s91, s[24:27], s83 offset:12288
    s_add_u32 s97, s97, 8192
    v_mfma_f32_32x32x16_bf16 a[80:95], a[116:119], v[100:103], a[80:95]
    v_mfma_f32_32x32x16_bf16 v[144:159], a[120:123], v[104:107], v[144:159]
    buffer_load_dwordx4 v[64:67], v18, s[24:27], s97 offen sc1
    v_mfma_f32_32x32x16_bf16 a[224:239], a[120:123], v[108:111], a[224:239]
    v_mfma_f32_32x32x16_bf16 a[64:79], a[124:127], v[104:107], a[64:79]
    buffer_load_dwordx4 v[68:71], v19, s[24:27], s97 offen sc1
    s_add_u32 s97, s97, 8192
    v_mfma_f32_32x32x16_bf16 a[80:95], a[124:127], v[108:111], a[80:95]
    v_mfma_f32_32x32x16_bf16 v[144:159], a[128:131], v[112:115], v[144:159]
    ds_read_b64_tr_b16 a[240:241], v14 offset:4096
    s_branch L_overG6
    .p2align 12
L_padG6:
    s_branch L_retGb
L_overG6:
    buffer_load_dwordx4 v[72:75], v18, s[24:27], s97 offen sc1
    v_mfma_f32_32x32x16_bf16 a[224:239], a[128:131], v[116:119], a[224:239]
    ds_read_b64_tr_b16 a[242:243], v14 offset:5120
    v_mfma_f32_32x32x16_bf16 a[64:79], a[132:135], v[112:115], a[64:79]
    ds_read_b64_tr_b16 a[244:245], v15 offset:4096
    buffer_load_dwordx4 v[76:79], v19, s[24:27], s97 offen sc1
    v_mfma_f32_32x32x16_bf16 a[80:95], a[132:135], v[116:119], a[80:95]
    ds_read_b64_tr_b16 a[246:247], v15 offset:5120
    v_mfma_f32_32x32x16_bf16 v[144:159], a[136:139], v[120:123], v[144:159]
    ds_read_b64_tr_b16 a[248:249], v14 offset:6144
    s_waitcnt lgkmcnt(1)
    buffer_load_dwordx4 v12, s[4:7], s67 offen offset:0 lds
    v_mfma_f32_32x32x16_bf16 a[224:239], a[136:139], v[124:127], a[224:239]
    ds_read_b64_tr_b16 a[250:251], v14 offset:7168
    v_mfma_f32_32x32x16_bf16 a[64:79], a[140:143], v[120:123], a[64:79]
    ds_read_b64_tr_b16 a[252:253], v15 offset:6144
    buffer_load_dwordx4 v13, s[4:7], s67 offen offset:1024 lds
    s_add_u32 s97, s97, 8192
    v_mfma_f32_32x32x16_bf16 a[80:95], a[140:143], v[124:127], a[80:95]
    ds_read_b64_tr_b16 a[254:255], v15 offset:7168
    v_mfma_f32_32x32x16_bf16 v[144:159], a[144:147], v[128:131], v[144:159]
    ds_read_b64_tr_b16 a[112:113], v14 offset:8192
    buffer_load_dwordx4 v[80:83], v18, s[24:27], s97 offen sc1
    v_mfma_f32_32x32x16_bf16 a[224:239], a[144:147], v[132:135], a[224:239]
    ds_read_b64_tr_b16 a[114:115], v14 offset:9216
    v_mfma_f32_32x32x16_bf16 a[64:79], a[148:151], v[128:131], a[64:79]
    ds_read_b64_tr_b16 a[116:117], v15 offset:8192
    buffer_load_dwordx4 v[84:87], v19, s[24:27], s97 offen sc1
    s_add_u32 s97, s97, 8192
    v_mfma_f32_32x32x16_bf16 a[80:95], a[148:151], v[132:135], a[80:95]
    ds_read_b64_tr_b16 a[118:119], v15 offset:9216
    v_mfma_f32_32x32x16_bf16 v[144:159], a[152:155], v[136:139], v[144:159]
    ds_read_b64_tr_b16 a[120:121], v14 offset:10240
    buffer_load_dwordx4 v[88:91], v18, s[24:27], s97 offen sc1
    v_mfma_f32_32x32x16_bf16 a[224:239], a[152:155], v[140:143], a[224:239]
    ds_read_b64_tr_b16 a[122:123], v14 offset:11264
    v_mfma_f32_32x32x16_bf16 a[64:79], a[156:159], v[136:139], a[64:79]
    ds_read_b64_tr_b16 a[124:125], v15 offset:10240
    buffer_load_dwordx4 v[92:95], v19, s[24:27], s97 offen sc1
    s_add_u32 s97, s97, 8192
    v_mfma_f32_32x32x16_bf16 a[80:95], a[156:159], v[140:143], a[80:95]
    ds_read_b64_tr_b16 a[126:127], v15 offset:11264
    s_waitcnt vmcnt(16)
    v_mfma_f32_32x32x16_bf16 v[144:159], a[160:163], v[32:35], v[144:159]
    ds_read_b64_tr_b16 a[128:129], v14 offset:12288
    buffer_load_dwordx4 v[96:99], v18, s[24:27], s97 offen sc1
    v_mfma_f32_32x32x16_bf16 a[224:239], a[160:163], v[36:39], a[224:239]
    ds_read_b64_tr_b16 a[130:131], v14 offset:13312
    v_mfma_f32_32x32x16_bf16 a[64:79], a[164:167], v[32:35], a[64:79]
    ds_read_b64_tr_b16 a[132:133], v15 offset:12288
    buffer_load_dwordx4 v[100:103], v19, s[24:27], s97 offen sc1
    s_add_u32 s97, s97, 8192
    v_mfma_f32_32x32x16_bf16 a[80:95], a[164:167], v[36:39], a[80:95]
    ds_read_b64_tr_b16 a[134:135], v15 offset:13312
    s_waitcnt vmcnt(16)
    v_mfma_f32_32x32x16_bf16 v[144:159], a[168:171], v[40:43], v[144:159]
    ds_read_b64_tr_b16 a[136:137], v14 offset:14336
    buffer_load_dwordx4 v[104:107], v18, s[24:27], s97 offen sc1
    v_mfma_f32_32x32x16_bf16 a[224:239], a[168:171], v[44:47], a[224:239]
    ds_read_b64_tr_b16 a[138:139], v14 offset:15360
    v_mfma_f32_32x32x16_bf16 a[64:79], a[172:175], v[40:43], a[64:79]
    ds_read_b64_tr_b16 a[140:141], v15 offset:14336
    buffer_load_dwordx4 v[108:111], v19, s[24:27], s97 offen sc1
    s_add_u32 s97, s97, 8192
    v_mfma_f32_32x32x16_bf16 a[80:95], a[172:175], v[44:47], a[80:95]
    ds_read_b64_tr_b16 a[142:143], v15 offset:15360
    s_waitcnt vmcnt(16)
    v_mfma_f32_32x32x16_bf16 v[144:159], a[176:179], v[48:51], v[144:159]
    buffer_load_dwordx4 v[112:115], v18, s[24:27], s97 offen sc1
    v_mfma_f32_32x32x16_bf16 a[224:239], a[176:179], v[52:55], a[224:239]
    v_mfma_f32_32x32x16_bf16 a[64:79], a[180:183], v[48:51], a[64:79]
    buffer_load_dwordx4 v[116:119], v19, s[24:27], s97 offen sc1
    s_add_u32 s97, s97, 8192
    v_mfma_f32_32x32x16_bf16 a[80:95], a[180:183], v[52:55], a[80:95]
    s_waitcnt vmcnt(16)
    v_mfma_f32_32x32x16_bf16 v[144:159], a[184:187], v[56:59], v[144:159]
    buffer_load_dwordx4 v[120:123], v18, s[24:27], s97 offen sc1
    v_mfma_f32_32x32x16_bf16 a[224:239], a[184:187], v[60:63], a[224:239]
    v_mfma_f32_32x32x16_bf16 a[64:79], a[188:191], v[56:59], a[64:79]
    buffer_load_dwordx4 v[124:127], v19, s[24:27], s97 offen sc1
    s_add_u32 s97, s97, 8192
    v_mfma_f32_32x32x16_bf16 a[80:95], a[188:191], v[60:63], a[80:95]
    s_waitcnt vmcnt(16)
    v_mfma_f32_32x32x16_bf16 v[144:159], a[192:195], v[64:67], v[144:159]
    s_waitcnt vmcnt(12)
    s_barrier
    buffer_load_dwordx4 v[128:131], v18, s[24:27], s97 offen sc1
    v_mfma_f32_32x32x16_bf16 a[224:239], a[192:195], v[68:71], a[224:239]
    ds_read_b64 v[248:249], v10
    ds_read_b64 v[250:251], v11
    v_mfma_f32_32x32x16_bf16 a[64:79], a[196:199], v[64:67], a[64:79]
    buffer_load_dwordx4 v[132:135], v19, s[24:27], s97 offen sc1
    s_mov_b32 s78, 0
    s_buffer_load_dword s78, s[24:27], s100 offset:12288
    s_add_u32 s97, s97, 8192
    ds_read_b64 v[252:253], v22
    ds_read_b64 v[254:255], v23
    v_mfma_f32_32x32x16_bf16 a[80:95], a[196:199], v[68:71], a[80:95]
    ds_read_b64_tr_b16 a[4:5], v9 offset:16384
    ds_read_b64_tr_b16 a[6:7], v9 offset:17408
    v_mfma_f32_32x32x16_bf16 v[144:159], a[200:203], v[72:75], v[144:159]
    buffer_load_dwordx4 v[136:139], v18, s[24:27], s97 offen sc1
    ds_read_b64_tr_b16 a[0:1], v8 offset:16384
    ds_read_b64_tr_b16 a[2:3], v8 offset:17408
    s_waitcnt lgkmcnt(4)
    v_lshlrev_b32 v240, 16, v248
    v_mfma_f32_32x32x16_bf16 a[224:239], a[200:203], v[76:79], a[224:239]
    ds_read_b64_tr_b16 a[12:13], v9 offset:18432
    ds_read_b64_tr_b16 a[14:15], v9 offset:19456
    v_and_b32 v241, 0xffff0000, v248
    v_lshlrev_b32 v242, 16, v249
    v_and_b32 v243, 0xffff0000, v249
    v_lshlrev_b32 v244, 16, v250
    v_mfma_f32_32x32x16_bf16 a[64:79], a[204:207], v[72:75], a[64:79]
    buffer_load_dwordx4 v[140:143], v19, s[24:27], s97 offen sc1
    s_andn2_b32 vcc_hi, s68, s78
    s_cbranch_scc1 L_slow_o
L_back_o:
    ds_read_b64_tr_b16 a[8:9], v8 offset:18432
    ds_read_b64_tr_b16 a[10:11], v8 offset:19456
    v_mfma_f32_32x32x16_bf16 a[80:95], a[204:207], v[76:79], a[80:95]
    ds_read_b64_tr_b16 a[20:21], v9 offset:20480
    ds_read_b64_tr_b16 a[22:23], v9 offset:21504
    v_and_b32 v245, 0xffff0000, v250
    v_lshlrev_b32 v246, 16, v251
    v_and_b32 v247, 0xffff0000, v251
    s_waitcnt vmcnt(14)
    v_mfma_f32_32x32x16_bf16 v[144:159], a[96:99], v[80:83], v[144:159]
    buffer_load_dwordx4 v[176:179], v1, s[24:27], s66 offen offset:0 sc1
    ds_read_b64_tr_b16 a[16:17], v8 offset:20480
    ds_read_b64_tr_b16 a[18:19], v8 offset:21504
    v_lshlrev_b32 v248, 16, v252
    v_and_b32 v249, 0xffff0000, v252
    v_mfma_f32_32x32x16_bf16 a[224:239], a[96:99], v[84:87], a[224:239]
    ds_read_b64_tr_b16 a[28:29], v9 offset:22528
    ds_read_b64_tr_b16 a[30:31], v9 offset:23552
    v_lshlrev_b32 v250, 16, v253
    v_and_b32 v251, 0xffff0000, v253
    v_lshlrev_b32 v252, 16, v254
    v_and_b32 v253, 0xffff0000, v254
    v_mfma_f32_32x32x16_bf16 a[64:79], a[100:103], v[80:83], a[64:79]
    buffer_load_dwordx4 v[180:183], v1, s[24:27], s66 offen offset:1024 sc1
    ds_read_b64_tr_b16 a[24:25], v8 offset:22528
    ds_read_b64_tr_b16 a[26:27], v8 offset:23552
    v_lshlrev_b32 v254, 16, v255
    v_and_b32 v255, 0xffff0000, v255
    v_mfma_f32_32x32x16_bf16 a[80:95], a[100:103], v[84:87], a[80:95]
    ds_read_b64_tr_b16 a[36:37], v9 offset:24576
    ds_read_b64_tr_b16 a[38:39], v9 offset:25600
    s_waitcnt vmcnt(14)
    v_mfma_f32_32x32x16_bf16 v[144:159], a[104:107], v[88:91], v[144:159]
    buffer_load_dwordx4 v[184:187], v1, s[24:27], s66 offen offset:2048 sc1
    ds_read_b64_tr_b16 a[32:33], v8 offset:24576
    ds_read_b64_tr_b16 a[34:35], v8 offset:25600
    v_mfma_f32_32x32x16_bf16 a[224:239], a[104:107], v[92:95], a[224:239]
    ds_read_b64_tr_b16 a[44:45], v9 offset:26624
    ds_read_b64_tr_b16 a[46:47], v9 offset:27648
    v_mfma_f32_32x32x16_bf16 a[64:79], a[108:111], v[88:91], a[64:79]
    buffer_load_dwordx4 v[188:191], v1, s[24:27], s66 offen offset:3072 sc1
    s_add_u32 s66, s66, 4096
    ds_read_b64_tr_b16 a[40:41], v8 offset:26624
    ds_read_b64_tr_b16 a[42:43], v8 offset:27648
    v_mfma_f32_32x32x16_bf16 a[80:95], a[108:111], v[92:95], a[80:95]
    ds_read_b64_tr_b16 a[52:53], v9 offset:0
    ds_read_b64_tr_b16 a[54:55], v9 offset:1024
    s_waitcnt vmcnt(14)
    v_mfma_f32_32x32x16_bf16 v[144:159], a[240:243], v[96:99], v[144:159]
    buffer_load_dwordx4 v[192:195], v1, s[24:27], s66 offen offset:0 sc1
    ds_read_b64_tr_b16 a[48:49], v8 offset:0
    ds_read_b64_tr_b16 a[50:51], v8 offset:1024
    v_mfma_f32_32x32x16_bf16 a[224:239], a[240:243], v[100:103], a[224:239]
    ds_read_b64_tr_b16 a[60:61], v9 offset:2048
    ds_read_b64_tr_b16 a[62:63], v9 offset:3072
    v_mfma_f32_32x32x16_bf16 a[64:79], a[244:247], v[96:99], a[64:79]
    buffer_load_dwordx4 v[196:199], v1, s[24:27], s66 offen offset:1024 sc1
    ds_read_b64_tr_b16 a[56:57], v8 offset:2048
    ds_read_b64_tr_b16 a[58:59], v8 offset:3072
    v_mfma_f32_32x32x16_bf16 a[80:95], a[244:247], v[100:103], a[80:95]
    ds_read_b64_tr_b16 a[148:149], v9 offset:45056
    ds_read_b64_tr_b16 a[150:151], v9 offset:46080
    s_waitcnt vmcnt(14)
    v_mfma_f32_32x32x16_bf16 a[224:239], a[248:251], v[108:111], a[224:239]
    buffer_load_dwordx4 v[200:203], v1, s[24:27], s66 offen offset:2048 sc1
    ds_read_b64_tr_b16 a[144:145], v8 offset:45056
    ds_read_b64_tr_b16 a[146:147], v8 offset:46080
    s_waitcnt vmcnt(13)
    v_mfma_f32_32x32x16_bf16 a[224:239], a[112:115], v[116:119], a[224:239]
    ds_read_b64_tr_b16 a[156:157], v9 offset:47104
    ds_read_b64_tr_b16 a[158:159], v9 offset:48128
    s_waitcnt vmcnt(11)
    v_mfma_f32_32x32x16_bf16 a[224:239], a[120:123], v[124:127], a[224:239]
    buffer_load_dwordx4 v[204:207], v1, s[24:27], s66 offen offset:3072 sc1
    s_add_u32 s66, s66, 4096
    ds_read_b64_tr_b16 a[152:153], v8 offset:47104
    ds_read_b64_tr_b16 a[154:155], v8 offset:48128
    s_waitcnt vmcnt(10)
    v_mfma_f32_32x32x16_bf16 a[224:239], a[128:131], v[132:135], a[224:239]
    ds_read_b64_tr_b16 a[164:165], v9 offset:49152
    ds_read_b64_tr_b16 a[166:167], v9 offset:50176
    s_waitcnt vmcnt(8)
    v_mfma_f32_32x32x16_bf16 a[224:239], a[136:139], v[140:143], a[224:239]
    buffer_load_dwordx4 v[208:211], v1, s[24:27], s66 offen offset:0 sc1
    ds_read_b64_tr_b16 a[160:161], v8 offset:49152
    ds_read_b64_tr_b16 a[162:163], v8 offset:50176
    v_mfma_f32_32x32x16_bf16 a[64:79], a[252:255], v[104:107], a[64:79]
    ds_read_b64_tr_b16 a[172:173], v9 offset:51200
    ds_read_b64_tr_b16 a[174:175], v9 offset:52224
    v_mfma_f32_32x32x16_bf16 a[64:79], a[116:119], v[112:115], a[64:79]
    buffer_load_dwordx4 v[212:215], v1, s[24:27], s66 offen offset:1024 sc1
    ds_read_b64_tr_b16 a[168:169], v8 offset:51200
    ds_read_b64_tr_b16 a[170:171], v8 offset:52224
    v_mfma_f32_32x32x16_bf16 a[64:79], a[124:127], v[120:123], a[64:79]
    ds_read_b64_tr_b16 a[180:181], v9 offset:53248
    ds_read_b64_tr_b16 a[182:183], v9 offset:54272
    ds_write_b128 v24, a[224:227] offset:0
    v_mfma_f32_32x32x16_bf16 a[64:79], a[132:135], v[128:131], a[64:79]
    buffer_load_dwordx4 v[216:219], v1, s[24:27], s66 offen offset:2048 sc1
    ds_read_b64_tr_b16 a[176:177], v8 offset:53248
    ds_read_b64_tr_b16 a[178:179], v8 offset:54272
    ds_write_b128 v24, a[228:231] offset:1024
    v_mfma_f32_32x32x16_bf16 a[64:79], a[140:143], v[136:139], a[64:79]
    ds_read_b64_tr_b16 a[188:189], v9 offset:55296
    ds_read_b64_tr_b16 a[190:191], v9 offset:56320
    ds_write_b128 v24, a[232:235] offset:2048
    v_mfma_f32_32x32x16_bf16 a[80:95], a[252:255], v[108:111], a[80:95]
    buffer_load_dwordx4 v[220:223], v1, s[24:27], s66 offen offset:3072 sc1
    s_add_u32 s66, s66, 4096
    ds_read_b64_tr_b16 a[184:185], v8 offset:55296
    ds_read_b64_tr_b16 a[186:187], v8 offset:56320
    ds_write_b128 v24, a[236:239] offset:3072
    v_mfma_f32_32x32x16_bf16 a[80:95], a[116:119], v[116:119], a[80:95]
    ds_read_b64_tr_b16 a[196:197], v9 offset:28672
    ds_read_b64_tr_b16 a[198:199], v9 offset:29696
    v_mfma_f32_32x32x16_bf16 a[80:95], a[124:127], v[124:127], a[80:95]
    buffer_load_dwordx4 v[224:227], v1, s[24:27], s66 offen offset:0 sc1
    ds_read_b64_tr_b16 a[192:193], v8 offset:28672
    ds_read_b64_tr_b16 a[194:195], v8 offset:29696
    ds_write_b128 v25, a[64:67] offset:0
    v_mfma_f32_32x32x16_bf16 a[80:95], a[132:135], v[132:135], a[80:95]
    ds_read_b64_tr_b16 a[204:205], v9 offset:30720
    ds_read_b64_tr_b16 a[206:207], v9 offset:31744
    ds_write_b128 v25, a[68:71] offset:1024
    v_mfma_f32_32x32x16_bf16 a[80:95], a[140:143], v[140:143], a[80:95]
    buffer_load_dwordx4 v[228:231], v1, s[24:27], s66 offen offset:1024 sc1
    ds_read_b64_tr_b16 a[200:201], v8 offset:30720
    ds_read_b64_tr_b16 a[202:203], v8 offset:31744
    ds_write_b128 v25, a[72:75] offset:2048
    v_mfma_f32_32x32x16_bf16 v[144:159], a[248:251], v[104:107], v[144:159]
    ds_write_b128 v25, a[76:79] offset:3072
    v_mfma_f32_32x32x16_bf16 v[144:159], a[112:115], v[112:115], v[144:159]
    buffer_load_dwordx4 v[232:235], v1, s[24:27], s66 offen offset:2048 sc1
    v_mfma_f32_32x32x16_bf16 v[144:159], a[120:123], v[120:123], v[144:159]
    ds_write_b128 v26, a[80:83] offset:0
    v_mfma_f32_32x32x16_bf16 v[144:159], a[128:131], v[128:131], v[144:159]
    buffer_load_dwordx4 v[236:239], v1, s[24:27], s66 offen offset:3072 sc1
    ds_write_b128 v26, a[84:87] offset:1024
    v_mfma_f32_32x32x16_bf16 v[144:159], a[136:139], v[136:139], v[144:159]
    ds_write_b128 v26, a[88:91] offset:2048
    s_waitcnt vmcnt(14) lgkmcnt(15)
    v_mfma_f32_32x32x16_bf16 a[96:111], a[4:7], v[176:179], 0
    ds_write_b128 v26, a[92:95] offset:3072
    v_mfma_f32_32x32x16_bf16 a[96:111], a[12:15], v[180:183], a[96:111]
    s_waitcnt vmcnt(12)
    v_mfma_f32_32x32x16_bf16 a[96:111], a[20:23], v[184:187], a[96:111]
    v_mfma_f32_32x32x16_bf16 a[96:111], a[28:31], v[188:191], a[96:111]
    s_waitcnt lgkmcnt(0)
    s_barrier
    ds_read_b128 v[32:35], v5 offset:0
    ds_read_b128 v[48:51], v5 offset:4096
    s_waitcnt vmcnt(10)
    v_mfma_f32_32x32x16_bf16 a[96:111], a[36:39], v[192:195], a[96:111]
    ds_read_b128 v[64:67], v5 offset:8192
    ds_read_b128 v[36:39], v5 offset:1024
    v_mfma_f32_32x32x16_bf16 a[96:111], a[44:47], v[196:199], a[96:111]
    ds_read_b128 v[52:55], v5 offset:5120
    ds_read_b128 v[68:71], v5 offset:9216
    s_waitcnt vmcnt(8)
    v_mfma_f32_32x32x16_bf16 a[96:111], a[52:55], v[200:203], a[96:111]
    ds_read_b128 v[40:43], v5 offset:2048
    ds_read_b128 v[56:59], v5 offset:6144
    v_mfma_f32_32x32x16_bf16 a[96:111], a[60:63], v[204:207], a[96:111]
    ds_read_b128 v[72:75], v5 offset:10240
    ds_read_b128 v[44:47], v5 offset:3072
    s_waitcnt lgkmcnt(7)
    v_add_f32 v32, v32, v48
    v_add_f32 v33, v33, v49
    v_add_f32 v34, v34, v50
    s_waitcnt vmcnt(6)
    v_mfma_f32_32x32x16_bf16 a[96:111], a[148:151], v[208:211], a[96:111]
    ds_read_b128 v[60:63], v5 offset:7168
    ds_read_b128 v[76:79], v5 offset:11264
    v_add_f32 v35, v35, v51
    v_add_f32 v144, v144, v64
    v_add_f32 v145, v145, v65
    v_add_f32 v146, v146, v66
    v_add_f32 v147, v147, v67
    v_mfma_f32_32x32x16_bf16 a[96:111], a[156:159], v[212:215], a[96:111]
    v_add_f32 v144, v144, v32
    v_add_f32 v145, v145, v33
    v_add_f32 v146, v146, v34
    v_add_f32 v147, v147, v35
    v_exp_f32 v80, -v144
    s_waitcnt vmcnt(4)
    v_mfma_f32_32x32x16_bf16 a[96:111], a[164:167], v[216:219], a[96:111]
    v_exp_f32 v81, -v145
    v_exp_f32 v82, -v146
    v_exp_f32 v83, -v147
    v_add_f32 v80, 1.0, v80
    v_mfma_f32_32x32x16_bf16 a[96:111], a[172:175], v[220:223], a[96:111]
    v_add_f32 v81, 1.0, v81
    v_add_f32 v82, 1.0, v82
    v_add_f32 v83, 1.0, v83
    v_rcp_f32 v80, v80
    s_waitcnt vmcnt(2)
    v_mfma_f32_32x32x16_bf16 a[96:111], a[180:183], v[224:227], a[96:111]
    v_rcp_f32 v81, v81
    v_rcp_f32 v82, v82
    v_rcp_f32 v83, v83
    v_mul_f32 v144, v144, v80
    v_mfma_f32_32x32x16_bf16 a[96:111], a[188:191], v[228:231], a[96:111]
    v_mul_f32 v145, v145, v81
    v_mul_f32 v146, v146, v82
    v_mul_f32 v147, v147, v83
    s_waitcnt lgkmcnt(6)
    v_add_f32 v36, v36, v52
    v_add_f32 v37, v37, v53
    s_waitcnt vmcnt(0)
    v_mfma_f32_32x32x16_bf16 a[96:111], a[196:199], v[232:235], a[96:111]
    v_add_f32 v38, v38, v54
    v_add_f32 v39, v39, v55
    v_add_f32 v148, v148, v68
    v_add_f32 v149, v149, v69
    v_add_f32 v150, v150, v70
    v_add_f32 v151, v151, v71
    v_add_f32 v148, v148, v36
    v_mfma_f32_32x32x16_bf16 a[96:111], a[204:207], v[236:239], a[96:111]
    v_add_f32 v149, v149, v37
    v_add_f32 v150, v150, v38
    v_add_f32 v151, v151, v39
    v_exp_f32 v84, -v148
    v_exp_f32 v85, -v149
    v_mfma_f32_32x32x16_bf16 v[160:175], a[0:3], v[176:179], 0
    v_exp_f32 v86, -v150
    v_exp_f32 v87, -v151
    v_add_f32 v84, 1.0, v84
    v_add_f32 v85, 1.0, v85
    v_add_f32 v86, 1.0, v86
    v_mfma_f32_32x32x16_bf16 v[160:175], a[8:11], v[180:183], v[160:175]
    v_add_f32 v87, 1.0, v87
    v_rcp_f32 v84, v84
    v_rcp_f32 v85, v85
    v_rcp_f32 v86, v86
    v_mfma_f32_32x32x16_bf16 v[160:175], a[16:19], v[184:187], v[160:175]
    ds_write_b128 v6, a[96:99] offset:8192
    v_rcp_f32 v87, v87
    v_mfma_f32_32x32x16_bf16 v[160:175], a[24:27], v[188:191], v[160:175]
    ds_write_b128 v6, a[100:103] offset:9216
    v_mul_f32 v148, v148, v84
    v_mul_f32 v149, v149, v85
    v_mfma_f32_32x32x16_bf16 v[160:175], a[32:35], v[192:195], v[160:175]
    ds_write_b128 v6, a[104:107] offset:10240
    v_mul_f32 v150, v150, v86
    v_mul_f32 v151, v151, v87
    v_mfma_f32_32x32x16_bf16 v[160:175], a[40:43], v[196:199], v[160:175]
    ds_write_b128 v6, a[108:111] offset:11264
    s_waitcnt lgkmcnt(7)
    v_add_f32 v40, v40, v56
    v_add_f32 v41, v41, v57
    v_mfma_f32_32x32x16_bf16 v[160:175], a[48:51], v[200:203], v[160:175]
    v_add_f32 v42, v42, v58
    v_add_f32 v43, v43, v59
    v_add_f32 v152, v152, v72
    v_add_f32 v153, v153, v73
    v_add_f32 v154, v154, v74
    v_add_f32 v155, v155, v75
    v_add_f32 v152, v152, v40
    v_add_f32 v153, v153, v41
    v_mfma_f32_32x32x16_bf16 v[160:175], a[56:59], v[204:207], v[160:175]
    v_add_f32 v154, v154, v42
    v_add_f32 v155, v155, v43
    v_exp_f32 v88, -v152
    v_exp_f32 v89, -v153
    v_exp_f32 v90, -v154
    v_mfma_f32_32x32x16_bf16 v[160:175], a[144:147], v[208:211], v[160:175]
    s_waitcnt lgkmcnt(0)
    s_barrier
    ds_read_b128 v[96:99], v7 offset:8192
    ds_read_b128 v[100:103], v7 offset:9216
    v_exp_f32 v91, -v155
    v_add_f32 v88, 1.0, v88
    v_mfma_f32_32x32x16_bf16 v[160:175], a[152:155], v[212:215], v[160:175]
    ds_read_b128 v[104:107], v7 offset:10240
    ds_read_b128 v[108:111], v7 offset:11264
    v_add_f32 v89, 1.0, v89
    v_add_f32 v90, 1.0, v90
    v_add_f32 v91, 1.0, v91
    v_rcp_f32 v88, v88
    v_mfma_f32_32x32x16_bf16 v[160:175], a[160:163], v[216:219], v[160:175]
    v_rcp_f32 v89, v89
    v_rcp_f32 v90, v90
    v_rcp_f32 v91, v91
    v_mul_f32 v152, v152, v88
    v_mul_f32 v153, v153, v89
    v_mfma_f32_32x32x16_bf16 v[160:175], a[168:171], v[220:223], v[160:175]
    v_mul_f32 v154, v154, v90
    v_mul_f32 v155, v155, v91
    v_add_f32 v44, v44, v60
    v_add_f32 v45, v45, v61
    v_add_f32 v46, v46, v62
    v_add_f32 v47, v47, v63
    v_add_f32 v156, v156, v76
    v_mfma_f32_32x32x16_bf16 v[160:175], a[176:179], v[224:227], v[160:175]
    v_add_f32 v157, v157, v77
    v_add_f32 v158, v158, v78
    v_add_f32 v159, v159, v79
    v_add_f32 v156, v156, v44
    v_add_f32 v157, v157, v45
    v_add_f32 v158, v158, v46
    v_add_f32 v159, v159, v47
    v_mfma_f32_32x32x16_bf16 v[160:175], a[184:187], v[228:231], v[160:175]
    v_exp_f32 v92, -v156
    v_exp_f32 v93, -v157
    v_exp_f32 v94, -v158
    v_exp_f32 v95, -v159
    v_mfma_f32_32x32x16_bf16 v[160:175], a[192:195], v[232:235], v[160:175]
    v_add_f32 v92, 1.0, v92
    v_add_f32 v93, 1.0, v93
    v_add_f32 v94, 1.0, v94
    v_add_f32 v95, 1.0, v95
    v_rcp_f32 v92, v92
    v_rcp_f32 v93, v93
    v_mfma_f32_32x32x16_bf16 v[160:175], a[200:203], v[236:239], v[160:175]
    v_rcp_f32 v94, v94
    v_rcp_f32 v95, v95
    v_mul_f32 v156, v156, v92
    v_mul_f32 v157, v157, v93
    v_mul_f32 v158, v158, v94
    v_mul_f32 v159, v159, v95
    s_waitcnt lgkmcnt(3)
    v_fma_f32 v240, v96, v144, v240
    v_fma_f32 v241, v97, v145, v241
    v_fma_f32 v242, v98, v146, v242
    v_fma_f32 v243, v99, v147, v243
    s_waitcnt lgkmcnt(2)
    v_fma_f32 v244, v100, v148, v244
    v_fma_f32 v245, v101, v149, v245
    v_fma_f32 v246, v102, v150, v246
    v_fma_f32 v247, v103, v151, v247
    s_waitcnt lgkmcnt(1)
    v_fma_f32 v248, v104, v152, v248
    v_fma_f32 v249, v105, v153, v249
    v_fma_f32 v250, v106, v154, v250
    v_fma_f32 v251, v107, v155, v251
    s_waitcnt lgkmcnt(0)
    v_fma_f32 v252, v108, v156, v252
    v_fma_f32 v253, v109, v157, v253
    v_fma_f32 v254, v110, v158, v254
    v_fma_f32 v255, v111, v159, v255
    v_fma_f32 v160, v160, v144, v240
    v_fma_f32 v161, v161, v145, v241
    v_fma_f32 v162, v162, v146, v242
    v_fma_f32 v163, v163, v147, v243
    v_fma_f32 v164, v164, v148, v244
    v_fma_f32 v165, v165, v149, v245
    v_fma_f32 v166, v166, v150, v246
    v_fma_f32 v167, v167, v151, v247
    v_fma_f32 v168, v168, v152, v248
    v_fma_f32 v169, v169, v153, v249
    v_fma_f32 v170, v170, v154, v250
    v_fma_f32 v171, v171, v155, v251
    v_fma_f32 v172, v172, v156, v252
    v_fma_f32 v173, v173, v157, v253
    v_fma_f32 v174, v174, v158, v254
    v_fma_f32 v175, v175, v159, v255
    v_cvt_pk_bf16_f32 v160, v160, v161
    v_cvt_pk_bf16_f32 v161, v162, v163
    v_cvt_pk_bf16_f32 v162, v164, v165
    v_cvt_pk_bf16_f32 v163, v166, v167
    v_cvt_pk_bf16_f32 v164, v168, v169
    v_cvt_pk_bf16_f32 v165, v170, v171
    v_cvt_pk_bf16_f32 v166, v172, v173
    v_cvt_pk_bf16_f32 v167, v174, v175
    v_permlane32_swap_b32 v160, v162
    v_permlane32_swap_b32 v161, v163
    buffer_store_dwordx4 v[160:163], v27, s[16:19], s74 offen offset:0
    v_permlane32_swap_b32 v164, v166
    v_permlane32_swap_b32 v165, v167
    buffer_store_dwordx4 v[164:167], v27, s[16:19], s74 offen offset:32
    s_endpgm
    .p2align 12
L_Q:
    v_mov_b32 v248, 0
    v_mov_b32 v249, 0
    v_mov_b32 v250, 0
    v_mov_b32 v251, 0
    v_lshl_add_u32 v5, s55, 4, v2
    v_bfe_u32 v4, v0, 4, 1
    v_lshlrev_b32 v7, 4, v3
    v_lshlrev_b32 v6, 6, v4
    v_xor_b32 v6, v6, v7
    v_mul_u32_u24 v12, 2688, v5
    v_add_u32 v12, v12, v6
    v_add_u32 v13, 20480, v12
    s_mov_b32 s1, s54
    s_cmp_eq_u32 s53, 14
    s_cselect_b32 s59, 0, 640
    s_add_u32 s62, s59, 128
    s_add_u32 s59, s59, 2048
    s_cmp_eq_u32 s53, 14
    s_cselect_b32 s12, 384, 0
    s_cselect_b32 s13, 640, 0
    s_sub_u32 s12, s12, 128
    s_sub_u32 s13, s13, 384
    s_mul_i32 s73, s1, 172032
    s_add_u32 s66, s73, s59
    s_add_u32 s73, s73, s62
    s_add_u32 s1, s1, 1
    s_cmp_eq_u32 s1, 7
    s_cselect_b32 s1, 0, s1
    s_mul_i32 s74, s1, 172032
    s_add_u32 s67, s74, s59
    s_add_u32 s74, s74, s62
    s_add_u32 s1, s1, 1
    s_cmp_eq_u32 s1, 7
    s_cselect_b32 s1, 0, s1
    s_mul_i32 s75, s1, 172032
    s_add_u32 s68, s75, s59
    s_add_u32 s75, s75, s62
    s_add_u32 s1, s1, 1
    s_cmp_eq_u32 s1, 7
    s_cselect_b32 s1, 0, s1
    s_mul_i32 s76, s1, 172032
    s_add_u32 s69, s76, s59
    s_add_u32 s76, s76, s62
    s_add_u32 s1, s1, 1
    s_cmp_eq_u32 s1, 7
    s_cselect_b32 s1, 0, s1
    s_mul_i32 s77, s1, 172032
    s_waitcnt lgkmcnt(0)
    s_cmp_lg_u32 s2, 0
    s_cbranch_scc1 L_noclear
    buffer_store_dwordx4 v[248:251], v1, s[24:27], s99 offen offset:0 sc1
    buffer_store_dwordx4 v[248:251], v1, s[24:27], s99 offen offset:1024 sc1
    buffer_store_dwordx4 v[248:251], v1, s[24:27], s99 offen offset:2048 sc1
    buffer_store_dwordx4 v[248:251], v1, s[24:27], s99 offen offset:3072 sc1
L_noclear:
    buffer_load_dwordx4 v24, s[4:7], s28 offen offset:0 lds
    buffer_load_dwordx4 v25, s[4:7], s28 offen offset:1024 lds
    buffer_load_dwordx4 v26, s[4:7], s28 offen offset:2048 lds
    buffer_load_dwordx4 v27, s[4:7], s28 offen offset:3072 lds
    s_add_u32 m0, s80, 4096
    s_add_u32 s28, s28, 128
    s_cmp_eq_u32 s28, s29
    s_cselect_b32 s28, s30, s28
    s_add_u32 s70, s77, s59
    s_add_u32 s77, s77, s62
    s_add_u32 s1, s1, 1
    s_cmp_eq_u32 s1, 7
    s_cselect_b32 s1, 0, s1
    s_mul_i32 s78, s1, 172032
    s_add_u32 s71, s78, s59
    s_add_u32 s78, s78, s62
    s_add_u32 s1, s1, 1
    s_cmp_eq_u32 s1, 7
    s_cselect_b32 s1, 0, s1
    s_mul_i32 s79, s1, 172032
    s_add_u32 s72, s79, s59
    s_add_u32 s79, s79, s62
    buffer_load_dwordx4 v24, s[4:7], s28 offen offset:0 lds
    v_lshrrev_b32 v240, 5, v0
    v_bfe_u32 v241, v0, 4, 1
    v_bfe_u32 v242, v0, 2, 2
    v_and_b32 v243, 3, v0
    v_and_b32 v244, 31, v0
    v_bfe_u32 v245, v0, 3, 1
    v_lshlrev_b32 v246, 7, v242
    v_lshl_add_u32 v246, v243, 3, v246
    v_lshl_add_u32 v247, v245, 1, v241
    v_lshl_add_u32 v247, v247, 5, v246
    v_lshl_add_u32 v6, v240, 10, v247
    v_xor_b32 v7, 64, v6
    buffer_load_dwordx4 v25, s[4:7], s28 offen offset:1024 lds
    s_and_b32 s60, s53, 1
    s_lshl_b32 s60, s60, 6
    v_xor_b32 v2, s60, v6
    v_add_u32 v3, 49152, v6
    v_add_u32 v4, 49152, v7
    v_add_u32 v5, 49152, v2
    v_add_u32 v8, 106496, v6
    v_add_u32 v9, 106496, v7
    v_add_u32 v10, 106496, v2
    v_bfe_u32 v247, v0, 1, 3
    v_xor_b32 v247, v247, v240
    v_lshlrev_b32 v247, 4, v247
    buffer_load_dwordx4 v26, s[4:7], s28 offen offset:2048 lds
    v_lshl_add_u32 v18, v244, 7, v247
    v_add_u32 v18, s80, v18
    v_xor_b32 v19, 32, v18
    v_xor_b32 v20, 64, v18
    v_xor_b32 v21, 96, v18
    v_mov_b32 v247, 0x3f803f80
    v_accvgpr_write_b32 a248, v247
    v_accvgpr_write_b32 a249, v247
    s_sub_u32 s8, s36, 2048
    s_subb_u32 s9, s37, 0
    s_mov_b32 s10, 1206272
    s_mov_b32 s11, 0x20000
    s_mov_b32 s32, s50
    buffer_load_dwordx4 v27, s[4:7], s28 offen offset:3072 lds
    s_add_u32 m0, s80, 8192
    s_add_u32 s28, s28, 128
    s_cmp_eq_u32 s28, s29
    s_cselect_b32 s28, s30, s28
    s_mov_b32 s33, s51
    s_mul_i32 s61, s58, 86016
    s_add_u32 s61, s61, 65536
    s_cmp_eq_u32 s53, 14
    s_cselect_b32 s60, 0, 20480
    s_add_u32 s82, s61, s60
    s_cmp_eq_u32 s53, 14
    s_cselect_b32 s60, 16, 32
    s_lshl_b32 s60, s60, 9
    s_add_u32 s14, s61, s60
    s_cmp_eq_u32 s53, 14
    s_cselect_b32 s60, 24, 28
    s_lshl_b32 s60, s60, 9
    s_add_u32 s15, s61, s60
    s_lshl_b32 s41, s52, 7
    buffer_load_dwordx4 v24, s[4:7], s28 offen offset:0 lds
    s_add_u32 s44, s41, 2048
    s_mov_b32 s60, 56
    s_lshl2_add_u32 s43, s53, s55
    s_sub_u32 s60, s43, s60
    s_lshl_b32 s43, 1, s60
    s_min_u32 s60, s55, 2
    s_add_u32 s60, s60, s52
    s_max_u32 s60, s60, 2
    s_sub_u32 s60, s60, 2
    s_lshl_b32 s42, s60, 7
    s_lshr_b32 s60, s58, 1
    s_lshl_b32 s83, s60, 7
    buffer_load_dwordx4 v25, s[4:7], s28 offen offset:1024 lds
    s_and_b32 s60, s55, 1
    s_lshl1_add_u32 s60, s53, s60
    s_lshl_b32 s91, 1, s60
    s_mul_i32 s59, s53, 7
    s_lshr_b32 s59, s59, 1
    s_lshl_b32 s60, s59, 9
    s_add_u32 s60, s60, 28672
    s_add_u32 s87, s61, s60
    s_add_u32 s60, s60, 65536
    s_sub_u32 s85, s87, 688128
    s_add_u32 s88, s85, 28672
    s_waitcnt vmcnt(6)
    s_cmp_eq_u32 s99, 0
    s_cbranch_scc1 L_padQ1
    s_cmp_eq_u32 s99, 4096
    s_cbranch_scc1 L_padQ2
    s_cmp_eq_u32 s99, 8192
    s_cbranch_scc1 L_padQ3
    s_branch L_padQ4
L_retQa:
    ds_read_b128 v[36:39], v18 offset:0
    ds_read_b128 v[44:47], v19 offset:0
    ds_read_b128 v[52:55], v20 offset:0
    ds_read_b128 v[60:63], v21 offset:0
    buffer_load_dwordx4 v26, s[4:7], s28 offen offset:2048 lds
    s_cmp_lg_u32 s2, 0
    s_cbranch_scc1 L_nodbg
    s_lshr_b32 s3, s99, 12
    v_mov_b32 v254, s3
    v_mov_b32 v255, 1
    global_store_byte v254, v255, s[32:33] sc1
L_nodbg:
    s_cmp_ge_u32 s52, 2
    s_cselect_b32 s85, s85, s60
    s_cselect_b32 s88, s88, 268435456
    s_sub_u32 s86, s87, 344064
    s_add_u32 s89, s86, 28672
    s_cmp_ge_u32 s52, 1
    s_cselect_b32 s86, s86, s60
    s_cselect_b32 s89, s89, 268435456
    s_lshr_b32 s60, s59, 3
    s_lshl_b32 s60, s60, 2
    s_lshl_b32 s90, 15, s60
    s_add_u32 s60, s59, 3
    s_lshr_b32 s60, s60, 3
    s_lshl_b32 s60, s60, 2
    s_waitcnt lgkmcnt(3)
    v_mfma_f32_4x4x4_16b_bf16 a[0:3], a[248:249], v[36:37], 0
    buffer_load_dwordx4 v27, s[4:7], s28 offen offset:3072 lds
    s_add_u32 m0, s80, 12288
    s_add_u32 s28, s28, 128
    s_cmp_eq_u32 s28, s29
    s_cselect_b32 s28, s30, s28
    v_mfma_f32_4x4x4_16b_bf16 v[28:31], v[36:37], v[36:37], 0
    s_lshl_b32 s60, 15, s60
    s_or_b32 s90, s90, s60
    v_mfma_f32_4x4x4_16b_bf16 a[0:3], a[248:249], v[38:39], a[0:3]
    v_mfma_f32_4x4x4_16b_bf16 v[28:31], v[38:39], v[38:39], v[28:31]
    s_cmp_ge_u32 s53, 8
    s_cselect_b32 s96, 16, 1
    s_lshl_b32 s96, s96, s55
    s_waitcnt lgkmcnt(2)
    v_mfma_f32_4x4x4_16b_bf16 a[0:3], a[248:249], v[44:45], a[0:3]
    v_mfma_f32_4x4x4_16b_bf16 v[28:31], v[44:45], v[44:45], v[28:31]
    s_bitcmp1_b32 s53, 0
    s_cselect_b32 s92, -1, 0
    s_cselect_b32 s95, 0, -1
    s_mov_b32 s93, 0
    v_mfma_f32_4x4x4_16b_bf16 a[0:3], a[248:249], v[46:47], a[0:3]
    buffer_load_dwordx4 v24, s[4:7], s28 offen offset:0 lds
    v_mfma_f32_4x4x4_16b_bf16 v[28:31], v[46:47], v[46:47], v[28:31]
    s_mov_b32 s94, 0
    s_waitcnt lgkmcnt(1)
    v_mfma_f32_4x4x4_16b_bf16 a[0:3], a[248:249], v[52:53], a[0:3]
    v_mfma_f32_4x4x4_16b_bf16 v[28:31], v[52:53], v[52:53], v[28:31]
    s_lshl_b32 s98, s58, 15
    v_mfma_f32_4x4x4_16b_bf16 a[0:3], a[248:249], v[54:55], a[0:3]
    v_mfma_f32_4x4x4_16b_bf16 v[28:31], v[54:55], v[54:55], v[28:31]
    s_lshl_b32 s60, s53, 11
    s_waitcnt lgkmcnt(0)
    v_mfma_f32_4x4x4_16b_bf16 a[0:3], a[248:249], v[60:61], a[0:3]
    v_mfma_f32_4x4x4_16b_bf16 v[28:31], v[60:61], v[60:61], v[28:31]
    s_add_u32 s98, s98, s60
    buffer_load_dwordx4 v25, s[4:7], s28 offen offset:1024 lds
    v_mfma_f32_4x4x4_16b_bf16 a[0:3], a[248:249], v[62:63], a[0:3]
    v_mfma_f32_4x4x4_16b_bf16 v[28:31], v[62:63], v[62:63], v[28:31]
    s_add_u32 s98, s98, 14680064
    s_waitcnt vmcnt(6)
    ds_read_b128 v[68:71], v18 offset:4096
    ds_read_b128 v[76:79], v19 offset:4096
    ds_read_b128 v[84:87], v20 offset:4096
    ds_read_b128 v[92:95], v21 offset:4096
    v_lshlrev_b32 v32, 16, v36
    v_and_b32 v33, 0xffff0000, v36
    v_lshlrev_b32 v34, 16, v37
    v_and_b32 v35, 0xffff0000, v37
    v_lshlrev_b32 v36, 16, v38
    buffer_load_dwordx4 v26, s[4:7], s28 offen offset:2048 lds
    v_and_b32 v37, 0xffff0000, v38
    v_lshlrev_b32 v38, 16, v39
    v_and_b32 v39, 0xffff0000, v39
    v_lshlrev_b32 v40, 16, v44
    v_and_b32 v41, 0xffff0000, v44
    s_waitcnt lgkmcnt(3)
    v_mfma_f32_4x4x4_16b_bf16 a[0:3], a[248:249], v[68:69], a[0:3]
    v_mfma_f32_4x4x4_16b_bf16 v[28:31], v[68:69], v[68:69], v[28:31]
    v_lshlrev_b32 v42, 16, v45
    v_and_b32 v43, 0xffff0000, v45
    v_lshlrev_b32 v44, 16, v46
    v_mfma_f32_4x4x4_16b_bf16 a[0:3], a[248:249], v[70:71], a[0:3]
    v_mfma_f32_4x4x4_16b_bf16 v[28:31], v[70:71], v[70:71], v[28:31]
    buffer_load_dwordx4 v27, s[4:7], s28 offen offset:3072 lds
    s_add_u32 m0, s80, 16384
    s_add_u32 s28, s28, 128
    s_cmp_eq_u32 s28, s29
    s_cselect_b32 s28, s30, s28
    v_and_b32 v45, 0xffff0000, v46
    v_lshlrev_b32 v46, 16, v47
    v_and_b32 v47, 0xffff0000, v47
    s_waitcnt lgkmcnt(2)
    v_mfma_f32_4x4x4_16b_bf16 a[0:3], a[248:249], v[76:77], a[0:3]
    v_mfma_f32_4x4x4_16b_bf16 v[28:31], v[76:77], v[76:77], v[28:31]
    v_lshlrev_b32 v48, 16, v52
    v_and_b32 v49, 0xffff0000, v52
    v_lshlrev_b32 v50, 16, v53
    v_mfma_f32_4x4x4_16b_bf16 a[0:3], a[248:249], v[78:79], a[0:3]
    v_mfma_f32_4x4x4_16b_bf16 v[28:31], v[78:79], v[78:79], v[28:31]
    v_and_b32 v51, 0xffff0000, v53
    v_lshlrev_b32 v52, 16, v54
    buffer_load_dwordx4 v24, s[4:7], s28 offen offset:0 lds
    v_and_b32 v53, 0xffff0000, v54
    s_waitcnt lgkmcnt(1)
    v_mfma_f32_4x4x4_16b_bf16 a[0:3], a[248:249], v[84:85], a[0:3]
    v_mfma_f32_4x4x4_16b_bf16 v[28:31], v[84:85], v[84:85], v[28:31]
    v_lshlrev_b32 v54, 16, v55
    v_and_b32 v55, 0xffff0000, v55
    v_lshlrev_b32 v56, 16, v60
    v_mfma_f32_4x4x4_16b_bf16 a[0:3], a[248:249], v[86:87], a[0:3]
    v_mfma_f32_4x4x4_16b_bf16 v[28:31], v[86:87], v[86:87], v[28:31]
    v_and_b32 v57, 0xffff0000, v60
    v_lshlrev_b32 v58, 16, v61
    v_and_b32 v59, 0xffff0000, v61
    s_waitcnt lgkmcnt(0)
    buffer_load_dwordx4 v25, s[4:7], s28 offen offset:1024 lds
    v_mfma_f32_4x4x4_16b_bf16 a[0:3], a[248:249], v[92:93], a[0:3]
    v_mfma_f32_4x4x4_16b_bf16 v[28:31], v[92:93], v[92:93], v[28:31]
    v_lshlrev_b32 v60, 16, v62
    v_and_b32 v61, 0xffff0000, v62
    v_mfma_f32_4x4x4_16b_bf16 a[0:3], a[248:249], v[94:95], a[0:3]
    v_mfma_f32_4x4x4_16b_bf16 v[28:31], v[94:95], v[94:95], v[28:31]
    v_lshlrev_b32 v62, 16, v63
    v_and_b32 v63, 0xffff0000, v63
    s_waitcnt vmcnt(6)
    ds_read_b128 v[100:103], v18 offset:8192
    ds_read_b128 v[108:111], v19 offset:8192
    ds_read_b128 v[116:119], v20 offset:8192
    ds_read_b128 v[124:127], v21 offset:8192
    buffer_load_dwordx4 v26, s[4:7], s28 offen offset:2048 lds
    v_lshlrev_b32 v64, 16, v68
    v_and_b32 v65, 0xffff0000, v68
    v_lshlrev_b32 v66, 16, v69
    v_and_b32 v67, 0xffff0000, v69
    v_lshlrev_b32 v68, 16, v70
    v_and_b32 v69, 0xffff0000, v70
    v_lshlrev_b32 v70, 16, v71
    v_and_b32 v71, 0xffff0000, v71
    v_lshlrev_b32 v72, 16, v76
    v_and_b32 v73, 0xffff0000, v76
    s_waitcnt lgkmcnt(3)
    v_mfma_f32_4x4x4_16b_bf16 a[0:3], a[248:249], v[100:101], a[0:3]
    v_mfma_f32_4x4x4_16b_bf16 v[28:31], v[100:101], v[100:101], v[28:31]
    buffer_load_dwordx4 v27, s[4:7], s28 offen offset:3072 lds
    s_add_u32 m0, s80, 20480
    s_add_u32 s28, s28, 128
    s_cmp_eq_u32 s28, s29
    s_cselect_b32 s28, s30, s28
    v_lshlrev_b32 v74, 16, v77
    v_and_b32 v75, 0xffff0000, v77
    v_lshlrev_b32 v76, 16, v78
    v_mfma_f32_4x4x4_16b_bf16 a[0:3], a[248:249], v[102:103], a[0:3]
    v_mfma_f32_4x4x4_16b_bf16 v[28:31], v[102:103], v[102:103], v[28:31]
    v_and_b32 v77, 0xffff0000, v78
    v_lshlrev_b32 v78, 16, v79
    v_and_b32 v79, 0xffff0000, v79
    s_waitcnt lgkmcnt(2)
    v_mfma_f32_4x4x4_16b_bf16 a[0:3], a[248:249], v[108:109], a[0:3]
    v_mfma_f32_4x4x4_16b_bf16 v[28:31], v[108:109], v[108:109], v[28:31]
    v_lshlrev_b32 v80, 16, v84
    v_and_b32 v81, 0xffff0000, v84
    buffer_load_dwordx4 v24, s[4:7], s28 offen offset:0 lds
    v_lshlrev_b32 v82, 16, v85
    v_mfma_f32_4x4x4_16b_bf16 a[0:3], a[248:249], v[110:111], a[0:3]
    v_mfma_f32_4x4x4_16b_bf16 v[28:31], v[110:111], v[110:111], v[28:31]
    v_and_b32 v83, 0xffff0000, v85
    v_lshlrev_b32 v84, 16, v86
    v_and_b32 v85, 0xffff0000, v86
    s_waitcnt lgkmcnt(1)
    v_mfma_f32_4x4x4_16b_bf16 a[0:3], a[248:249], v[116:117], a[0:3]
    v_mfma_f32_4x4x4_16b_bf16 v[28:31], v[116:117], v[116:117], v[28:31]
    v_lshlrev_b32 v86, 16, v87
    v_and_b32 v87, 0xffff0000, v87
    v_lshlrev_b32 v88, 16, v92
    v_mfma_f32_4x4x4_16b_bf16 a[0:3], a[248:249], v[118:119], a[0:3]
    buffer_load_dwordx4 v25, s[4:7], s28 offen offset:1024 lds
    v_mfma_f32_4x4x4_16b_bf16 v[28:31], v[118:119], v[118:119], v[28:31]
    v_and_b32 v89, 0xffff0000, v92
    v_lshlrev_b32 v90, 16, v93
    v_and_b32 v91, 0xffff0000, v93
    s_waitcnt lgkmcnt(0)
    v_mfma_f32_4x4x4_16b_bf16 a[0:3], a[248:249], v[124:125], a[0:3]
    v_mfma_f32_4x4x4_16b_bf16 v[28:31], v[124:125], v[124:125], v[28:31]
    v_lshlrev_b32 v92, 16, v94
    v_and_b32 v93, 0xffff0000, v94
    v_mfma_f32_4x4x4_16b_bf16 a[0:3], a[248:249], v[126:127], a[0:3]
    v_mfma_f32_4x4x4_16b_bf16 v[28:31], v[126:127], v[126:127], v[28:31]
    v_lshlrev_b32 v94, 16, v95
    v_and_b32 v95, 0xffff0000, v95
    buffer_load_dwordx4 v26, s[4:7], s28 offen offset:2048 lds
    s_waitcnt vmcnt(7)
    ds_read_b128 v[132:135], v18 offset:12288
    ds_read_b128 v[140:143], v19 offset:12288
    ds_read_b128 v[148:151], v20 offset:12288
    ds_read_b128 v[156:159], v21 offset:12288
    v_lshlrev_b32 v96, 16, v100
    v_and_b32 v97, 0xffff0000, v100
    v_lshlrev_b32 v98, 16, v101
    v_and_b32 v99, 0xffff0000, v101
    v_lshlrev_b32 v100, 16, v102
    v_and_b32 v101, 0xffff0000, v102
    v_lshlrev_b32 v102, 16, v103
    v_and_b32 v103, 0xffff0000, v103
    buffer_load_dwordx4 v27, s[4:7], s28 offen offset:3072 lds
    s_add_u32 m0, s80, 24576
    s_add_u32 s28, s28, 128
    s_cmp_eq_u32 s28, s29
    s_cselect_b32 s28, s30, s28
    v_lshlrev_b32 v104, 16, v108
    v_and_b32 v105, 0xffff0000, v108
    s_waitcnt lgkmcnt(3)
    v_mfma_f32_4x4x4_16b_bf16 a[0:3], a[248:249], v[132:133], a[0:3]
    v_mfma_f32_4x4x4_16b_bf16 v[28:31], v[132:133], v[132:133], v[28:31]
    v_lshlrev_b32 v106, 16, v109
    v_and_b32 v107, 0xffff0000, v109
    v_lshlrev_b32 v108, 16, v110
    v_mfma_f32_4x4x4_16b_bf16 a[0:3], a[248:249], v[134:135], a[0:3]
    v_mfma_f32_4x4x4_16b_bf16 v[28:31], v[134:135], v[134:135], v[28:31]
    v_and_b32 v109, 0xffff0000, v110
    v_lshlrev_b32 v110, 16, v111
    v_and_b32 v111, 0xffff0000, v111
    buffer_load_dwordx4 v24, s[4:7], s28 offen offset:0 lds
    s_waitcnt lgkmcnt(2)
    v_mfma_f32_4x4x4_16b_bf16 a[0:3], a[248:249], v[140:141], a[0:3]
    v_mfma_f32_4x4x4_16b_bf16 v[28:31], v[140:141], v[140:141], v[28:31]
    v_lshlrev_b32 v112, 16, v116
    v_and_b32 v113, 0xffff0000, v116
    v_lshlrev_b32 v114, 16, v117
    v_mfma_f32_4x4x4_16b_bf16 a[0:3], a[248:249], v[142:143], a[0:3]
    v_mfma_f32_4x4x4_16b_bf16 v[28:31], v[142:143], v[142:143], v[28:31]
    v_and_b32 v115, 0xffff0000, v117
    v_lshlrev_b32 v116, 16, v118
    v_and_b32 v117, 0xffff0000, v118
    s_waitcnt lgkmcnt(1)
    v_mfma_f32_4x4x4_16b_bf16 a[0:3], a[248:249], v[148:149], a[0:3]
    buffer_load_dwordx4 v25, s[4:7], s28 offen offset:1024 lds
    v_mfma_f32_4x4x4_16b_bf16 v[28:31], v[148:149], v[148:149], v[28:31]
    v_lshlrev_b32 v118, 16, v119
    v_and_b32 v119, 0xffff0000, v119
    v_lshlrev_b32 v120, 16, v124
    v_mfma_f32_4x4x4_16b_bf16 a[0:3], a[248:249], v[150:151], a[0:3]
    v_mfma_f32_4x4x4_16b_bf16 v[28:31], v[150:151], v[150:151], v[28:31]
    v_and_b32 v121, 0xffff0000, v124
    v_lshlrev_b32 v122, 16, v125
    v_and_b32 v123, 0xffff0000, v125
    s_waitcnt lgkmcnt(0)
    v_mfma_f32_4x4x4_16b_bf16 a[0:3], a[248:249], v[156:157], a[0:3]
    v_mfma_f32_4x4x4_16b_bf16 v[28:31], v[156:157], v[156:157], v[28:31]
    v_lshlrev_b32 v124, 16, v126
    buffer_load_dwordx4 v26, s[4:7], s28 offen offset:2048 lds
    v_and_b32 v125, 0xffff0000, v126
    v_mfma_f32_4x4x4_16b_bf16 a[0:3], a[248:249], v[158:159], a[0:3]
    v_mfma_f32_4x4x4_16b_bf16 v[28:31], v[158:159], v[158:159], v[28:31]
    v_lshlrev_b32 v126, 16, v127
    v_and_b32 v127, 0xffff0000, v127
    s_waitcnt vmcnt(7)
    ds_read_b128 v[164:167], v18 offset:16384
    ds_read_b128 v[172:175], v19 offset:16384
    ds_read_b128 v[180:183], v20 offset:16384
    ds_read_b128 v[188:191], v21 offset:16384
    v_lshlrev_b32 v128, 16, v132
    v_and_b32 v129, 0xffff0000, v132
    v_lshlrev_b32 v130, 16, v133
    buffer_load_dwordx4 v27, s[4:7], s28 offen offset:3072 lds
    s_add_u32 m0, s99, 0
    v_and_b32 v131, 0xffff0000, v133
    v_lshlrev_b32 v132, 16, v134
    v_and_b32 v133, 0xffff0000, v134
    v_lshlrev_b32 v134, 16, v135
    v_and_b32 v135, 0xffff0000, v135
    v_lshlrev_b32 v136, 16, v140
    v_and_b32 v137, 0xffff0000, v140
    s_waitcnt lgkmcnt(3)
    v_mfma_f32_4x4x4_16b_bf16 a[0:3], a[248:249], v[164:165], a[0:3]
    v_mfma_f32_4x4x4_16b_bf16 v[28:31], v[164:165], v[164:165], v[28:31]
    v_lshlrev_b32 v138, 16, v141
    v_and_b32 v139, 0xffff0000, v141
    v_lshlrev_b32 v140, 16, v142
    buffer_load_dwordx4 v12, s[8:11], s66 offen offset:0 lds
    v_mfma_f32_4x4x4_16b_bf16 a[0:3], a[248:249], v[166:167], a[0:3]
    v_mfma_f32_4x4x4_16b_bf16 v[28:31], v[166:167], v[166:167], v[28:31]
    v_and_b32 v141, 0xffff0000, v142
    v_lshlrev_b32 v142, 16, v143
    v_and_b32 v143, 0xffff0000, v143
    s_waitcnt lgkmcnt(2)
    v_mfma_f32_4x4x4_16b_bf16 a[0:3], a[248:249], v[172:173], a[0:3]
    v_mfma_f32_4x4x4_16b_bf16 v[28:31], v[172:173], v[172:173], v[28:31]
    v_lshlrev_b32 v144, 16, v148
    v_and_b32 v145, 0xffff0000, v148
    v_lshlrev_b32 v146, 16, v149
    v_mfma_f32_4x4x4_16b_bf16 a[0:3], a[248:249], v[174:175], a[0:3]
    v_mfma_f32_4x4x4_16b_bf16 v[28:31], v[174:175], v[174:175], v[28:31]
    buffer_load_dwordx4 v13, s[8:11], s66 offen offset:1024 lds
    v_and_b32 v147, 0xffff0000, v149
    v_lshlrev_b32 v148, 16, v150
    v_and_b32 v149, 0xffff0000, v150
    s_waitcnt lgkmcnt(1)
    v_mfma_f32_4x4x4_16b_bf16 a[0:3], a[248:249], v[180:181], a[0:3]
    v_mfma_f32_4x4x4_16b_bf16 v[28:31], v[180:181], v[180:181], v[28:31]
    v_lshlrev_b32 v150, 16, v151
    v_and_b32 v151, 0xffff0000, v151
    v_lshlrev_b32 v152, 16, v156
    v_mfma_f32_4x4x4_16b_bf16 a[0:3], a[248:249], v[182:183], a[0:3]
    v_mfma_f32_4x4x4_16b_bf16 v[28:31], v[182:183], v[182:183], v[28:31]
    v_and_b32 v153, 0xffff0000, v156
    v_lshlrev_b32 v154, 16, v157
    buffer_load_dwordx4 v12, s[8:11], s73 offen offset:2048 lds
    v_and_b32 v155, 0xffff0000, v157
    s_waitcnt lgkmcnt(0)
    v_mfma_f32_4x4x4_16b_bf16 a[0:3], a[248:249], v[188:189], a[0:3]
    v_mfma_f32_4x4x4_16b_bf16 v[28:31], v[188:189], v[188:189], v[28:31]
    v_lshlrev_b32 v156, 16, v158
    v_and_b32 v157, 0xffff0000, v158
    v_mfma_f32_4x4x4_16b_bf16 a[0:3], a[248:249], v[190:191], a[0:3]
    v_mfma_f32_4x4x4_16b_bf16 v[28:31], v[190:191], v[190:191], v[28:31]
    v_lshlrev_b32 v158, 16, v159
    v_and_b32 v159, 0xffff0000, v159
    s_waitcnt vmcnt(7)
    ds_read_b128 v[196:199], v18 offset:20480
    ds_read_b128 v[204:207], v19 offset:20480
    buffer_load_dwordx4 v13, s[8:11], s73 offen offset:3072 lds
    s_add_u32 s66, s66, s12
    s_add_u32 s73, s73, s13
    s_add_u32 m0, s99, 16384
    ds_read_b128 v[212:215], v20 offset:20480
    ds_read_b128 v[220:223], v21 offset:20480
    v_lshlrev_b32 v160, 16, v164
    v_and_b32 v161, 0xffff0000, v164
    v_lshlrev_b32 v162, 16, v165
    v_and_b32 v163, 0xffff0000, v165
    v_lshlrev_b32 v164, 16, v166
    v_and_b32 v165, 0xffff0000, v166
    v_lshlrev_b32 v166, 16, v167
    v_and_b32 v167, 0xffff0000, v167
    v_lshlrev_b32 v168, 16, v172
    v_and_b32 v169, 0xffff0000, v172
    s_waitcnt lgkmcnt(3)
    buffer_load_dwordx4 v12, s[8:11], s67 offen offset:0 lds
    v_mfma_f32_4x4x4_16b_bf16 a[0:3], a[248:249], v[196:197], a[0:3]
    v_mfma_f32_4x4x4_16b_bf16 v[28:31], v[196:197], v[196:197], v[28:31]
    v_lshlrev_b32 v170, 16, v173
    v_and_b32 v171, 0xffff0000, v173
    v_lshlrev_b32 v172, 16, v174
    v_mfma_f32_4x4x4_16b_bf16 a[0:3], a[248:249], v[198:199], a[0:3]
    v_mfma_f32_4x4x4_16b_bf16 v[28:31], v[198:199], v[198:199], v[28:31]
    v_and_b32 v173, 0xffff0000, v174
    v_lshlrev_b32 v174, 16, v175
    v_and_b32 v175, 0xffff0000, v175
    s_waitcnt lgkmcnt(2)
    v_mfma_f32_4x4x4_16b_bf16 a[0:3], a[248:249], v[204:205], a[0:3]
    v_mfma_f32_4x4x4_16b_bf16 v[28:31], v[204:205], v[204:205], v[28:31]
    buffer_load_dwordx4 v13, s[8:11], s67 offen offset:1024 lds
    v_lshlrev_b32 v176, 16, v180
    v_and_b32 v177, 0xffff0000, v180
    v_lshlrev_b32 v178, 16, v181
    v_mfma_f32_4x4x4_16b_bf16 a[0:3], a[248:249], v[206:207], a[0:3]
    v_mfma_f32_4x4x4_16b_bf16 v[28:31], v[206:207], v[206:207], v[28:31]
    v_and_b32 v179, 0xffff0000, v181
    v_lshlrev_b32 v180, 16, v182
    v_and_b32 v181, 0xffff0000, v182
    s_waitcnt lgkmcnt(1)
    v_mfma_f32_4x4x4_16b_bf16 a[0:3], a[248:249], v[212:213], a[0:3]
    v_mfma_f32_4x4x4_16b_bf16 v[28:31], v[212:213], v[212:213], v[28:31]
    v_lshlrev_b32 v182, 16, v183
    v_and_b32 v183, 0xffff0000, v183
    buffer_load_dwordx4 v12, s[8:11], s74 offen offset:2048 lds
    v_lshlrev_b32 v184, 16, v188
    v_mfma_f32_4x4x4_16b_bf16 a[0:3], a[248:249], v[214:215], a[0:3]
    v_mfma_f32_4x4x4_16b_bf16 v[28:31], v[214:215], v[214:215], v[28:31]
    v_and_b32 v185, 0xffff0000, v188
    v_lshlrev_b32 v186, 16, v189
    v_and_b32 v187, 0xffff0000, v189
    s_waitcnt lgkmcnt(0)
    v_mfma_f32_4x4x4_16b_bf16 a[0:3], a[248:249], v[220:221], a[0:3]
    v_mfma_f32_4x4x4_16b_bf16 v[28:31], v[220:221], v[220:221], v[28:31]
    v_lshlrev_b32 v188, 16, v190
    v_and_b32 v189, 0xffff0000, v190
    v_mfma_f32_4x4x4_16b_bf16 a[0:3], a[248:249], v[222:223], a[0:3]
    v_mfma_f32_4x4x4_16b_bf16 v[28:31], v[222:223], v[222:223], v[28:31]
    buffer_load_dwordx4 v13, s[8:11], s74 offen offset:3072 lds
    s_add_u32 s67, s67, s12
    s_add_u32 s74, s74, s13
    s_add_u32 m0, s99, 32768
    v_lshlrev_b32 v190, 16, v191
    v_and_b32 v191, 0xffff0000, v191
    s_waitcnt vmcnt(8)
    ds_read_b128 v[228:231], v18 offset:24576
    ds_read_b128 v[236:239], v19 offset:24576
    ds_read_b128 v[244:247], v20 offset:24576
    ds_read_b128 v[252:255], v21 offset:24576
    v_lshlrev_b32 v192, 16, v196
    v_and_b32 v193, 0xffff0000, v196
    v_lshlrev_b32 v194, 16, v197
    v_and_b32 v195, 0xffff0000, v197
    v_lshlrev_b32 v196, 16, v198
    v_and_b32 v197, 0xffff0000, v198
    buffer_load_dwordx4 v12, s[8:11], s68 offen offset:0 lds
    v_lshlrev_b32 v198, 16, v199
    v_and_b32 v199, 0xffff0000, v199
    v_lshlrev_b32 v200, 16, v204
    v_and_b32 v201, 0xffff0000, v204
    s_waitcnt lgkmcnt(3)
    v_mfma_f32_4x4x4_16b_bf16 a[0:3], a[248:249], v[228:229], a[0:3]
    v_mfma_f32_4x4x4_16b_bf16 v[28:31], v[228:229], v[228:229], v[28:31]
    v_lshlrev_b32 v202, 16, v205
    v_and_b32 v203, 0xffff0000, v205
    v_lshlrev_b32 v204, 16, v206
    v_mfma_f32_4x4x4_16b_bf16 a[0:3], a[248:249], v[230:231], a[0:3]
    v_mfma_f32_4x4x4_16b_bf16 v[28:31], v[230:231], v[230:231], v[28:31]
    v_and_b32 v205, 0xffff0000, v206
    buffer_load_dwordx4 v13, s[8:11], s68 offen offset:1024 lds
    v_lshlrev_b32 v206, 16, v207
    v_and_b32 v207, 0xffff0000, v207
    s_waitcnt lgkmcnt(2)
    v_mfma_f32_4x4x4_16b_bf16 a[0:3], a[248:249], v[236:237], a[0:3]
    v_mfma_f32_4x4x4_16b_bf16 v[28:31], v[236:237], v[236:237], v[28:31]
    v_lshlrev_b32 v208, 16, v212
    v_and_b32 v209, 0xffff0000, v212
    v_lshlrev_b32 v210, 16, v213
    v_mfma_f32_4x4x4_16b_bf16 a[0:3], a[248:249], v[238:239], a[0:3]
    v_mfma_f32_4x4x4_16b_bf16 v[28:31], v[238:239], v[238:239], v[28:31]
    v_and_b32 v211, 0xffff0000, v213
    v_lshlrev_b32 v212, 16, v214
    v_and_b32 v213, 0xffff0000, v214
    buffer_load_dwordx4 v12, s[8:11], s75 offen offset:2048 lds
    s_waitcnt lgkmcnt(1)
    v_mfma_f32_4x4x4_16b_bf16 a[0:3], a[248:249], v[244:245], a[0:3]
    v_mfma_f32_4x4x4_16b_bf16 v[28:31], v[244:245], v[244:245], v[28:31]
    v_lshlrev_b32 v214, 16, v215
    v_and_b32 v215, 0xffff0000, v215
    v_lshlrev_b32 v216, 16, v220
    v_mfma_f32_4x4x4_16b_bf16 a[0:3], a[248:249], v[246:247], a[0:3]
    v_mfma_f32_4x4x4_16b_bf16 v[28:31], v[246:247], v[246:247], v[28:31]
    v_and_b32 v217, 0xffff0000, v220
    v_lshlrev_b32 v218, 16, v221
    v_and_b32 v219, 0xffff0000, v221
    s_waitcnt lgkmcnt(0)
    v_mfma_f32_4x4x4_16b_bf16 a[0:3], a[248:249], v[252:253], a[0:3]
    buffer_load_dwordx4 v13, s[8:11], s75 offen offset:3072 lds
    s_add_u32 s68, s68, s12
    s_add_u32 s75, s75, s13
    s_add_u32 m0, s80, 0
    v_mfma_f32_4x4x4_16b_bf16 v[28:31], v[252:253], v[252:253], v[28:31]
    v_lshlrev_b32 v220, 16, v222
    v_and_b32 v221, 0xffff0000, v222
    v_mfma_f32_4x4x4_16b_bf16 a[0:3], a[248:249], v[254:255], a[0:3]
    v_mfma_f32_4x4x4_16b_bf16 v[28:31], v[254:255], v[254:255], v[28:31]
    v_lshlrev_b32 v222, 16, v223
    v_and_b32 v223, 0xffff0000, v223
    s_waitcnt vmcnt(8)
    s_barrier
    ds_read_b64_tr_b16 a[64:65], v6 offset:0
    ds_read_b64_tr_b16 a[66:67], v6 offset:512
    ds_read_b64_tr_b16 a[68:69], v7 offset:0
    ds_read_b64_tr_b16 a[70:71], v7 offset:512
    buffer_load_dwordx4 v12, s[8:11], s69 offen offset:0 lds
    ds_read_b64_tr_b16 a[72:73], v6 offset:2048
    ds_read_b64_tr_b16 a[74:75], v6 offset:2560
    ds_read_b64_tr_b16 a[76:77], v7 offset:2048
    ds_read_b64_tr_b16 a[78:79], v7 offset:2560
    ds_read_b64_tr_b16 a[80:81], v6 offset:4096
    ds_read_b64_tr_b16 a[82:83], v6 offset:4608
    ds_read_b64_tr_b16 a[84:85], v7 offset:4096
    ds_read_b64_tr_b16 a[86:87], v7 offset:4608
    ds_read_b64_tr_b16 a[88:89], v6 offset:6144
    ds_read_b64_tr_b16 a[90:91], v6 offset:6656
    ds_read_b64_tr_b16 a[92:93], v7 offset:6144
    ds_read_b64_tr_b16 a[94:95], v7 offset:6656
    s_mov_b32 vcc_lo, 0xaaaaaaaa
    buffer_load_dwordx4 v13, s[8:11], s69 offen offset:1024 lds
    s_mov_b32 vcc_hi, 0xaaaaaaaa
    s_mov_b32 s2, 0xcccccccc
    s_mov_b32 s3, 0xcccccccc
    v_cndmask_b32 v28, v28, v29, vcc
    v_cndmask_b32 v30, v30, v31, vcc
    s_branch L_overQ1
    .p2align 12
L_padQ1:
    s_branch L_retQa
L_overQ1:
    v_accvgpr_read_b32 v24, a0
    v_accvgpr_read_b32 v25, a0
    v_cndmask_b32 v28, v28, v30, s[2:3]
    v_lshlrev_b32 v224, 16, v228
    v_mov_b32 v29, v28
    v_permlane32_swap_b32 v24, v25
    v_and_b32 v225, 0xffff0000, v228
    v_permlane32_swap_b32 v28, v29
    buffer_load_dwordx4 v12, s[8:11], s76 offen offset:2048 lds
    v_add_f32 v24, v24, v25
    v_add_f32 v28, v28, v29
    v_mul_f32 v24, 0xbb124925, v24
    v_mul_f32 v28, 0x3b124925, v28
    v_fma_f32 v28, -v24, v24, v28
    v_max_f32 v28, 0, v28
    v_add_f32 v28, 0x3727c5ac, v28
    v_rsq_f32 v28, v28
    v_lshlrev_b32 v226, 16, v229
    v_mul_f32 v18, 0x3fb8aa3b, v28
    v_mul_f32 v19, v24, v18
    v_fma_f32 v32, v32, v18, v19
    v_fma_f32 v33, v33, v18, v19
    buffer_load_dwordx4 v13, s[8:11], s76 offen offset:3072 lds
    s_add_u32 s69, s69, s12
    s_add_u32 s76, s76, s13
    v_fma_f32 v34, v34, v18, v19
    v_fma_f32 v35, v35, v18, v19
    v_fma_f32 v36, v36, v18, v19
    v_fma_f32 v37, v37, v18, v19
    v_fma_f32 v38, v38, v18, v19
    v_fma_f32 v39, v39, v18, v19
    v_cvt_pk_bf16_f32 v32, v32, v33
    v_cvt_pk_bf16_f32 v33, v34, v35
    v_cvt_pk_bf16_f32 v34, v36, v37
    v_cvt_pk_bf16_f32 v35, v38, v39
    v_fma_f32 v40, v40, v18, v19
    v_fma_f32 v41, v41, v18, v19
    v_fma_f32 v42, v42, v18, v19
    v_fma_f32 v43, v43, v18, v19
    v_fma_f32 v44, v44, v18, v19
    v_fma_f32 v45, v45, v18, v19
    v_fma_f32 v46, v46, v18, v19
    v_fma_f32 v47, v47, v18, v19
    v_cvt_pk_bf16_f32 v36, v40, v41
    v_cvt_pk_bf16_f32 v37, v42, v43
    v_cvt_pk_bf16_f32 v38, v44, v45
    v_cvt_pk_bf16_f32 v39, v46, v47
    s_waitcnt lgkmcnt(8)
    v_mfma_f32_32x32x16_bf16 a[0:15], a[64:67], v[32:35], 0
    ds_read_b64_tr_b16 a[96:97], v6 offset:8192
    ds_read_b64_tr_b16 a[98:99], v6 offset:8704
    s_add_u32 m0, s80, 4096
    s_nop 0
    buffer_load_dwordx4 v12, s[8:11], s70 offen offset:0 lds
    v_fma_f32 v48, v48, v18, v19
    v_mfma_f32_32x32x16_bf16 a[16:31], a[68:71], v[32:35], 0
    ds_read_b64_tr_b16 a[100:101], v7 offset:8192
    ds_read_b64_tr_b16 a[102:103], v7 offset:8704
    v_fma_f32 v49, v49, v18, v19
    v_fma_f32 v50, v50, v18, v19
    v_fma_f32 v51, v51, v18, v19
    v_fma_f32 v52, v52, v18, v19
    v_mfma_f32_32x32x16_bf16 a[32:47], a[72:75], v[32:35], 0
    ds_read_b64_tr_b16 a[104:105], v6 offset:10240
    ds_read_b64_tr_b16 a[106:107], v6 offset:10752
    buffer_load_dwordx4 v13, s[8:11], s70 offen offset:1024 lds
    v_fma_f32 v53, v53, v18, v19
    v_fma_f32 v54, v54, v18, v19
    v_mfma_f32_32x32x16_bf16 a[48:63], a[76:79], v[32:35], 0
    ds_read_b64_tr_b16 a[108:109], v7 offset:10240
    ds_read_b64_tr_b16 a[110:111], v7 offset:10752
    v_fma_f32 v55, v55, v18, v19
    v_cvt_pk_bf16_f32 v40, v48, v49
    v_cvt_pk_bf16_f32 v41, v50, v51
    s_waitcnt lgkmcnt(8)
    v_mfma_f32_32x32x16_bf16 a[0:15], a[80:83], v[36:39], a[0:15]
    ds_read_b64_tr_b16 a[64:65], v6 offset:12288
    ds_read_b64_tr_b16 a[66:67], v6 offset:12800
    buffer_load_dwordx4 v12, s[8:11], s77 offen offset:2048 lds
    v_cvt_pk_bf16_f32 v42, v52, v53
    v_cvt_pk_bf16_f32 v43, v54, v55
    v_mfma_f32_32x32x16_bf16 a[16:31], a[84:87], v[36:39], a[16:31]
    ds_read_b64_tr_b16 a[68:69], v7 offset:12288
    ds_read_b64_tr_b16 a[70:71], v7 offset:12800
    v_fma_f32 v56, v56, v18, v19
    v_fma_f32 v57, v57, v18, v19
    v_fma_f32 v58, v58, v18, v19
    v_fma_f32 v59, v59, v18, v19
    v_mfma_f32_32x32x16_bf16 a[32:47], a[88:91], v[36:39], a[32:47]
    ds_read_b64_tr_b16 a[72:73], v6 offset:14336
    ds_read_b64_tr_b16 a[74:75], v6 offset:14848
    buffer_load_dwordx4 v13, s[8:11], s77 offen offset:3072 lds
    s_add_u32 m0, s80, 8192
    s_add_u32 s70, s70, s12
    s_add_u32 s77, s77, s13
    v_mfma_f32_32x32x16_bf16 a[48:63], a[92:95], v[36:39], a[48:63]
    ds_read_b64_tr_b16 a[76:77], v7 offset:14336
    ds_read_b64_tr_b16 a[78:79], v7 offset:14848
    v_fma_f32 v60, v60, v18, v19
    v_fma_f32 v61, v61, v18, v19
    v_fma_f32 v62, v62, v18, v19
    s_waitcnt lgkmcnt(8)
    v_mfma_f32_32x32x16_bf16 a[0:15], a[96:99], v[40:43], a[0:15]
    buffer_load_dwordx4 v12, s[8:11], s71 offen offset:0 lds
    v_fma_f32 v63, v63, v18, v19
    v_cvt_pk_bf16_f32 v44, v56, v57
    v_cvt_pk_bf16_f32 v45, v58, v59
    v_cvt_pk_bf16_f32 v46, v60, v61
    v_mfma_f32_32x32x16_bf16 a[16:31], a[100:103], v[40:43], a[16:31]
    s_waitcnt vmcnt(13) lgkmcnt(0)
    s_barrier
    ds_read_b64_tr_b16 a[80:81], v6 offset:16384
    ds_read_b64_tr_b16 a[82:83], v6 offset:16896
    v_cvt_pk_bf16_f32 v47, v62, v63
    v_mfma_f32_32x32x16_bf16 a[32:47], a[104:107], v[40:43], a[32:47]
    ds_read_b64_tr_b16 a[84:85], v7 offset:16384
    ds_read_b64_tr_b16 a[86:87], v7 offset:16896
    ds_read_b64_tr_b16 a[88:89], v6 offset:18432
    buffer_load_dwordx4 v13, s[8:11], s71 offen offset:1024 lds
    v_fma_f32 v64, v64, v18, v19
    v_mfma_f32_32x32x16_bf16 a[48:63], a[108:111], v[40:43], a[48:63]
    ds_read_b64_tr_b16 a[90:91], v6 offset:18944
    ds_read_b64_tr_b16 a[92:93], v7 offset:18432
    ds_read_b64_tr_b16 a[94:95], v7 offset:18944
    v_fma_f32 v65, v65, v18, v19
    v_fma_f32 v66, v66, v18, v19
    v_fma_f32 v67, v67, v18, v19
    v_mfma_f32_32x32x16_bf16 a[0:15], a[64:67], v[44:47], a[0:15]
    ds_read_b64_tr_b16 a[96:97], v6 offset:20480
    ds_read_b64_tr_b16 a[98:99], v6 offset:20992
    buffer_load_dwordx4 v12, s[8:11], s78 offen offset:2048 lds
    v_fma_f32 v68, v68, v18, v19
    v_fma_f32 v69, v69, v18, v19
    v_fma_f32 v70, v70, v18, v19
    v_mfma_f32_32x32x16_bf16 a[16:31], a[68:71], v[44:47], a[16:31]
    ds_read_b64_tr_b16 a[100:101], v7 offset:20480
    ds_read_b64_tr_b16 a[102:103], v7 offset:20992
    v_fma_f32 v71, v71, v18, v19
    v_cvt_pk_bf16_f32 v48, v64, v65
    v_cvt_pk_bf16_f32 v49, v66, v67
    v_cvt_pk_bf16_f32 v50, v68, v69
    v_cvt_pk_bf16_f32 v51, v70, v71
    v_mfma_f32_32x32x16_bf16 a[32:47], a[72:75], v[44:47], a[32:47]
    ds_read_b64_tr_b16 a[104:105], v6 offset:22528
    ds_read_b64_tr_b16 a[106:107], v6 offset:23040
    buffer_load_dwordx4 v13, s[8:11], s78 offen offset:3072 lds
    s_add_u32 m0, s80, 12288
    s_add_u32 s71, s71, s12
    s_add_u32 s78, s78, s13
    v_mfma_f32_32x32x16_bf16 a[48:63], a[76:79], v[44:47], a[48:63]
    ds_read_b64_tr_b16 a[108:109], v7 offset:22528
    ds_read_b64_tr_b16 a[110:111], v7 offset:23040
    v_fma_f32 v72, v72, v18, v19
    v_fma_f32 v73, v73, v18, v19
    v_fma_f32 v74, v74, v18, v19
    s_waitcnt lgkmcnt(8)
    v_mfma_f32_32x32x16_bf16 a[0:15], a[80:83], v[48:51], a[0:15]
    ds_read_b64_tr_b16 a[64:65], v6 offset:24576
    ds_read_b64_tr_b16 a[66:67], v6 offset:25088
    buffer_load_dwordx4 v12, s[8:11], s72 offen offset:0 lds
    v_fma_f32 v75, v75, v18, v19
    v_fma_f32 v76, v76, v18, v19
    v_mfma_f32_32x32x16_bf16 a[16:31], a[84:87], v[48:51], a[16:31]
    ds_read_b64_tr_b16 a[68:69], v7 offset:24576
    ds_read_b64_tr_b16 a[70:71], v7 offset:25088
    v_fma_f32 v77, v77, v18, v19
    v_fma_f32 v78, v78, v18, v19
    v_fma_f32 v79, v79, v18, v19
    v_cvt_pk_bf16_f32 v52, v72, v73
    v_mfma_f32_32x32x16_bf16 a[32:47], a[88:91], v[48:51], a[32:47]
    ds_read_b64_tr_b16 a[72:73], v6 offset:26624
    ds_read_b64_tr_b16 a[74:75], v6 offset:27136
    buffer_load_dwordx4 v13, s[8:11], s72 offen offset:1024 lds
    v_cvt_pk_bf16_f32 v53, v74, v75
    v_cvt_pk_bf16_f32 v54, v76, v77
    v_cvt_pk_bf16_f32 v55, v78, v79
    v_mfma_f32_32x32x16_bf16 a[48:63], a[92:95], v[48:51], a[48:63]
    ds_read_b64_tr_b16 a[76:77], v7 offset:26624
    ds_read_b64_tr_b16 a[78:79], v7 offset:27136
    v_fma_f32 v80, v80, v18, v19
    v_fma_f32 v81, v81, v18, v19
    v_fma_f32 v82, v82, v18, v19
    v_fma_f32 v83, v83, v18, v19
    s_waitcnt lgkmcnt(8)
    v_mfma_f32_32x32x16_bf16 a[0:15], a[96:99], v[52:55], a[0:15]
    ds_read_b64_tr_b16 a[80:81], v6 offset:28672
    ds_read_b64_tr_b16 a[82:83], v6 offset:29184
    buffer_load_dwordx4 v12, s[8:11], s79 offen offset:2048 lds
    v_fma_f32 v84, v84, v18, v19
    v_fma_f32 v85, v85, v18, v19
    v_fma_f32 v86, v86, v18, v19
    v_mfma_f32_32x32x16_bf16 a[16:31], a[100:103], v[52:55], a[16:31]
    ds_read_b64_tr_b16 a[84:85], v7 offset:28672
    ds_read_b64_tr_b16 a[86:87], v7 offset:29184
    v_fma_f32 v87, v87, v18, v19
    v_cvt_pk_bf16_f32 v56, v80, v81
    v_cvt_pk_bf16_f32 v57, v82, v83
    v_cvt_pk_bf16_f32 v58, v84, v85
    v_cvt_pk_bf16_f32 v59, v86, v87
    v_mfma_f32_32x32x16_bf16 a[32:47], a[104:107], v[52:55], a[32:47]
    ds_read_b64_tr_b16 a[88:89], v6 offset:30720
    ds_read_b64_tr_b16 a[90:91], v6 offset:31232
    buffer_load_dwordx4 v13, s[8:11], s79 offen offset:3072 lds
    s_add_u32 m0, s80, 16384
    s_add_u32 s72, s72, s12
    s_add_u32 s79, s79, s13
    v_mfma_f32_32x32x16_bf16 a[48:63], a[108:111], v[52:55], a[48:63]
    ds_read_b64_tr_b16 a[92:93], v7 offset:30720
    ds_read_b64_tr_b16 a[94:95], v7 offset:31232
    v_fma_f32 v88, v88, v18, v19
    v_fma_f32 v89, v89, v18, v19
    v_fma_f32 v90, v90, v18, v19
    s_waitcnt lgkmcnt(8)
    v_mfma_f32_32x32x16_bf16 a[0:15], a[64:67], v[56:59], a[0:15]
    buffer_load_dwordx4 v12, s[8:11], s66 offen offset:0 lds
    v_fma_f32 v91, v91, v18, v19
    v_fma_f32 v92, v92, v18, v19
    v_fma_f32 v93, v93, v18, v19
    v_fma_f32 v94, v94, v18, v19
    v_fma_f32 v95, v95, v18, v19
    v_mfma_f32_32x32x16_bf16 a[16:31], a[68:71], v[56:59], a[16:31]
    s_waitcnt vmcnt(17) lgkmcnt(0)
    s_barrier
    ds_read_b64_tr_b16 a[96:97], v6 offset:32768
    ds_read_b64_tr_b16 a[98:99], v6 offset:33280
    v_cvt_pk_bf16_f32 v60, v88, v89
    v_cvt_pk_bf16_f32 v61, v90, v91
    v_mfma_f32_32x32x16_bf16 a[32:47], a[72:75], v[56:59], a[32:47]
    ds_read_b64_tr_b16 a[100:101], v7 offset:32768
    ds_read_b64_tr_b16 a[102:103], v7 offset:33280
    ds_read_b64_tr_b16 a[104:105], v6 offset:34816
    buffer_load_dwordx4 v13, s[8:11], s66 offen offset:1024 lds
    v_cvt_pk_bf16_f32 v62, v92, v93
    v_cvt_pk_bf16_f32 v63, v94, v95
    v_mfma_f32_32x32x16_bf16 a[48:63], a[76:79], v[56:59], a[48:63]
    ds_read_b64_tr_b16 a[106:107], v6 offset:35328
    ds_read_b64_tr_b16 a[108:109], v7 offset:34816
    ds_read_b64_tr_b16 a[110:111], v7 offset:35328
    v_fma_f32 v96, v96, v18, v19
    v_fma_f32 v97, v97, v18, v19
    v_mfma_f32_32x32x16_bf16 a[0:15], a[80:83], v[60:63], a[0:15]
    ds_read_b64_tr_b16 a[64:65], v6 offset:36864
    ds_read_b64_tr_b16 a[66:67], v6 offset:37376
    buffer_load_dwordx4 v12, s[8:11], s73 offen offset:2048 lds
    v_fma_f32 v98, v98, v18, v19
    v_fma_f32 v99, v99, v18, v19
    v_fma_f32 v100, v100, v18, v19
    v_mfma_f32_32x32x16_bf16 a[16:31], a[84:87], v[60:63], a[16:31]
    ds_read_b64_tr_b16 a[68:69], v7 offset:36864
    ds_read_b64_tr_b16 a[70:71], v7 offset:37376
    v_fma_f32 v101, v101, v18, v19
    v_fma_f32 v102, v102, v18, v19
    v_fma_f32 v103, v103, v18, v19
    v_cvt_pk_bf16_f32 v64, v96, v97
    v_cvt_pk_bf16_f32 v65, v98, v99
    v_mfma_f32_32x32x16_bf16 a[32:47], a[88:91], v[60:63], a[32:47]
    ds_read_b64_tr_b16 a[72:73], v6 offset:38912
    ds_read_b64_tr_b16 a[74:75], v6 offset:39424
    buffer_load_dwordx4 v13, s[8:11], s73 offen offset:3072 lds
    s_add_u32 m0, s80, 20480
    v_cvt_pk_bf16_f32 v66, v100, v101
    v_cvt_pk_bf16_f32 v67, v102, v103
    v_mfma_f32_32x32x16_bf16 a[48:63], a[92:95], v[60:63], a[48:63]
    ds_read_b64_tr_b16 a[76:77], v7 offset:38912
    ds_read_b64_tr_b16 a[78:79], v7 offset:39424
    v_fma_f32 v104, v104, v18, v19
    v_fma_f32 v105, v105, v18, v19
    v_fma_f32 v106, v106, v18, v19
    s_waitcnt lgkmcnt(8)
    v_mfma_f32_32x32x16_bf16 a[0:15], a[96:99], v[64:67], a[0:15]
    ds_read_b64_tr_b16 a[80:81], v6 offset:40960
    ds_read_b64_tr_b16 a[82:83], v6 offset:41472
    buffer_load_dwordx4 v12, s[8:11], s67 offen offset:0 lds
    v_fma_f32 v107, v107, v18, v19
    v_fma_f32 v108, v108, v18, v19
    v_mfma_f32_32x32x16_bf16 a[16:31], a[100:103], v[64:67], a[16:31]
    ds_read_b64_tr_b16 a[84:85], v7 offset:40960
    ds_read_b64_tr_b16 a[86:87], v7 offset:41472
    v_fma_f32 v109, v109, v18, v19
    v_fma_f32 v110, v110, v18, v19
    v_fma_f32 v111, v111, v18, v19
    v_cvt_pk_bf16_f32 v68, v104, v105
    v_mfma_f32_32x32x16_bf16 a[32:47], a[104:107], v[64:67], a[32:47]
    ds_read_b64_tr_b16 a[88:89], v6 offset:43008
    ds_read_b64_tr_b16 a[90:91], v6 offset:43520
    buffer_load_dwordx4 v13, s[8:11], s67 offen offset:1024 lds
    v_cvt_pk_bf16_f32 v69, v106, v107
    v_cvt_pk_bf16_f32 v70, v108, v109
    v_cvt_pk_bf16_f32 v71, v110, v111
    v_mfma_f32_32x32x16_bf16 a[48:63], a[108:111], v[64:67], a[48:63]
    ds_read_b64_tr_b16 a[92:93], v7 offset:43008
    ds_read_b64_tr_b16 a[94:95], v7 offset:43520
    v_fma_f32 v112, v112, v18, v19
    v_fma_f32 v113, v113, v18, v19
    v_fma_f32 v114, v114, v18, v19
    s_waitcnt lgkmcnt(8)
    v_mfma_f32_32x32x16_bf16 a[0:15], a[64:67], v[68:71], a[0:15]
    ds_read_b64_tr_b16 a[96:97], v6 offset:45056
    ds_read_b64_tr_b16 a[98:99], v6 offset:45568
    buffer_load_dwordx4 v12, s[8:11], s74 offen offset:2048 lds
    v_fma_f32 v115, v115, v18, v19
    v_fma_f32 v116, v116, v18, v19
    v_mfma_f32_32x32x16_bf16 a[16:31], a[68:71], v[68:71], a[16:31]
    ds_read_b64_tr_b16 a[100:101], v7 offset:45056
    ds_read_b64_tr_b16 a[102:103], v7 offset:45568
    v_fma_f32 v117, v117, v18, v19
    v_fma_f32 v118, v118, v18, v19
    v_fma_f32 v119, v119, v18, v19
    v_cvt_pk_bf16_f32 v72, v112, v113
    v_cvt_pk_bf16_f32 v73, v114, v115
    v_mfma_f32_32x32x16_bf16 a[32:47], a[72:75], v[68:71], a[32:47]
    ds_read_b64_tr_b16 a[104:105], v6 offset:47104
    ds_read_b64_tr_b16 a[106:107], v6 offset:47616
    buffer_load_dwordx4 v13, s[8:11], s74 offen offset:3072 lds
    s_add_u32 m0, s80, 24576
    v_cvt_pk_bf16_f32 v74, v116, v117
    v_cvt_pk_bf16_f32 v75, v118, v119
    v_mfma_f32_32x32x16_bf16 a[48:63], a[76:79], v[68:71], a[48:63]
    ds_read_b64_tr_b16 a[108:109], v7 offset:47104
    ds_read_b64_tr_b16 a[110:111], v7 offset:47616
    v_fma_f32 v120, v120, v18, v19
    v_fma_f32 v121, v121, v18, v19
    v_fma_f32 v122, v122, v18, v19
    s_waitcnt lgkmcnt(8)
    v_mfma_f32_32x32x16_bf16 a[0:15], a[80:83], v[72:75], a[0:15]
    buffer_load_dwordx4 v12, s[8:11], s68 offen offset:0 lds
    v_fma_f32 v123, v123, v18, v19
    v_fma_f32 v124, v124, v18, v19
    v_fma_f32 v125, v125, v18, v19
    v_fma_f32 v126, v126, v18, v19
    v_fma_f32 v127, v127, v18, v19
    v_mfma_f32_32x32x16_bf16 a[16:31], a[84:87], v[72:75], a[16:31]
    s_waitcnt vmcnt(17) lgkmcnt(0)
    s_barrier
    ds_read_b64_tr_b16 a[64:65], v3 offset:0
    ds_read_b64_tr_b16 a[66:67], v3 offset:512
    v_cvt_pk_bf16_f32 v76, v120, v121
    v_cvt_pk_bf16_f32 v77, v122, v123
    v_mfma_f32_32x32x16_bf16 a[32:47], a[88:91], v[72:75], a[32:47]
    ds_read_b64_tr_b16 a[68:69], v4 offset:0
    ds_read_b64_tr_b16 a[70:71], v4 offset:512
    ds_read_b64_tr_b16 a[72:73], v3 offset:2048
    buffer_load_dwordx4 v13, s[8:11], s68 offen offset:1024 lds
    v_cvt_pk_bf16_f32 v78, v124, v125
    v_cvt_pk_bf16_f32 v79, v126, v127
    v_mfma_f32_32x32x16_bf16 a[48:63], a[92:95], v[72:75], a[48:63]
    ds_read_b64_tr_b16 a[74:75], v3 offset:2560
    ds_read_b64_tr_b16 a[76:77], v4 offset:2048
    ds_read_b64_tr_b16 a[78:79], v4 offset:2560
    v_fma_f32 v128, v128, v18, v19
    v_fma_f32 v129, v129, v18, v19
    v_mfma_f32_32x32x16_bf16 a[0:15], a[96:99], v[76:79], a[0:15]
    ds_read_b64_tr_b16 a[80:81], v3 offset:28672
    ds_read_b64_tr_b16 a[82:83], v3 offset:29184
    buffer_load_dwordx4 v12, s[8:11], s75 offen offset:2048 lds
    v_fma_f32 v130, v130, v18, v19
    v_fma_f32 v131, v131, v18, v19
    v_fma_f32 v132, v132, v18, v19
    v_mfma_f32_32x32x16_bf16 a[16:31], a[100:103], v[76:79], a[16:31]
    ds_read_b64_tr_b16 a[84:85], v4 offset:28672
    ds_read_b64_tr_b16 a[86:87], v4 offset:29184
    v_fma_f32 v133, v133, v18, v19
    v_fma_f32 v134, v134, v18, v19
    v_fma_f32 v135, v135, v18, v19
    v_cvt_pk_bf16_f32 v80, v128, v129
    v_cvt_pk_bf16_f32 v81, v130, v131
    v_mfma_f32_32x32x16_bf16 a[32:47], a[104:107], v[76:79], a[32:47]
    ds_read_b64_tr_b16 a[88:89], v3 offset:30720
    ds_read_b64_tr_b16 a[90:91], v3 offset:31232
    buffer_load_dwordx4 v13, s[8:11], s75 offen offset:3072 lds
    s_add_u32 m0, s99, 0
    v_cvt_pk_bf16_f32 v82, v132, v133
    v_cvt_pk_bf16_f32 v83, v134, v135
    v_mfma_f32_32x32x16_bf16 a[48:63], a[108:111], v[76:79], a[48:63]
    ds_read_b64_tr_b16 a[92:93], v4 offset:30720
    ds_read_b64_tr_b16 a[94:95], v4 offset:31232
    v_fma_f32 v136, v136, v18, v19
    v_fma_f32 v137, v137, v18, v19
    v_fma_f32 v138, v138, v18, v19
    s_waitcnt lgkmcnt(8)
    v_mfma_f32_32x32x16_bf16 a[0:15], a[64:67], v[80:83], a[0:15]
    ds_read_b64_tr_b16 a[96:97], v8 offset:0
    ds_read_b64_tr_b16 a[98:99], v8 offset:512
    buffer_load_dwordx4 v12, s[8:11], s69 offen offset:0 lds
    v_fma_f32 v139, v139, v18, v19
    v_fma_f32 v140, v140, v18, v19
    v_mfma_f32_32x32x16_bf16 a[16:31], a[68:71], v[80:83], a[16:31]
    ds_read_b64_tr_b16 a[100:101], v9 offset:0
    ds_read_b64_tr_b16 a[102:103], v9 offset:512
    v_fma_f32 v141, v141, v18, v19
    v_fma_f32 v142, v142, v18, v19
    v_fma_f32 v143, v143, v18, v19
    v_cvt_pk_bf16_f32 v84, v136, v137
    v_mfma_f32_32x32x16_bf16 a[32:47], a[72:75], v[80:83], a[32:47]
    ds_read_b64_tr_b16 a[104:105], v8 offset:2048
    ds_read_b64_tr_b16 a[106:107], v8 offset:2560
    buffer_load_dwordx4 v13, s[8:11], s69 offen offset:1024 lds
    v_cvt_pk_bf16_f32 v85, v138, v139
    v_cvt_pk_bf16_f32 v86, v140, v141
    v_cvt_pk_bf16_f32 v87, v142, v143
    v_mfma_f32_32x32x16_bf16 a[48:63], a[76:79], v[80:83], a[48:63]
    ds_read_b64_tr_b16 a[108:109], v9 offset:2048
    ds_read_b64_tr_b16 a[110:111], v9 offset:2560
    v_fma_f32 v144, v144, v18, v19
    v_fma_f32 v145, v145, v18, v19
    v_fma_f32 v146, v146, v18, v19
    s_waitcnt lgkmcnt(8)
    v_mfma_f32_32x32x16_bf16 a[0:15], a[80:83], v[84:87], a[0:15]
    ds_read_b64_tr_b16 a[64:65], v8 offset:28672
    ds_read_b64_tr_b16 a[66:67], v8 offset:29184
    buffer_load_dwordx4 v12, s[8:11], s76 offen offset:2048 lds
    v_fma_f32 v147, v147, v18, v19
    v_fma_f32 v148, v148, v18, v19
    v_mfma_f32_32x32x16_bf16 a[16:31], a[84:87], v[84:87], a[16:31]
    ds_read_b64_tr_b16 a[68:69], v9 offset:28672
    ds_read_b64_tr_b16 a[70:71], v9 offset:29184
    v_fma_f32 v149, v149, v18, v19
    v_fma_f32 v150, v150, v18, v19
    v_fma_f32 v151, v151, v18, v19
    v_cvt_pk_bf16_f32 v88, v144, v145
    v_cvt_pk_bf16_f32 v89, v146, v147
    v_mfma_f32_32x32x16_bf16 a[32:47], a[88:91], v[84:87], a[32:47]
    ds_read_b64_tr_b16 a[72:73], v8 offset:30720
    ds_read_b64_tr_b16 a[74:75], v8 offset:31232
    buffer_load_dwordx4 v13, s[8:11], s76 offen offset:3072 lds
    s_add_u32 m0, s99, 16384
    v_cvt_pk_bf16_f32 v90, v148, v149
    v_cvt_pk_bf16_f32 v91, v150, v151
    v_mfma_f32_32x32x16_bf16 a[48:63], a[92:95], v[84:87], a[48:63]
    ds_read_b64_tr_b16 a[76:77], v9 offset:30720
    ds_read_b64_tr_b16 a[78:79], v9 offset:31232
    v_fma_f32 v152, v152, v18, v19
    v_fma_f32 v153, v153, v18, v19
    v_fma_f32 v154, v154, v18, v19
    s_waitcnt lgkmcnt(8)
    v_mfma_f32_32x32x16_bf16 a[0:15], a[96:99], v[88:91], a[0:15]
    ds_read_b64_tr_b16 a[80:81], v3 offset:4096
    ds_read_b64_tr_b16 a[82:83], v3 offset:4608
    buffer_load_dwordx4 v12, s[8:11], s70 offen offset:0 lds
    v_fma_f32 v155, v155, v18, v19
    v_fma_f32 v156, v156, v18, v19
    v_mfma_f32_32x32x16_bf16 a[16:31], a[100:103], v[88:91], a[16:31]
    ds_read_b64_tr_b16 a[84:85], v4 offset:4096
    ds_read_b64_tr_b16 a[86:87], v4 offset:4608
    v_fma_f32 v157, v157, v18, v19
    v_fma_f32 v158, v158, v18, v19
    v_fma_f32 v159, v159, v18, v19
    v_cvt_pk_bf16_f32 v92, v152, v153
    v_mfma_f32_32x32x16_bf16 a[32:47], a[104:107], v[88:91], a[32:47]
    ds_read_b64_tr_b16 a[88:89], v3 offset:6144
    ds_read_b64_tr_b16 a[90:91], v3 offset:6656
    buffer_load_dwordx4 v13, s[8:11], s70 offen offset:1024 lds
    v_cvt_pk_bf16_f32 v93, v154, v155
    v_cvt_pk_bf16_f32 v94, v156, v157
    v_cvt_pk_bf16_f32 v95, v158, v159
    v_mfma_f32_32x32x16_bf16 a[48:63], a[108:111], v[88:91], a[48:63]
    ds_read_b64_tr_b16 a[92:93], v4 offset:6144
    ds_read_b64_tr_b16 a[94:95], v4 offset:6656
    v_fma_f32 v160, v160, v18, v19
    v_fma_f32 v161, v161, v18, v19
    v_fma_f32 v162, v162, v18, v19
    s_waitcnt lgkmcnt(8)
    v_mfma_f32_32x32x16_bf16 a[0:15], a[64:67], v[92:95], a[0:15]
    ds_read_b64_tr_b16 a[96:97], v3 offset:32768
    ds_read_b64_tr_b16 a[98:99], v3 offset:33280
    buffer_load_dwordx4 v12, s[8:11], s77 offen offset:2048 lds
    v_fma_f32 v163, v163, v18, v19
    v_fma_f32 v164, v164, v18, v19
    v_mfma_f32_32x32x16_bf16 a[16:31], a[68:71], v[92:95], a[16:31]
    ds_read_b64_tr_b16 a[100:101], v4 offset:32768
    ds_read_b64_tr_b16 a[102:103], v4 offset:33280
    v_fma_f32 v165, v165, v18, v19
    v_fma_f32 v166, v166, v18, v19
    v_fma_f32 v167, v167, v18, v19
    v_cvt_pk_bf16_f32 v96, v160, v161
    v_cvt_pk_bf16_f32 v97, v162, v163
    v_mfma_f32_32x32x16_bf16 a[32:47], a[72:75], v[92:95], a[32:47]
    ds_read_b64_tr_b16 a[104:105], v3 offset:34816
    ds_read_b64_tr_b16 a[106:107], v3 offset:35328
    buffer_load_dwordx4 v13, s[8:11], s77 offen offset:3072 lds
    s_add_u32 m0, s99, 32768
    v_cvt_pk_bf16_f32 v98, v164, v165
    v_cvt_pk_bf16_f32 v99, v166, v167
    v_mfma_f32_32x32x16_bf16 a[48:63], a[76:79], v[92:95], a[48:63]
    ds_read_b64_tr_b16 a[108:109], v4 offset:34816
    ds_read_b64_tr_b16 a[110:111], v4 offset:35328
    v_fma_f32 v168, v168, v18, v19
    v_fma_f32 v169, v169, v18, v19
    v_fma_f32 v170, v170, v18, v19
    s_waitcnt lgkmcnt(8)
    v_mfma_f32_32x32x16_bf16 a[0:15], a[80:83], v[96:99], a[0:15]
    ds_read_b64_tr_b16 a[64:65], v8 offset:4096
    ds_read_b64_tr_b16 a[66:67], v8 offset:4608
    buffer_load_dwordx4 v12, s[8:11], s71 offen offset:0 lds
    v_fma_f32 v171, v171, v18, v19
    v_fma_f32 v172, v172, v18, v19
    v_mfma_f32_32x32x16_bf16 a[16:31], a[84:87], v[96:99], a[16:31]
    ds_read_b64_tr_b16 a[68:69], v9 offset:4096
    ds_read_b64_tr_b16 a[70:71], v9 offset:4608
    v_fma_f32 v173, v173, v18, v19
    v_fma_f32 v174, v174, v18, v19
    v_fma_f32 v175, v175, v18, v19
    v_cvt_pk_bf16_f32 v100, v168, v169
    v_mfma_f32_32x32x16_bf16 a[32:47], a[88:91], v[96:99], a[32:47]
    ds_read_b64_tr_b16 a[72:73], v8 offset:6144
    ds_read_b64_tr_b16 a[74:75], v8 offset:6656
    buffer_load_dwordx4 v13, s[8:11], s71 offen offset:1024 lds
    v_cvt_pk_bf16_f32 v101, v170, v171
    v_cvt_pk_bf16_f32 v102, v172, v173
    v_cvt_pk_bf16_f32 v103, v174, v175
    v_mfma_f32_32x32x16_bf16 a[48:63], a[92:95], v[96:99], a[48:63]
    ds_read_b64_tr_b16 a[76:77], v9 offset:6144
    ds_read_b64_tr_b16 a[78:79], v9 offset:6656
    v_fma_f32 v176, v176, v18, v19
    v_fma_f32 v177, v177, v18, v19
    v_fma_f32 v178, v178, v18, v19
    s_waitcnt lgkmcnt(8)
    v_mfma_f32_32x32x16_bf16 a[0:15], a[96:99], v[100:103], a[0:15]
    ds_read_b64_tr_b16 a[80:81], v8 offset:32768
    ds_read_b64_tr_b16 a[82:83], v8 offset:33280
    buffer_load_dwordx4 v12, s[8:11], s78 offen offset:2048 lds
    v_fma_f32 v179, v179, v18, v19
    v_fma_f32 v180, v180, v18, v19
    v_mfma_f32_32x32x16_bf16 a[16:31], a[100:103], v[100:103], a[16:31]
    ds_read_b64_tr_b16 a[84:85], v9 offset:32768
    ds_read_b64_tr_b16 a[86:87], v9 offset:33280
    v_fma_f32 v181, v181, v18, v19
    v_fma_f32 v182, v182, v18, v19
    v_fma_f32 v183, v183, v18, v19
    v_cvt_pk_bf16_f32 v104, v176, v177
    v_cvt_pk_bf16_f32 v105, v178, v179
    s_branch L_overQ2
    .p2align 12
L_padQ2:
    s_branch L_retQa
L_overQ2:
    v_mfma_f32_32x32x16_bf16 a[32:47], a[104:107], v[100:103], a[32:47]
    ds_read_b64_tr_b16 a[88:89], v8 offset:34816
    ds_read_b64_tr_b16 a[90:91], v8 offset:35328
    buffer_load_dwordx4 v13, s[8:11], s78 offen offset:3072 lds
    s_add_u32 m0, s80, 0
    v_cvt_pk_bf16_f32 v106, v180, v181
    v_cvt_pk_bf16_f32 v107, v182, v183
    v_mfma_f32_32x32x16_bf16 a[48:63], a[108:111], v[100:103], a[48:63]
    ds_read_b64_tr_b16 a[92:93], v9 offset:34816
    ds_read_b64_tr_b16 a[94:95], v9 offset:35328
    v_fma_f32 v184, v184, v18, v19
    v_fma_f32 v185, v185, v18, v19
    v_fma_f32 v186, v186, v18, v19
    s_waitcnt lgkmcnt(8)
    v_mfma_f32_32x32x16_bf16 a[0:15], a[64:67], v[104:107], a[0:15]
    v_fma_f32 v187, v187, v18, v19
    v_fma_f32 v188, v188, v18, v19
    v_fma_f32 v189, v189, v18, v19
    v_fma_f32 v190, v190, v18, v19
    v_fma_f32 v191, v191, v18, v19
    v_cvt_pk_bf16_f32 v108, v184, v185
    v_mfma_f32_32x32x16_bf16 a[16:31], a[68:71], v[104:107], a[16:31]
    s_waitcnt vmcnt(24) lgkmcnt(0)
    s_barrier
    ds_read_b64_tr_b16 a[96:97], v3 offset:8192
    ds_read_b64_tr_b16 a[98:99], v3 offset:8704
    buffer_load_dwordx4 v12, s[8:11], s72 offen offset:0 lds
    v_mfma_f32_32x32x16_bf16 a[32:47], a[72:75], v[104:107], a[32:47]
    ds_read_b64_tr_b16 a[100:101], v4 offset:8192
    ds_read_b64_tr_b16 a[102:103], v4 offset:8704
    ds_read_b64_tr_b16 a[104:105], v3 offset:10240
    v_cvt_pk_bf16_f32 v109, v186, v187
    v_cvt_pk_bf16_f32 v110, v188, v189
    v_cvt_pk_bf16_f32 v111, v190, v191
    v_mfma_f32_32x32x16_bf16 a[48:63], a[76:79], v[104:107], a[48:63]
    ds_read_b64_tr_b16 a[106:107], v3 offset:10752
    ds_read_b64_tr_b16 a[108:109], v4 offset:10240
    ds_read_b64_tr_b16 a[110:111], v4 offset:10752
    buffer_load_dwordx4 v13, s[8:11], s72 offen offset:1024 lds
    v_mfma_f32_32x32x16_bf16 a[0:15], a[80:83], v[108:111], a[0:15]
    ds_read_b64_tr_b16 a[64:65], v3 offset:36864
    ds_read_b64_tr_b16 a[66:67], v3 offset:37376
    v_fma_f32 v192, v192, v18, v19
    v_fma_f32 v193, v193, v18, v19
    v_fma_f32 v194, v194, v18, v19
    v_fma_f32 v195, v195, v18, v19
    v_mfma_f32_32x32x16_bf16 a[16:31], a[84:87], v[108:111], a[16:31]
    ds_read_b64_tr_b16 a[68:69], v4 offset:36864
    ds_read_b64_tr_b16 a[70:71], v4 offset:37376
    buffer_load_dwordx4 v12, s[8:11], s79 offen offset:2048 lds
    v_fma_f32 v196, v196, v18, v19
    v_fma_f32 v197, v197, v18, v19
    v_fma_f32 v198, v198, v18, v19
    v_mfma_f32_32x32x16_bf16 a[32:47], a[88:91], v[108:111], a[32:47]
    ds_read_b64_tr_b16 a[72:73], v3 offset:38912
    ds_read_b64_tr_b16 a[74:75], v3 offset:39424
    v_fma_f32 v199, v199, v18, v19
    v_cvt_pk_bf16_f32 v112, v192, v193
    v_cvt_pk_bf16_f32 v113, v194, v195
    v_cvt_pk_bf16_f32 v114, v196, v197
    v_cvt_pk_bf16_f32 v115, v198, v199
    v_mfma_f32_32x32x16_bf16 a[48:63], a[92:95], v[108:111], a[48:63]
    ds_read_b64_tr_b16 a[76:77], v4 offset:38912
    ds_read_b64_tr_b16 a[78:79], v4 offset:39424
    buffer_load_dwordx4 v13, s[8:11], s79 offen offset:3072 lds
    v_fma_f32 v200, v200, v18, v19
    s_waitcnt lgkmcnt(8)
    v_mfma_f32_32x32x16_bf16 a[0:15], a[96:99], v[112:115], a[0:15]
    ds_read_b64_tr_b16 a[80:81], v8 offset:8192
    ds_read_b64_tr_b16 a[82:83], v8 offset:8704
    v_fma_f32 v201, v201, v18, v19
    v_fma_f32 v202, v202, v18, v19
    v_fma_f32 v203, v203, v18, v19
    v_fma_f32 v204, v204, v18, v19
    v_mfma_f32_32x32x16_bf16 a[16:31], a[100:103], v[112:115], a[16:31]
    ds_read_b64_tr_b16 a[84:85], v9 offset:8192
    ds_read_b64_tr_b16 a[86:87], v9 offset:8704
    v_fma_f32 v205, v205, v18, v19
    v_fma_f32 v206, v206, v18, v19
    v_fma_f32 v207, v207, v18, v19
    v_cvt_pk_bf16_f32 v116, v200, v201
    v_mfma_f32_32x32x16_bf16 a[32:47], a[104:107], v[112:115], a[32:47]
    ds_read_b64_tr_b16 a[88:89], v8 offset:10240
    ds_read_b64_tr_b16 a[90:91], v8 offset:10752
    v_cvt_pk_bf16_f32 v117, v202, v203
    v_cvt_pk_bf16_f32 v118, v204, v205
    v_cvt_pk_bf16_f32 v119, v206, v207
    v_fma_f32 v208, v208, v18, v19
    v_mfma_f32_32x32x16_bf16 a[48:63], a[108:111], v[112:115], a[48:63]
    ds_read_b64_tr_b16 a[92:93], v9 offset:10240
    ds_read_b64_tr_b16 a[94:95], v9 offset:10752
    v_fma_f32 v209, v209, v18, v19
    v_fma_f32 v210, v210, v18, v19
    v_fma_f32 v211, v211, v18, v19
    s_waitcnt lgkmcnt(8)
    v_mfma_f32_32x32x16_bf16 a[0:15], a[64:67], v[116:119], a[0:15]
    ds_read_b64_tr_b16 a[96:97], v8 offset:36864
    ds_read_b64_tr_b16 a[98:99], v8 offset:37376
    v_fma_f32 v212, v212, v18, v19
    v_fma_f32 v213, v213, v18, v19
    v_fma_f32 v214, v214, v18, v19
    v_fma_f32 v215, v215, v18, v19
    v_mfma_f32_32x32x16_bf16 a[16:31], a[68:71], v[116:119], a[16:31]
    ds_read_b64_tr_b16 a[100:101], v9 offset:36864
    ds_read_b64_tr_b16 a[102:103], v9 offset:37376
    v_cvt_pk_bf16_f32 v120, v208, v209
    v_cvt_pk_bf16_f32 v121, v210, v211
    v_cvt_pk_bf16_f32 v122, v212, v213
    v_cvt_pk_bf16_f32 v123, v214, v215
    v_mfma_f32_32x32x16_bf16 a[32:47], a[72:75], v[116:119], a[32:47]
    ds_read_b64_tr_b16 a[104:105], v8 offset:38912
    ds_read_b64_tr_b16 a[106:107], v8 offset:39424
    v_fma_f32 v216, v216, v18, v19
    v_fma_f32 v217, v217, v18, v19
    v_fma_f32 v218, v218, v18, v19
    v_fma_f32 v219, v219, v18, v19
    v_mfma_f32_32x32x16_bf16 a[48:63], a[76:79], v[116:119], a[48:63]
    ds_read_b64_tr_b16 a[108:109], v9 offset:38912
    ds_read_b64_tr_b16 a[110:111], v9 offset:39424
    v_fma_f32 v220, v220, v18, v19
    v_fma_f32 v221, v221, v18, v19
    v_fma_f32 v222, v222, v18, v19
    s_waitcnt lgkmcnt(8)
    v_mfma_f32_32x32x16_bf16 a[0:15], a[80:83], v[120:123], a[0:15]
    ds_read_b64_tr_b16 a[64:65], v3 offset:12288
    ds_read_b64_tr_b16 a[66:67], v3 offset:12800
    v_fma_f32 v223, v223, v18, v19
    v_cvt_pk_bf16_f32 v124, v216, v217
    v_cvt_pk_bf16_f32 v125, v218, v219
    v_cvt_pk_bf16_f32 v126, v220, v221
    v_mfma_f32_32x32x16_bf16 a[16:31], a[84:87], v[120:123], a[16:31]
    ds_read_b64_tr_b16 a[68:69], v4 offset:12288
    ds_read_b64_tr_b16 a[70:71], v4 offset:12800
    v_cvt_pk_bf16_f32 v127, v222, v223
    v_and_b32 v227, 0xffff0000, v229
    v_lshlrev_b32 v228, 16, v230
    v_and_b32 v229, 0xffff0000, v230
    v_mfma_f32_32x32x16_bf16 a[32:47], a[88:91], v[120:123], a[32:47]
    ds_read_b64_tr_b16 a[72:73], v3 offset:14336
    ds_read_b64_tr_b16 a[74:75], v3 offset:14848
    v_lshlrev_b32 v230, 16, v231
    v_and_b32 v231, 0xffff0000, v231
    v_fma_f32 v224, v224, v18, v19
    v_fma_f32 v225, v225, v18, v19
    v_mfma_f32_32x32x16_bf16 a[48:63], a[92:95], v[120:123], a[48:63]
    ds_read_b64_tr_b16 a[76:77], v4 offset:14336
    ds_read_b64_tr_b16 a[78:79], v4 offset:14848
    v_fma_f32 v226, v226, v18, v19
    v_fma_f32 v227, v227, v18, v19
    v_fma_f32 v228, v228, v18, v19
    s_waitcnt lgkmcnt(8)
    v_mfma_f32_32x32x16_bf16 a[0:15], a[96:99], v[124:127], a[0:15]
    ds_read_b64_tr_b16 a[80:81], v3 offset:40960
    ds_read_b64_tr_b16 a[82:83], v3 offset:41472
    v_fma_f32 v229, v229, v18, v19
    v_fma_f32 v230, v230, v18, v19
    v_fma_f32 v231, v231, v18, v19
    v_cvt_pk_bf16_f32 v128, v224, v225
    v_mfma_f32_32x32x16_bf16 a[16:31], a[100:103], v[124:127], a[16:31]
    ds_read_b64_tr_b16 a[84:85], v4 offset:40960
    ds_read_b64_tr_b16 a[86:87], v4 offset:41472
    v_cvt_pk_bf16_f32 v129, v226, v227
    v_cvt_pk_bf16_f32 v130, v228, v229
    v_cvt_pk_bf16_f32 v131, v230, v231
    v_lshlrev_b32 v232, 16, v236
    v_and_b32 v233, 0xffff0000, v236
    v_mfma_f32_32x32x16_bf16 a[32:47], a[104:107], v[124:127], a[32:47]
    ds_read_b64_tr_b16 a[88:89], v3 offset:43008
    ds_read_b64_tr_b16 a[90:91], v3 offset:43520
    v_lshlrev_b32 v234, 16, v237
    v_and_b32 v235, 0xffff0000, v237
    v_lshlrev_b32 v236, 16, v238
    v_and_b32 v237, 0xffff0000, v238
    v_lshlrev_b32 v238, 16, v239
    v_mfma_f32_32x32x16_bf16 a[48:63], a[108:111], v[124:127], a[48:63]
    ds_read_b64_tr_b16 a[92:93], v4 offset:43008
    ds_read_b64_tr_b16 a[94:95], v4 offset:43520
    v_and_b32 v239, 0xffff0000, v239
    v_fma_f32 v232, v232, v18, v19
    v_fma_f32 v233, v233, v18, v19
    v_fma_f32 v234, v234, v18, v19
    s_waitcnt lgkmcnt(8)
    v_mfma_f32_32x32x16_bf16 a[0:15], a[64:67], v[128:131], a[0:15]
    ds_read_b64_tr_b16 a[96:97], v8 offset:12288
    ds_read_b64_tr_b16 a[98:99], v8 offset:12800
    v_fma_f32 v235, v235, v18, v19
    v_fma_f32 v236, v236, v18, v19
    v_fma_f32 v237, v237, v18, v19
    v_fma_f32 v238, v238, v18, v19
    v_fma_f32 v239, v239, v18, v19
    v_mfma_f32_32x32x16_bf16 a[16:31], a[68:71], v[128:131], a[16:31]
    ds_read_b64_tr_b16 a[100:101], v9 offset:12288
    ds_read_b64_tr_b16 a[102:103], v9 offset:12800
    v_cvt_pk_bf16_f32 v132, v232, v233
    v_cvt_pk_bf16_f32 v133, v234, v235
    v_cvt_pk_bf16_f32 v134, v236, v237
    v_cvt_pk_bf16_f32 v135, v238, v239
    v_lshlrev_b32 v240, 16, v244
    v_mfma_f32_32x32x16_bf16 a[32:47], a[72:75], v[128:131], a[32:47]
    ds_read_b64_tr_b16 a[104:105], v8 offset:14336
    ds_read_b64_tr_b16 a[106:107], v8 offset:14848
    v_and_b32 v241, 0xffff0000, v244
    v_lshlrev_b32 v242, 16, v245
    v_and_b32 v243, 0xffff0000, v245
    v_lshlrev_b32 v244, 16, v246
    v_and_b32 v245, 0xffff0000, v246
    v_mfma_f32_32x32x16_bf16 a[48:63], a[76:79], v[128:131], a[48:63]
    ds_read_b64_tr_b16 a[108:109], v9 offset:14336
    ds_read_b64_tr_b16 a[110:111], v9 offset:14848
    v_lshlrev_b32 v246, 16, v247
    v_and_b32 v247, 0xffff0000, v247
    v_fma_f32 v240, v240, v18, v19
    v_fma_f32 v241, v241, v18, v19
    s_waitcnt lgkmcnt(8)
    v_mfma_f32_32x32x16_bf16 a[0:15], a[80:83], v[132:135], a[0:15]
    ds_read_b64_tr_b16 a[64:65], v8 offset:40960
    ds_read_b64_tr_b16 a[66:67], v8 offset:41472
    v_fma_f32 v242, v242, v18, v19
    v_fma_f32 v243, v243, v18, v19
    v_fma_f32 v244, v244, v18, v19
    v_fma_f32 v245, v245, v18, v19
    v_fma_f32 v246, v246, v18, v19
    v_mfma_f32_32x32x16_bf16 a[16:31], a[84:87], v[132:135], a[16:31]
    ds_read_b64_tr_b16 a[68:69], v9 offset:40960
    ds_read_b64_tr_b16 a[70:71], v9 offset:41472
    v_fma_f32 v247, v247, v18, v19
    v_cvt_pk_bf16_f32 v136, v240, v241
    v_cvt_pk_bf16_f32 v137, v242, v243
    v_cvt_pk_bf16_f32 v138, v244, v245
    v_cvt_pk_bf16_f32 v139, v246, v247
    v_mfma_f32_32x32x16_bf16 a[32:47], a[88:91], v[132:135], a[32:47]
    ds_read_b64_tr_b16 a[72:73], v8 offset:43008
    ds_read_b64_tr_b16 a[74:75], v8 offset:43520
    v_lshlrev_b32 v248, 16, v252
    v_and_b32 v249, 0xffff0000, v252
    v_lshlrev_b32 v250, 16, v253
    v_and_b32 v251, 0xffff0000, v253
    v_lshlrev_b32 v252, 16, v254
    v_mfma_f32_32x32x16_bf16 a[48:63], a[92:95], v[132:135], a[48:63]
    ds_read_b64_tr_b16 a[76:77], v9 offset:43008
    ds_read_b64_tr_b16 a[78:79], v9 offset:43520
    v_and_b32 v253, 0xffff0000, v254
    v_lshlrev_b32 v254, 16, v255
    v_and_b32 v255, 0xffff0000, v255
    v_fma_f32 v248, v248, v18, v19
    s_waitcnt lgkmcnt(8)
    v_mfma_f32_32x32x16_bf16 a[0:15], a[96:99], v[136:139], a[0:15]
    s_mov_b32 s76, 0
    s_load_dword s76, s[32:33], 0
    v_fma_f32 v249, v249, v18, v19
    v_fma_f32 v250, v250, v18, v19
    v_fma_f32 v251, v251, v18, v19
    v_fma_f32 v252, v252, v18, v19
    v_fma_f32 v253, v253, v18, v19
    v_mfma_f32_32x32x16_bf16 a[16:31], a[100:103], v[136:139], a[16:31]
    s_waitcnt vmcnt(16) lgkmcnt(0)
    s_barrier
    ds_read_b64_tr_b16 a[80:81], v3 offset:16384
    ds_read_b64_tr_b16 a[82:83], v3 offset:16896
    v_fma_f32 v254, v254, v18, v19
    v_fma_f32 v255, v255, v18, v19
    v_mfma_f32_32x32x16_bf16 a[32:47], a[104:107], v[136:139], a[32:47]
    ds_read_b64_tr_b16 a[84:85], v4 offset:16384
    ds_read_b64_tr_b16 a[86:87], v4 offset:16896
    ds_read_b64_tr_b16 a[88:89], v5 offset:18432
    v_cvt_pk_bf16_f32 v140, v248, v249
    v_cvt_pk_bf16_f32 v141, v250, v251
    v_cvt_pk_bf16_f32 v142, v252, v253
    v_cvt_pk_bf16_f32 v143, v254, v255
    v_mfma_f32_32x32x16_bf16 a[48:63], a[108:111], v[136:139], a[48:63]
    ds_read_b64_tr_b16 a[90:91], v5 offset:18944
    s_mov_b32 s73, s41
    s_mov_b32 s74, s42
    s_mov_b32 s75, s43
    s_mov_b32 s79, s44
    v_mfma_f32_32x32x16_bf16 a[0:15], a[64:67], v[140:143], a[0:15]
    ds_read_b64_tr_b16 a[96:97], v3 offset:45056
    ds_read_b64_tr_b16 a[98:99], v3 offset:45568
    v_and_b32 v30, 32, v0
    v_lshlrev_b32 v30, 1, v30
    v_xor_b32 v22, v1, v30
    v_xor_b32 v23, 128, v22
    v_mfma_f32_32x32x16_bf16 a[16:31], a[68:71], v[140:143], a[16:31]
    ds_read_b64_tr_b16 a[100:101], v4 offset:45056
    ds_read_b64_tr_b16 a[102:103], v4 offset:45568
    v_and_b32 v30, 512, v1
    v_mfma_f32_32x32x16_bf16 a[32:47], a[72:75], v[140:143], a[32:47]
    ds_read_b64_tr_b16 a[104:105], v5 offset:47104
    ds_read_b64_tr_b16 a[106:107], v5 offset:47616
    s_cmp_ge_u32 s52, 1
    s_cselect_b64 vcc, -1, 0
    v_cndmask_b32 v13, v30, v23, vcc
    v_cndmask_b32 v12, v30, v22, vcc
    v_mfma_f32_32x32x16_bf16 a[48:63], a[76:79], v[140:143], a[48:63]
    s_cmp_ge_u32 s52, 2
    s_cselect_b64 vcc, -1, 0
    v_cndmask_b32 v31, v30, v23, vcc
    v_cndmask_b32 v30, v30, v22, vcc
    s_waitcnt lgkmcnt(6)
    v_mfma_f32_32x32x16_bf16 v[144:159], a[80:83], v[32:35], 0
    ds_read_b64_tr_b16 a[64:65], v8 offset:16384
    ds_read_b64_tr_b16 a[66:67], v8 offset:16896
    ds_read_b64_tr_b16 a[68:69], v9 offset:16384
    s_bitcmp1_b32 s53, 0
    s_cselect_b32 s61, 0, 1544
    s_lshr_b32 s60, s99, 1
    s_add_u32 s60, s60, 24576
    v_mfma_f32_32x32x16_bf16 v[160:175], a[84:87], v[32:35], 0
    ds_read_b64_tr_b16 a[70:71], v9 offset:16896
    ds_read_b64_tr_b16 a[72:73], v10 offset:18432
    ds_read_b64_tr_b16 a[74:75], v10 offset:18944
    s_add_u32 s61, s60, s61
    v_and_b32 v209, 0x1f0, v1
    v_add_u32 v209, s61, v209
    v_lshrrev_b32 v18, 5, v0
    v_mfma_f32_32x32x16_bf16 v[176:191], a[88:91], v[32:35], 0
    v_accvgpr_read_b32 v224, a0
    v_accvgpr_read_b32 v225, a1
    v_accvgpr_read_b32 v226, a2
    v_accvgpr_read_b32 v227, a3
    v_accvgpr_read_b32 v228, a4
    v_accvgpr_read_b32 v229, a5
    s_waitcnt lgkmcnt(6)
    v_mfma_f32_32x32x16_bf16 v[144:159], a[96:99], v[36:39], v[144:159]
    ds_read_b64_tr_b16 a[80:81], v8 offset:45056
    ds_read_b64_tr_b16 a[82:83], v8 offset:45568
    ds_read_b64_tr_b16 a[84:85], v9 offset:45056
    v_accvgpr_read_b32 v230, a6
    v_accvgpr_read_b32 v231, a7
    v_mul_f32 v224, 0x3e0622e6, v224
    v_mul_f32 v225, 0x3e0622e6, v225
    v_mfma_f32_32x32x16_bf16 v[160:175], a[100:103], v[36:39], v[160:175]
    ds_read_b64_tr_b16 a[86:87], v9 offset:45568
    ds_read_b64_tr_b16 a[88:89], v10 offset:47104
    ds_read_b64_tr_b16 a[90:91], v10 offset:47616
    v_mul_f32 v226, 0x3e0622e6, v226
    v_mul_f32 v227, 0x3e0622e6, v227
    v_mul_f32 v228, 0x3e0622e6, v228
    v_mul_f32 v229, 0x3e0622e6, v229
    v_mfma_f32_32x32x16_bf16 v[176:191], a[104:107], v[36:39], v[176:191]
    v_mul_f32 v230, 0x3e0622e6, v230
    v_mul_f32 v231, 0x3e0622e6, v231
    v_cvt_pk_bf16_f32 v224, v224, v225
    v_cvt_pk_bf16_f32 v225, v226, v227
    v_cvt_pk_bf16_f32 v226, v228, v229
    v_cvt_pk_bf16_f32 v227, v230, v231
    s_waitcnt lgkmcnt(6)
    v_mfma_f32_32x32x16_bf16 v[144:159], a[64:67], v[40:43], v[144:159]
    ds_read_b64_tr_b16 a[96:97], v3 offset:20480
    ds_read_b64_tr_b16 a[98:99], v3 offset:20992
    ds_read_b64_tr_b16 a[100:101], v4 offset:20480
    v_accvgpr_read_b32 v232, a8
    v_accvgpr_read_b32 v233, a9
    v_accvgpr_read_b32 v234, a10
    v_accvgpr_read_b32 v235, a11
    v_mfma_f32_32x32x16_bf16 v[160:175], a[68:71], v[40:43], v[160:175]
    ds_read_b64_tr_b16 a[102:103], v4 offset:20992
    ds_read_b64_tr_b16 a[104:105], v5 offset:22528
    ds_read_b64_tr_b16 a[106:107], v5 offset:23040
    v_accvgpr_read_b32 v236, a12
    v_accvgpr_read_b32 v237, a13
    v_accvgpr_read_b32 v238, a14
    v_accvgpr_read_b32 v239, a15
    v_mfma_f32_32x32x16_bf16 v[176:191], a[72:75], v[40:43], v[176:191]
    v_mul_f32 v232, 0x3e0622e6, v232
    v_mul_f32 v233, 0x3e0622e6, v233
    v_mul_f32 v234, 0x3e0622e6, v234
    v_mul_f32 v235, 0x3e0622e6, v235
    v_mul_f32 v236, 0x3e0622e6, v236
    v_mul_f32 v237, 0x3e0622e6, v237
    s_waitcnt lgkmcnt(6)
    v_mfma_f32_32x32x16_bf16 v[144:159], a[80:83], v[44:47], v[144:159]
    ds_read_b64_tr_b16 a[64:65], v3 offset:49152
    ds_read_b64_tr_b16 a[66:67], v3 offset:49664
    ds_read_b64_tr_b16 a[68:69], v4 offset:49152
    v_mul_f32 v238, 0x3e0622e6, v238
    v_mul_f32 v239, 0x3e0622e6, v239
    v_cvt_pk_bf16_f32 v232, v232, v233
    v_cvt_pk_bf16_f32 v233, v234, v235
    v_mfma_f32_32x32x16_bf16 v[160:175], a[84:87], v[44:47], v[160:175]
    ds_read_b64_tr_b16 a[70:71], v4 offset:49664
    ds_read_b64_tr_b16 a[72:73], v5 offset:51200
    ds_read_b64_tr_b16 a[74:75], v5 offset:51712
    v_cvt_pk_bf16_f32 v234, v236, v237
    v_cvt_pk_bf16_f32 v235, v238, v239
    v_permlane32_swap_b32 v224, v226
    v_mfma_f32_32x32x16_bf16 v[176:191], a[88:91], v[44:47], v[176:191]
    v_permlane32_swap_b32 v225, v227
    v_permlane32_swap_b32 v232, v234
    v_permlane32_swap_b32 v233, v235
    s_waitcnt lgkmcnt(6)
    v_mfma_f32_32x32x16_bf16 v[144:159], a[96:99], v[48:51], v[144:159]
    ds_read_b64_tr_b16 a[80:81], v8 offset:20480
    ds_read_b64_tr_b16 a[82:83], v8 offset:20992
    ds_read_b64_tr_b16 a[84:85], v9 offset:20480
    v_accvgpr_read_b32 v240, a16
    v_accvgpr_read_b32 v241, a17
    v_accvgpr_read_b32 v242, a18
    v_accvgpr_read_b32 v243, a19
    v_mfma_f32_32x32x16_bf16 v[160:175], a[100:103], v[48:51], v[160:175]
    ds_read_b64_tr_b16 a[86:87], v9 offset:20992
    ds_read_b64_tr_b16 a[88:89], v10 offset:22528
    ds_read_b64_tr_b16 a[90:91], v10 offset:23040
    v_accvgpr_read_b32 v244, a20
    v_accvgpr_read_b32 v245, a21
    v_accvgpr_read_b32 v246, a22
    v_accvgpr_read_b32 v247, a23
    v_mfma_f32_32x32x16_bf16 v[176:191], a[104:107], v[48:51], v[176:191]
    v_mul_f32 v240, 0x3e0622e6, v240
    v_mul_f32 v241, 0x3e0622e6, v241
    v_mul_f32 v242, 0x3e0622e6, v242
    v_mul_f32 v243, 0x3e0622e6, v243
    v_mul_f32 v244, 0x3e0622e6, v244
    v_mul_f32 v245, 0x3e0622e6, v245
    s_waitcnt lgkmcnt(6)
    v_mfma_f32_32x32x16_bf16 v[144:159], a[64:67], v[52:55], v[144:159]
    ds_read_b64_tr_b16 a[96:97], v8 offset:49152
    ds_read_b64_tr_b16 a[98:99], v8 offset:49664
    ds_read_b64_tr_b16 a[100:101], v9 offset:49152
    buffer_store_dwordx4 v[224:227], v1, s[24:27], s82 offen offset:0 sc1
    v_mul_f32 v246, 0x3e0622e6, v246
    v_mul_f32 v247, 0x3e0622e6, v247
    v_mfma_f32_32x32x16_bf16 v[160:175], a[68:71], v[52:55], v[160:175]
    ds_read_b64_tr_b16 a[102:103], v9 offset:49664
    ds_read_b64_tr_b16 a[104:105], v10 offset:51200
    ds_read_b64_tr_b16 a[106:107], v10 offset:51712
    v_cvt_pk_bf16_f32 v240, v240, v241
    v_cvt_pk_bf16_f32 v241, v242, v243
    v_cvt_pk_bf16_f32 v242, v244, v245
    v_cvt_pk_bf16_f32 v243, v246, v247
    v_mfma_f32_32x32x16_bf16 v[176:191], a[72:75], v[52:55], v[176:191]
    buffer_store_dwordx4 v[232:235], v1, s[24:27], s82 offen offset:1024 sc1
    v_accvgpr_read_b32 v248, a24
    v_accvgpr_read_b32 v249, a25
    v_accvgpr_read_b32 v250, a26
    v_accvgpr_read_b32 v251, a27
    s_waitcnt lgkmcnt(6)
    v_mfma_f32_32x32x16_bf16 v[144:159], a[80:83], v[56:59], v[144:159]
    ds_read_b64_tr_b16 a[64:65], v3 offset:24576
    ds_read_b64_tr_b16 a[66:67], v3 offset:25088
    ds_read_b64_tr_b16 a[68:69], v4 offset:24576
    v_accvgpr_read_b32 v252, a28
    v_accvgpr_read_b32 v253, a29
    v_accvgpr_read_b32 v254, a30
    v_accvgpr_read_b32 v255, a31
    v_mfma_f32_32x32x16_bf16 v[160:175], a[84:87], v[56:59], v[160:175]
    ds_read_b64_tr_b16 a[70:71], v4 offset:25088
    ds_read_b64_tr_b16 a[72:73], v5 offset:26624
    ds_read_b64_tr_b16 a[74:75], v5 offset:27136
    v_mul_f32 v248, 0x3e0622e6, v248
    v_mul_f32 v249, 0x3e0622e6, v249
    v_mul_f32 v250, 0x3e0622e6, v250
    v_mul_f32 v251, 0x3e0622e6, v251
    v_mfma_f32_32x32x16_bf16 v[176:191], a[88:91], v[56:59], v[176:191]
    v_mul_f32 v252, 0x3e0622e6, v252
    v_mul_f32 v253, 0x3e0622e6, v253
    v_mul_f32 v254, 0x3e0622e6, v254
    v_mul_f32 v255, 0x3e0622e6, v255
    v_cvt_pk_bf16_f32 v248, v248, v249
    v_cvt_pk_bf16_f32 v249, v250, v251
    s_waitcnt lgkmcnt(6)
    v_mfma_f32_32x32x16_bf16 v[144:159], a[96:99], v[60:63], v[144:159]
    ds_read_b64_tr_b16 a[80:81], v3 offset:53248
    ds_read_b64_tr_b16 a[82:83], v3 offset:53760
    ds_read_b64_tr_b16 a[84:85], v4 offset:53248
    v_cvt_pk_bf16_f32 v250, v252, v253
    v_cvt_pk_bf16_f32 v251, v254, v255
    v_permlane32_swap_b32 v240, v242
    v_mfma_f32_32x32x16_bf16 v[160:175], a[100:103], v[60:63], v[160:175]
    ds_read_b64_tr_b16 a[86:87], v4 offset:53760
    ds_read_b64_tr_b16 a[88:89], v5 offset:55296
    ds_read_b64_tr_b16 a[90:91], v5 offset:55808
    v_permlane32_swap_b32 v241, v243
    v_permlane32_swap_b32 v248, v250
    v_mfma_f32_32x32x16_bf16 v[176:191], a[104:107], v[60:63], v[176:191]
    v_permlane32_swap_b32 v249, v251
    v_accvgpr_read_b32 v224, a32
    v_accvgpr_read_b32 v225, a33
    v_accvgpr_read_b32 v226, a34
    v_accvgpr_read_b32 v227, a35
    s_waitcnt lgkmcnt(6)
    v_mfma_f32_32x32x16_bf16 v[144:159], a[64:67], v[64:67], v[144:159]
    ds_read_b64_tr_b16 a[96:97], v8 offset:24576
    ds_read_b64_tr_b16 a[98:99], v8 offset:25088
    ds_read_b64_tr_b16 a[100:101], v9 offset:24576
    buffer_store_dwordx4 v[240:243], v1, s[24:27], s82 offen offset:2048 sc1
    v_accvgpr_read_b32 v228, a36
    v_accvgpr_read_b32 v229, a37
    v_mfma_f32_32x32x16_bf16 v[160:175], a[68:71], v[64:67], v[160:175]
    ds_read_b64_tr_b16 a[102:103], v9 offset:25088
    ds_read_b64_tr_b16 a[104:105], v10 offset:26624
    ds_read_b64_tr_b16 a[106:107], v10 offset:27136
    v_accvgpr_read_b32 v230, a38
    v_accvgpr_read_b32 v231, a39
    v_mul_f32 v224, 0x3e0622e6, v224
    v_mul_f32 v225, 0x3e0622e6, v225
    v_mfma_f32_32x32x16_bf16 v[176:191], a[72:75], v[64:67], v[176:191]
    buffer_store_dwordx4 v[248:251], v1, s[24:27], s82 offen offset:3072 sc1
    s_add_u32 s82, s82, 4096
    v_mul_f32 v226, 0x3e0622e6, v226
    v_mul_f32 v227, 0x3e0622e6, v227
    v_mul_f32 v228, 0x3e0622e6, v228
    s_waitcnt lgkmcnt(6)
    v_mfma_f32_32x32x16_bf16 v[144:159], a[80:83], v[68:71], v[144:159]
    ds_read_b64_tr_b16 a[64:65], v8 offset:53248
    ds_read_b64_tr_b16 a[66:67], v8 offset:53760
    ds_read_b64_tr_b16 a[68:69], v9 offset:53248
    v_mul_f32 v229, 0x3e0622e6, v229
    v_mul_f32 v230, 0x3e0622e6, v230
    v_mul_f32 v231, 0x3e0622e6, v231
    v_cvt_pk_bf16_f32 v224, v224, v225
    v_mfma_f32_32x32x16_bf16 v[160:175], a[84:87], v[68:71], v[160:175]
    ds_read_b64_tr_b16 a[70:71], v9 offset:53760
    ds_read_b64_tr_b16 a[72:73], v10 offset:55296
    ds_read_b64_tr_b16 a[74:75], v10 offset:55808
    v_cvt_pk_bf16_f32 v225, v226, v227
    v_cvt_pk_bf16_f32 v226, v228, v229
    v_cvt_pk_bf16_f32 v227, v230, v231
    v_accvgpr_read_b32 v232, a40
    v_mfma_f32_32x32x16_bf16 v[176:191], a[88:91], v[68:71], v[176:191]
    v_accvgpr_read_b32 v233, a41
    v_accvgpr_read_b32 v234, a42
    v_accvgpr_read_b32 v235, a43
    v_accvgpr_read_b32 v236, a44
    v_accvgpr_read_b32 v237, a45
    v_accvgpr_read_b32 v238, a46
    s_waitcnt lgkmcnt(6)
    v_mfma_f32_32x32x16_bf16 v[144:159], a[96:99], v[72:75], v[144:159]
    v_accvgpr_read_b32 v239, a47
    v_mul_f32 v232, 0x3e0622e6, v232
    v_mul_f32 v233, 0x3e0622e6, v233
    v_mul_f32 v234, 0x3e0622e6, v234
    v_mul_f32 v235, 0x3e0622e6, v235
    v_mul_f32 v236, 0x3e0622e6, v236
    v_mul_f32 v237, 0x3e0622e6, v237
    v_mul_f32 v238, 0x3e0622e6, v238
    v_mfma_f32_32x32x16_bf16 v[160:175], a[100:103], v[72:75], v[160:175]
    s_waitcnt vmcnt(4) lgkmcnt(0)
    s_barrier
    ds_read_b64_tr_b16 a[80:81], v6 offset:0
    ds_read_b64_tr_b16 a[82:83], v6 offset:512
    ds_read_b64_tr_b16 a[84:85], v6 offset:4096
    ds_read_b64_tr_b16 a[86:87], v6 offset:4608
    v_mul_f32 v239, 0x3e0622e6, v239
    v_mfma_f32_32x32x16_bf16 v[176:191], a[104:107], v[72:75], v[176:191]
    s_branch L_overQ3
    .p2align 12
L_padQ3:
    s_branch L_retQa
L_overQ3:
    ds_read_b64_tr_b16 a[88:89], v6 offset:8192
    ds_read_b64_tr_b16 a[90:91], v6 offset:8704
    ds_read_b64_tr_b16 a[92:93], v6 offset:12288
    ds_read_b64_tr_b16 a[94:95], v6 offset:12800
    v_cvt_pk_bf16_f32 v232, v232, v233
    v_cvt_pk_bf16_f32 v233, v234, v235
    v_cvt_pk_bf16_f32 v234, v236, v237
    v_mfma_f32_32x32x16_bf16 v[144:159], a[64:67], v[76:79], v[144:159]
    ds_read_b64_tr_b16 a[96:97], v6 offset:16384
    ds_read_b64_tr_b16 a[98:99], v6 offset:16896
    ds_read_b64_tr_b16 a[100:101], v6 offset:20480
    v_cvt_pk_bf16_f32 v235, v238, v239
    v_permlane32_swap_b32 v224, v226
    v_permlane32_swap_b32 v225, v227
    v_mfma_f32_32x32x16_bf16 v[160:175], a[68:71], v[76:79], v[160:175]
    ds_read_b64_tr_b16 a[102:103], v6 offset:20992
    ds_read_b64_tr_b16 a[104:105], v6 offset:24576
    ds_read_b64_tr_b16 a[106:107], v6 offset:25088
    v_permlane32_swap_b32 v232, v234
    v_permlane32_swap_b32 v233, v235
    v_accvgpr_read_b32 v240, a48
    v_mfma_f32_32x32x16_bf16 v[176:191], a[72:75], v[76:79], v[176:191]
    ds_read_b64_tr_b16 a[108:109], v6 offset:28672
    ds_read_b64_tr_b16 a[110:111], v6 offset:29184
    v_accvgpr_read_b32 v241, a49
    v_accvgpr_read_b32 v242, a50
    v_accvgpr_read_b32 v243, a51
    v_accvgpr_read_b32 v244, a52
    v_accvgpr_read_b32 v245, a53
    s_waitcnt lgkmcnt(8)
    v_mfma_f32_32x32x16_bf16 v[144:159], a[80:83], v[80:83], v[144:159]
    ds_read_b64_tr_b16 a[64:65], v6 offset:32768
    ds_read_b64_tr_b16 a[66:67], v6 offset:33280
    buffer_store_dwordx4 v[224:227], v1, s[24:27], s82 offen offset:0 sc1
    v_accvgpr_read_b32 v246, a54
    v_accvgpr_read_b32 v247, a55
    s_cmp_lg_u32 s76, 0x1010101
    s_cbranch_scc1 L_slow_dbgQ
L_back_dbgQ:
    v_mfma_f32_32x32x16_bf16 v[144:159], a[84:87], v[84:87], v[144:159]
    ds_read_b64_tr_b16 a[68:69], v6 offset:36864
    ds_read_b64_tr_b16 a[70:71], v6 offset:37376
    v_mul_f32 v240, 0x3e0622e6, v240
    v_mul_f32 v241, 0x3e0622e6, v241
    v_mul_f32 v242, 0x3e0622e6, v242
    v_mul_f32 v243, 0x3e0622e6, v243
    v_mfma_f32_32x32x16_bf16 v[144:159], a[88:91], v[88:91], v[144:159]
    ds_read_b64_tr_b16 a[72:73], v6 offset:40960
    ds_read_b64_tr_b16 a[74:75], v6 offset:41472
    buffer_store_dwordx4 v[232:235], v1, s[24:27], s82 offen offset:1024 sc1
    v_mul_f32 v244, 0x3e0622e6, v244
    v_mul_f32 v245, 0x3e0622e6, v245
    v_mfma_f32_32x32x16_bf16 v[144:159], a[92:95], v[92:95], v[144:159]
    ds_read_b64_tr_b16 a[76:77], v6 offset:45056
    ds_read_b64_tr_b16 a[78:79], v6 offset:45568
    v_mul_f32 v246, 0x3e0622e6, v246
    v_mul_f32 v247, 0x3e0622e6, v247
    v_cvt_pk_bf16_f32 v240, v240, v241
    s_waitcnt lgkmcnt(8)
    v_mfma_f32_32x32x16_bf16 v[144:159], a[96:99], v[96:99], v[144:159]
    ds_read_b64_tr_b16 a[80:81], v3 offset:0
    ds_read_b64_tr_b16 a[82:83], v3 offset:512
    v_cvt_pk_bf16_f32 v241, v242, v243
    v_cvt_pk_bf16_f32 v242, v244, v245
    v_cvt_pk_bf16_f32 v243, v246, v247
    v_accvgpr_read_b32 v248, a56
    v_mfma_f32_32x32x16_bf16 v[144:159], a[100:103], v[100:103], v[144:159]
    ds_read_b64_tr_b16 a[84:85], v3 offset:28672
    ds_read_b64_tr_b16 a[86:87], v3 offset:29184
    v_accvgpr_read_b32 v249, a57
    v_accvgpr_read_b32 v250, a58
    v_accvgpr_read_b32 v251, a59
    v_accvgpr_read_b32 v252, a60
    v_mfma_f32_32x32x16_bf16 v[144:159], a[104:107], v[104:107], v[144:159]
    ds_read_b64_tr_b16 a[88:89], v8 offset:0
    ds_read_b64_tr_b16 a[90:91], v8 offset:512
    v_accvgpr_read_b32 v253, a61
    v_accvgpr_read_b32 v254, a62
    v_accvgpr_read_b32 v255, a63
    v_mul_f32 v248, 0x3e0622e6, v248
    v_mfma_f32_32x32x16_bf16 v[144:159], a[108:111], v[108:111], v[144:159]
    ds_read_b64_tr_b16 a[92:93], v8 offset:28672
    ds_read_b64_tr_b16 a[94:95], v8 offset:29184
    v_mul_f32 v249, 0x3e0622e6, v249
    v_mul_f32 v250, 0x3e0622e6, v250
    v_mul_f32 v251, 0x3e0622e6, v251
    s_waitcnt lgkmcnt(8)
    v_mfma_f32_32x32x16_bf16 v[144:159], a[64:67], v[112:115], v[144:159]
    ds_read_b64_tr_b16 a[96:97], v7 offset:0
    ds_read_b64_tr_b16 a[98:99], v7 offset:512
    v_mul_f32 v252, 0x3e0622e6, v252
    v_mul_f32 v253, 0x3e0622e6, v253
    v_mul_f32 v254, 0x3e0622e6, v254
    v_mul_f32 v255, 0x3e0622e6, v255
    v_mfma_f32_32x32x16_bf16 v[144:159], a[68:71], v[116:119], v[144:159]
    ds_read_b64_tr_b16 a[100:101], v7 offset:4096
    ds_read_b64_tr_b16 a[102:103], v7 offset:4608
    v_cvt_pk_bf16_f32 v248, v248, v249
    v_cvt_pk_bf16_f32 v249, v250, v251
    v_cvt_pk_bf16_f32 v250, v252, v253
    v_cvt_pk_bf16_f32 v251, v254, v255
    v_mfma_f32_32x32x16_bf16 v[144:159], a[72:75], v[120:123], v[144:159]
    ds_read_b64_tr_b16 a[104:105], v7 offset:8192
    ds_read_b64_tr_b16 a[106:107], v7 offset:8704
    v_permlane32_swap_b32 v240, v242
    v_permlane32_swap_b32 v241, v243
    v_mfma_f32_32x32x16_bf16 v[144:159], a[76:79], v[124:127], v[144:159]
    ds_read_b64_tr_b16 a[108:109], v7 offset:12288
    ds_read_b64_tr_b16 a[110:111], v7 offset:12800
    v_permlane32_swap_b32 v248, v250
    v_permlane32_swap_b32 v249, v251
    s_waitcnt lgkmcnt(8)
    v_mfma_f32_32x32x16_bf16 v[144:159], a[80:83], v[128:131], v[144:159]
    ds_read_b64_tr_b16 a[64:65], v7 offset:16384
    ds_read_b64_tr_b16 a[66:67], v7 offset:16896
    buffer_store_dwordx4 v[240:243], v1, s[24:27], s82 offen offset:2048 sc1
    v_lshl_add_u32 v208, v18, 13, v209
    v_add_u32 v209, 16384, v209
    v_mfma_f32_32x32x16_bf16 v[144:159], a[84:87], v[132:135], v[144:159]
    ds_read_b64_tr_b16 a[68:69], v7 offset:20480
    ds_read_b64_tr_b16 a[70:71], v7 offset:20992
    v_add_u32 v18, s52, v18
    v_mfma_f32_32x32x16_bf16 v[144:159], a[88:91], v[136:139], v[144:159]
    ds_read_b64_tr_b16 a[72:73], v7 offset:24576
    ds_read_b64_tr_b16 a[74:75], v7 offset:25088
    buffer_store_dwordx4 v[248:251], v1, s[24:27], s82 offen offset:3072 sc1
    v_mfma_f32_32x32x16_bf16 v[144:159], a[92:95], v[140:143], v[144:159]
    ds_read_b64_tr_b16 a[76:77], v7 offset:28672
    ds_read_b64_tr_b16 a[78:79], v7 offset:29184
    s_waitcnt lgkmcnt(8)
    v_mfma_f32_32x32x16_bf16 v[160:175], a[96:99], v[80:83], v[160:175]
    ds_read_b64_tr_b16 a[80:81], v7 offset:32768
    ds_read_b64_tr_b16 a[82:83], v7 offset:33280
    v_cmp_le_u32 vcc, 2, v18
    v_mov_b32 v211, 0x3f803f80
    s_nop 0
    v_cndmask_b32 v210, 0, v211, vcc
    v_mfma_f32_32x32x16_bf16 v[160:175], a[100:103], v[84:87], v[160:175]
    ds_read_b64_tr_b16 a[84:85], v7 offset:36864
    ds_read_b64_tr_b16 a[86:87], v7 offset:37376
    v_bfe_u32 v15, v0, 1, 1
    v_bfe_u32 v18, v0, 4, 1
    v_lshl_add_u32 v15, v18, 1, v15
    v_bfe_u32 v14, v0, 2, 2
    v_mfma_f32_32x32x16_bf16 v[160:175], a[104:107], v[88:91], v[160:175]
    ds_read_b64_tr_b16 a[88:89], v7 offset:40960
    ds_read_b64_tr_b16 a[90:91], v7 offset:41472
    v_mul_f32 v144, 0x3e0622e6, v144
    v_mul_f32 v145, 0x3e0622e6, v145
    v_mul_f32 v146, 0x3e0622e6, v146
    v_mul_f32 v147, 0x3e0622e6, v147
    v_mfma_f32_32x32x16_bf16 v[160:175], a[108:111], v[92:95], v[160:175]
    ds_read_b64_tr_b16 a[92:93], v7 offset:45056
    ds_read_b64_tr_b16 a[94:95], v7 offset:45568
    v_mul_f32 v148, 0x3e0622e6, v148
    v_mul_f32 v149, 0x3e0622e6, v149
    v_mul_f32 v150, 0x3e0622e6, v150
    s_waitcnt lgkmcnt(8)
    v_mfma_f32_32x32x16_bf16 v[160:175], a[64:67], v[96:99], v[160:175]
    ds_read_b64_tr_b16 a[96:97], v4 offset:0
    ds_read_b64_tr_b16 a[98:99], v4 offset:512
    v_mul_f32 v151, 0x3e0622e6, v151
    v_cvt_pk_bf16_f32 v144, v144, v145
    v_cvt_pk_bf16_f32 v145, v146, v147
    v_cvt_pk_bf16_f32 v146, v148, v149
    v_mfma_f32_32x32x16_bf16 v[160:175], a[68:71], v[100:103], v[160:175]
    ds_read_b64_tr_b16 a[100:101], v4 offset:28672
    ds_read_b64_tr_b16 a[102:103], v4 offset:29184
    v_cvt_pk_bf16_f32 v147, v150, v151
    v_mul_f32 v152, 0x3e0622e6, v152
    v_mul_f32 v153, 0x3e0622e6, v153
    v_mul_f32 v154, 0x3e0622e6, v154
    v_mfma_f32_32x32x16_bf16 v[160:175], a[72:75], v[104:107], v[160:175]
    ds_read_b64_tr_b16 a[104:105], v9 offset:0
    ds_read_b64_tr_b16 a[106:107], v9 offset:512
    v_mul_f32 v155, 0x3e0622e6, v155
    v_mul_f32 v156, 0x3e0622e6, v156
    v_mul_f32 v157, 0x3e0622e6, v157
    v_mul_f32 v158, 0x3e0622e6, v158
    v_mfma_f32_32x32x16_bf16 v[160:175], a[76:79], v[108:111], v[160:175]
    ds_read_b64_tr_b16 a[108:109], v9 offset:28672
    ds_read_b64_tr_b16 a[110:111], v9 offset:29184
    v_mul_f32 v159, 0x3e0622e6, v159
    v_cvt_pk_bf16_f32 v152, v152, v153
    v_cvt_pk_bf16_f32 v153, v154, v155
    s_waitcnt lgkmcnt(8)
    v_mfma_f32_32x32x16_bf16 v[160:175], a[80:83], v[112:115], v[160:175]
    ds_read_b64_tr_b16 a[64:65], v2 offset:2048
    ds_read_b64_tr_b16 a[66:67], v2 offset:2560
    v_cvt_pk_bf16_f32 v154, v156, v157
    v_cvt_pk_bf16_f32 v155, v158, v159
    v_permlane32_swap_b32 v144, v146
    v_mfma_f32_32x32x16_bf16 v[160:175], a[84:87], v[116:119], v[160:175]
    ds_read_b64_tr_b16 a[68:69], v2 offset:6144
    ds_read_b64_tr_b16 a[70:71], v2 offset:6656
    v_permlane32_swap_b32 v145, v147
    v_permlane32_swap_b32 v152, v154
    v_mfma_f32_32x32x16_bf16 v[160:175], a[88:91], v[120:123], v[160:175]
    ds_read_b64_tr_b16 a[72:73], v2 offset:10240
    ds_read_b64_tr_b16 a[74:75], v2 offset:10752
    v_permlane32_swap_b32 v153, v155
    v_lshrrev_b32 v18, 5, v0
    v_lshl_add_u32 v14, v18, 2, v14
    v_mfma_f32_32x32x16_bf16 v[160:175], a[92:95], v[124:127], v[160:175]
    ds_read_b64_tr_b16 a[76:77], v2 offset:14336
    ds_read_b64_tr_b16 a[78:79], v2 offset:14848
    v_lshlrev_b32 v18, 2, v15
    v_xor_b32 v14, v14, v18
    v_lshlrev_b32 v14, 4, v14
    s_waitcnt lgkmcnt(8)
    v_mfma_f32_32x32x16_bf16 v[160:175], a[96:99], v[128:131], v[160:175]
    ds_read_b64_tr_b16 a[80:81], v2 offset:18432
    ds_read_b64_tr_b16 a[82:83], v2 offset:18944
    v_lshl_add_u32 v14, v15, 9, v14
    v_and_b32 v18, 1, v0
    v_lshl_add_u32 v14, v18, 3, v14
    v_add_u32 v14, s60, v14
    v_mfma_f32_32x32x16_bf16 v[160:175], a[100:103], v[132:135], v[160:175]
    ds_read_b64_tr_b16 a[84:85], v2 offset:22528
    ds_read_b64_tr_b16 a[86:87], v2 offset:23040
    v_xor_b32 v15, 128, v14
    s_mov_b32 s34, 0xffffffff
    s_mov_b32 s35, 0xfffffff0
    s_mov_b32 s36, 0xfffffffe
    v_mfma_f32_32x32x16_bf16 v[160:175], a[104:107], v[136:139], v[160:175]
    ds_read_b64_tr_b16 a[88:89], v2 offset:26624
    ds_read_b64_tr_b16 a[90:91], v2 offset:27136
    buffer_store_dwordx4 v[144:147], v1, s[24:27], s14 offen offset:0 sc1
    s_mov_b32 s37, 0xffffffe0
    s_mov_b32 s38, 0xfffffffc
    v_mfma_f32_32x32x16_bf16 v[160:175], a[108:111], v[140:143], v[160:175]
    ds_read_b64_tr_b16 a[92:93], v2 offset:30720
    ds_read_b64_tr_b16 a[94:95], v2 offset:31232
    s_mov_b32 s39, 0xffffffc0
    s_mov_b32 s40, 0xfffffff8
    s_mov_b32 s41, 0xffffff80
    s_waitcnt lgkmcnt(8)
    v_mfma_f32_32x32x16_bf16 v[176:191], a[64:67], v[80:83], v[176:191]
    ds_read_b64_tr_b16 a[96:97], v2 offset:34816
    ds_read_b64_tr_b16 a[98:99], v2 offset:35328
    buffer_store_dwordx4 v[152:155], v1, s[24:27], s14 offen offset:1024 sc1
    s_mov_b32 s42, 0xffffff00
    s_mov_b32 s43, 0xfffff000
    v_mfma_f32_32x32x16_bf16 v[176:191], a[68:71], v[84:87], v[176:191]
    ds_read_b64_tr_b16 a[100:101], v2 offset:38912
    ds_read_b64_tr_b16 a[102:103], v2 offset:39424
    s_mov_b32 s44, 0xfffffe00
    s_mov_b32 s45, 0xffffe000
    s_mov_b32 s46, 0xfffffc00
    s_mov_b32 s47, 0xffffc000
    v_mfma_f32_32x32x16_bf16 v[176:191], a[72:75], v[88:91], v[176:191]
    ds_read_b64_tr_b16 a[104:105], v2 offset:43008
    ds_read_b64_tr_b16 a[106:107], v2 offset:43520
    v_mul_f32 v160, 0x3e0622e6, v160
    v_mul_f32 v161, 0x3e0622e6, v161
    v_mul_f32 v162, 0x3e0622e6, v162
    s_mov_b32 s48, 0xfffff800
    v_mfma_f32_32x32x16_bf16 v[176:191], a[76:79], v[92:95], v[176:191]
    ds_read_b64_tr_b16 a[108:109], v2 offset:47104
    ds_read_b64_tr_b16 a[110:111], v2 offset:47616
    v_mul_f32 v163, 0x3e0622e6, v163
    s_mov_b32 s49, 0xffff8000
    v_mul_f32 v164, 0x3e0622e6, v164
    s_waitcnt lgkmcnt(8)
    v_mfma_f32_32x32x16_bf16 v[176:191], a[80:83], v[96:99], v[176:191]
    ds_read_b64_tr_b16 a[64:65], v5 offset:2048
    ds_read_b64_tr_b16 a[66:67], v5 offset:2560
    s_mov_b32 s50, 0xffff0000
    v_mul_f32 v165, 0x3e0622e6, v165
    s_mov_b32 s51, 0xfff00000
    v_mul_f32 v166, 0x3e0622e6, v166
    s_mov_b32 s52, 0xfffe0000
    v_mfma_f32_32x32x16_bf16 v[176:191], a[84:87], v[100:103], v[176:191]
    ds_read_b64_tr_b16 a[68:69], v5 offset:30720
    ds_read_b64_tr_b16 a[70:71], v5 offset:31232
    v_mul_f32 v167, 0x3e0622e6, v167
    s_mov_b32 s53, 0xffe00000
    v_cvt_pk_bf16_f32 v160, v160, v161
    s_mov_b32 s54, 0xfffc0000
    v_cvt_pk_bf16_f32 v161, v162, v163
    v_mfma_f32_32x32x16_bf16 v[176:191], a[88:91], v[104:107], v[176:191]
    ds_read_b64_tr_b16 a[72:73], v10 offset:2048
    ds_read_b64_tr_b16 a[74:75], v10 offset:2560
    s_mov_b32 s55, 0xffc00000
    v_cvt_pk_bf16_f32 v162, v164, v165
    s_mov_b32 s56, 0xfff80000
    v_cvt_pk_bf16_f32 v163, v166, v167
    s_mov_b32 s57, 0xff800000
    v_mfma_f32_32x32x16_bf16 v[176:191], a[92:95], v[108:111], v[176:191]
    ds_read_b64_tr_b16 a[76:77], v10 offset:30720
    ds_read_b64_tr_b16 a[78:79], v10 offset:31232
    v_mul_f32 v168, 0x3e0622e6, v168
    s_mov_b32 s58, 0xff000000
    v_mul_f32 v169, 0x3e0622e6, v169
    s_mov_b32 s59, 0xf0000000
    s_waitcnt lgkmcnt(8)
    v_mfma_f32_32x32x16_bf16 v[176:191], a[96:99], v[112:115], v[176:191]
    v_mul_f32 v170, 0x3e0622e6, v170
    s_mov_b32 s60, 0xfe000000
    v_mul_f32 v171, 0x3e0622e6, v171
    s_mov_b32 s61, 0xe0000000
    v_mul_f32 v172, 0x3e0622e6, v172
    s_mov_b32 s62, 0xfc000000
    v_mul_f32 v173, 0x3e0622e6, v173
    v_mfma_f32_32x32x16_bf16 v[176:191], a[100:103], v[116:119], v[176:191]
    s_mov_b32 s63, 0xc0000000
    v_mul_f32 v174, 0x3e0622e6, v174
    s_mov_b32 s64, 0xf8000000
    v_mul_f32 v175, 0x3e0622e6, v175
    s_mov_b32 s65, 0x80000000
    v_cvt_pk_bf16_f32 v168, v168, v169
    v_lshrrev_b32 v207, 5, v0
    v_mfma_f32_32x32x16_bf16 v[176:191], a[104:107], v[120:123], v[176:191]
    v_cvt_pk_bf16_f32 v169, v170, v171
    v_mad_u32_u24 v207, v207, 36, 32
    v_cvt_pk_bf16_f32 v170, v172, v173
    v_sub_u32 v207, v207, v0
    v_cvt_pk_bf16_f32 v171, v174, v175
    v_mul_u32_u24 v207, 0x10001, v207
    v_add_u32 v207, -1, v207
    v_mfma_f32_32x32x16_bf16 v[176:191], a[108:111], v[124:127], v[176:191]
    v_permlane32_swap_b32 v160, v162
    v_pk_sub_i16 v200, v207, 32 op_sel_hi:[1,0]
    v_permlane32_swap_b32 v161, v163
    v_pk_sub_i16 v201, v207, 30 op_sel_hi:[1,0]
    s_waitcnt lgkmcnt(0)
    v_mfma_f32_32x32x16_bf16 v[176:191], a[64:67], v[128:131], v[176:191]
    v_pk_sub_i16 v202, v207, 24 op_sel_hi:[1,0]
    v_permlane32_swap_b32 v168, v170
    v_pk_sub_i16 v203, v207, 22 op_sel_hi:[1,0]
    v_pk_sub_i16 v204, v207, 16 op_sel_hi:[1,0]
    v_permlane32_swap_b32 v169, v171
    v_mfma_f32_32x32x16_bf16 v[176:191], a[68:71], v[132:135], v[176:191]
    buffer_store_dwordx4 v[160:163], v1, s[24:27], s14 offen offset:2048 sc1
    v_pk_sub_i16 v205, v207, 14 op_sel_hi:[1,0]
    v_pk_sub_i16 v206, v207, 8 op_sel_hi:[1,0]
    v_pk_sub_i16 v207, v207, 6 op_sel_hi:[1,0]
    v_pk_ashrrev_i16 v200, 15, v200 op_sel_hi:[0,1]
    v_mfma_f32_32x32x16_bf16 v[176:191], a[72:75], v[136:139], v[176:191]
    v_pk_ashrrev_i16 v201, 15, v201 op_sel_hi:[0,1]
    v_pk_ashrrev_i16 v202, 15, v202 op_sel_hi:[0,1]
    v_pk_ashrrev_i16 v203, 15, v203 op_sel_hi:[0,1]
    v_pk_ashrrev_i16 v204, 15, v204 op_sel_hi:[0,1]
    v_pk_ashrrev_i16 v205, 15, v205 op_sel_hi:[0,1]
    v_pk_ashrrev_i16 v206, 15, v206 op_sel_hi:[0,1]
    v_mfma_f32_32x32x16_bf16 v[176:191], a[76:79], v[140:143], v[176:191]
    buffer_store_dwordx4 v[168:171], v1, s[24:27], s14 offen offset:3072 sc1
    v_pk_ashrrev_i16 v207, 15, v207 op_sel_hi:[0,1]
    s_mov_b64 s[76:77], 0
    s_buffer_load_dwordx2 s[76:77], s[24:27], s74 offset:0
    s_nop 7
    v_mul_f32 v176, 0x3e0622e6, v176
    v_mul_f32 v177, 0x3e0622e6, v177
    v_mul_f32 v178, 0x3e0622e6, v178
    v_mul_f32 v179, 0x3e0622e6, v179
    v_mul_f32 v180, 0x3e0622e6, v180
    v_mul_f32 v181, 0x3e0622e6, v181
    v_mul_f32 v182, 0x3e0622e6, v182
    v_mul_f32 v183, 0x3e0622e6, v183
    v_cvt_pk_bf16_f32 v176, v176, v177
    v_cvt_pk_bf16_f32 v177, v178, v179
    v_cvt_pk_bf16_f32 v178, v180, v181
    v_cvt_pk_bf16_f32 v179, v182, v183
    v_mul_f32 v184, 0x3e0622e6, v184
    v_mul_f32 v185, 0x3e0622e6, v185
    v_mul_f32 v186, 0x3e0622e6, v186
    v_mul_f32 v187, 0x3e0622e6, v187
    v_mul_f32 v188, 0x3e0622e6, v188
    v_mul_f32 v189, 0x3e0622e6, v189
    v_mul_f32 v190, 0x3e0622e6, v190
    v_mul_f32 v191, 0x3e0622e6, v191
    v_cvt_pk_bf16_f32 v184, v184, v185
    v_cvt_pk_bf16_f32 v185, v186, v187
    v_cvt_pk_bf16_f32 v186, v188, v189
    v_cvt_pk_bf16_f32 v187, v190, v191
    v_permlane32_swap_b32 v176, v178
    v_permlane32_swap_b32 v177, v179
    v_permlane32_swap_b32 v184, v186
    v_permlane32_swap_b32 v185, v187
    buffer_store_dwordx4 v[176:179], v1, s[24:27], s15 offen offset:0 sc1
    buffer_store_dwordx4 v[184:187], v1, s[24:27], s15 offen offset:1024 sc1
    s_and_b32 vcc_hi, s76, s77
    s_andn2_b32 vcc_hi, s90, vcc_hi
    s_cbranch_scc1 L_slow_kvQ
L_back_kvQ:
    s_barrier
    s_lshr_b32 s1, s99, 1
    s_add_u32 m0, s1, 0
    s_nop 0
    buffer_load_dwordx4 v30, s[24:27], s85 offen sc1 lds
    buffer_load_dwordx4 v31, s[24:27], s85 offen offset:1024 sc1 lds
    s_add_u32 m0, s1, 8192
    s_nop 0
    buffer_load_dwordx4 v12, s[24:27], s86 offen sc1 lds
    buffer_load_dwordx4 v13, s[24:27], s86 offen offset:1024 sc1 lds
    s_add_u32 m0, s1, 16384
    s_nop 0
    buffer_load_dwordx4 v22, s[24:27], s87 offen sc1 lds
    buffer_load_dwordx4 v23, s[24:27], s87 offen offset:1024 sc1 lds
    s_add_u32 m0, s1, 24576
    s_nop 0
    buffer_load_dwordx4 v22, s[24:27], s88 offen sc1 lds
    buffer_load_dwordx4 v23, s[24:27], s88 offen offset:1024 sc1 lds
    s_add_u32 m0, s1, 32768
    s_nop 0
    buffer_load_dwordx4 v22, s[24:27], s89 offen sc1 lds
    buffer_load_dwordx4 v23, s[24:27], s89 offen offset:1024 sc1 lds
    s_add_u32 m0, s1, 40960
    s_add_u32 s88, s87, 28672
    buffer_load_dwordx4 v22, s[24:27], s88 offen sc1 lds
    buffer_load_dwordx4 v23, s[24:27], s88 offen offset:1024 sc1 lds
    v_add_u32 v22, s1, v22
    v_add_u32 v23, s1, v23
    s_waitcnt vmcnt(12)
    s_buffer_atomic_or s75, s[24:27], s79 offset:0
    s_waitcnt vmcnt(6)
    s_mov_b32 s78, 0
    s_buffer_load_dword s78, s[24:27], s73 offset:2048
    s_waitcnt vmcnt(0)
    ds_write_b32 v208, v210
    ds_write_b32 v209, v211
    s_waitcnt lgkmcnt(0)
    s_barrier
    ds_read_b128 a[208:211], v22 offset:0
    ds_read_b128 a[212:215], v23 offset:1024
    ds_read_b128 a[216:219], v22 offset:16384
    ds_read_b128 a[220:223], v23 offset:17408
    ds_read_b128 a[80:83], v22 offset:2048
    ds_read_b128 a[84:87], v23 offset:3072
    ds_read_b128 a[88:91], v22 offset:4096
    ds_read_b128 a[92:95], v23 offset:5120
    ds_read_b128 a[64:67], v22 offset:6144
    ds_read_b128 a[68:71], v23 offset:7168
    ds_read_b128 a[72:75], v22 offset:8192
    ds_read_b128 a[76:79], v23 offset:9216
    ds_read_b128 a[96:99], v22 offset:10240
    ds_read_b128 a[100:103], v23 offset:11264
    ds_read_b128 a[104:107], v22 offset:12288
    ds_read_b128 a[108:111], v23 offset:13312
    ds_read_b128 a[240:243], v22 offset:14336
    ds_read_b128 a[244:247], v23 offset:15360
    s_andn2_b32 vcc_hi, s96, s78
    s_cbranch_scc1 L_slow_qQ
L_back_qQ:
    s_sub_u32 s1, s87, 28672
    buffer_load_dwordx4 v[192:195], v1, s[24:27], s1 offen offset:0 sc1
    buffer_load_dwordx4 v[196:199], v1, s[24:27], s1 offen offset:1024 sc1
    s_waitcnt vmcnt(0)
    v_cndmask_b32 v192, v192, 0, s[92:93]
    v_cndmask_b32 v193, v193, 0, s[92:93]
    v_cndmask_b32 v198, v198, 0, s[94:95]
    v_cndmask_b32 v199, v199, 0, s[94:95]
    s_waitcnt lgkmcnt(15)
    v_mfma_f32_32x32x16_bf16 v[144:159], a[208:211], v[192:195], 0
    v_mfma_f32_32x32x16_bf16 v[144:159], a[212:215], v[196:199], v[144:159]
    ds_read_b64_tr_b16 a[208:209], v14 offset:0
    ds_read_b64_tr_b16 a[210:211], v15 offset:0
    ds_read_b64_tr_b16 a[212:213], v14 offset:256
    ds_read_b64_tr_b16 a[214:215], v15 offset:256
    s_waitcnt lgkmcnt(15)
    v_mfma_f32_32x32x16_bf16 v[160:175], a[216:219], v[192:195], 0
    v_mfma_f32_32x32x16_bf16 v[160:175], a[220:223], v[196:199], v[160:175]
    ds_read_b64_tr_b16 a[216:217], v14 offset:16384
    ds_read_b64_tr_b16 a[218:219], v15 offset:16384
    ds_read_b64_tr_b16 a[220:221], v14 offset:16640
    ds_read_b64_tr_b16 a[222:223], v15 offset:16640
    s_nop 7
    v_cndmask_b32 v144, v144, v160, s[34:35]
    v_cndmask_b32 v145, v145, v161, s[36:37]
    v_cndmask_b32 v146, v146, v162, s[38:39]
    v_cndmask_b32 v147, v147, v163, s[40:41]
    v_cndmask_b32 v148, v148, v164, s[42:43]
    v_cndmask_b32 v149, v149, v165, s[44:45]
    v_cndmask_b32 v150, v150, v166, s[46:47]
    v_cndmask_b32 v151, v151, v167, s[48:49]
    v_max3_f32 v2, v144, v145, v144
    v_max3_f32 v3, v146, v147, v146
    v_cndmask_b32 v152, v152, v168, s[50:51]
    v_cndmask_b32 v153, v153, v169, s[52:53]
    v_cndmask_b32 v154, v154, v170, s[54:55]
    v_cndmask_b32 v155, v155, v171, s[56:57]
    v_max3_f32 v2, v148, v149, v2
    v_max3_f32 v3, v150, v151, v3
    v_cndmask_b32 v156, v156, v172, s[58:59]
    v_cndmask_b32 v157, v157, v173, s[60:61]
    v_cndmask_b32 v158, v158, v174, s[62:63]
    v_cndmask_b32 v159, v159, v175, s[64:65]
    v_max3_f32 v2, v152, v153, v2
    v_max3_f32 v3, v154, v155, v3
    v_max3_f32 v2, v156, v157, v2
    v_max3_f32 v3, v158, v159, v3
    v_max_f32 v2, v2, v3
    v_mov_b32 v3, v2
    s_nop 1
    v_permlane32_swap_b32 v2, v3
    v_max_f32 v2, v2, v3
    v_sub_f32 v208, 0xc2c00000, v2
    v_mov_b32 v209, v208
    v_mov_b32 v210, v208
    v_mov_b32 v211, v208
    v_mov_b32 v212, v208
    v_mov_b32 v213, v208
    v_mov_b32 v214, v208
    v_mov_b32 v215, v208
    v_mov_b32 v216, v208
    v_mov_b32 v217, v208
    v_mov_b32 v218, v208
    v_mov_b32 v219, v208
    v_mov_b32 v220, v208
    v_mov_b32 v221, v208
    v_mov_b32 v222, v208
    v_mov_b32 v223, v208
    v_add_f32 v144, v144, v208
    v_add_f32 v145, v145, v208
    v_add_f32 v146, v146, v208
    v_add_f32 v147, v147, v208
    v_add_f32 v148, v148, v208
    v_add_f32 v149, v149, v208
    v_add_f32 v150, v150, v208
    v_add_f32 v151, v151, v208
    v_add_f32 v152, v152, v208
    v_add_f32 v153, v153, v208
    v_add_f32 v154, v154, v208
    v_add_f32 v155, v155, v208
    v_add_f32 v156, v156, v208
    v_add_f32 v157, v157, v208
    v_add_f32 v158, v158, v208
    v_add_f32 v159, v159, v208
    v_exp_f32 v144, v144
    v_exp_f32 v145, v145
    v_exp_f32 v146, v146
    v_exp_f32 v147, v147
    v_mfma_f32_32x32x16_bf16 v[176:191], a[80:83], v[192:195], v[208:223]
    ds_read_b64_tr_b16 a[80:81], v14 offset:2048
    v_exp_f32 v148, v148
    v_exp_f32 v149, v149
    v_exp_f32 v150, v150
    v_exp_f32 v151, v151
    v_cvt_pk_bf16_f32 v224, v144, v145
    v_cvt_pk_bf16_f32 v225, v146, v147
    v_mfma_f32_32x32x16_bf16 v[176:191], a[84:87], v[196:199], v[176:191]
    ds_read_b64_tr_b16 a[82:83], v15 offset:2048
    v_exp_f32 v152, v152
    v_exp_f32 v153, v153
    v_exp_f32 v154, v154
    v_exp_f32 v155, v155
    v_cvt_pk_bf16_f32 v226, v148, v149
    v_cvt_pk_bf16_f32 v227, v150, v151
    v_mfma_f32_32x32x16_bf16 v[160:175], a[88:91], v[192:195], v[208:223]
    ds_read_b64_tr_b16 a[84:85], v14 offset:2304
    v_exp_f32 v156, v156
    v_exp_f32 v157, v157
    v_exp_f32 v158, v158
    v_exp_f32 v159, v159
    v_cvt_pk_bf16_f32 v228, v152, v153
    v_cvt_pk_bf16_f32 v229, v154, v155
    s_waitcnt lgkmcnt(15)
    v_mfma_f32_32x32x16_bf16 v[160:175], a[92:95], v[196:199], v[160:175]
    ds_read_b64_tr_b16 a[86:87], v15 offset:2304
    ds_read_b64_tr_b16 a[88:89], v14 offset:4096
    ds_read_b64_tr_b16 a[90:91], v15 offset:4096
    ds_read_b64_tr_b16 a[92:93], v14 offset:4352
    ds_read_b64_tr_b16 a[94:95], v15 offset:4352
    v_cvt_pk_bf16_f32 v230, v156, v157
    v_cvt_pk_bf16_f32 v231, v158, v159
    v_and_b32 v232, v200, v224
    v_and_b32 v233, v201, v225
    v_and_b32 v234, v202, v226
    v_and_b32 v235, v203, v227
    v_and_b32 v236, v204, v228
    v_and_b32 v237, v205, v229
    v_and_b32 v238, v206, v230
    v_and_b32 v239, v207, v231
    v_xor_b32 v224, v232, v224
    v_xor_b32 v225, v233, v225
    v_xor_b32 v226, v234, v226
    v_xor_b32 v227, v235, v227
    v_xor_b32 v228, v236, v228
    v_xor_b32 v229, v237, v229
    v_xor_b32 v230, v238, v230
    v_xor_b32 v231, v239, v231
    v_exp_f32 v176, v176
    v_exp_f32 v177, v177
    v_exp_f32 v178, v178
    v_exp_f32 v179, v179
    s_waitcnt lgkmcnt(8)
    v_mfma_f32_32x32x16_bf16 v[240:255], a[208:211], v[224:227], 0
    v_exp_f32 v180, v180
    v_exp_f32 v181, v181
    v_exp_f32 v182, v182
    v_exp_f32 v183, v183
    v_cvt_pk_bf16_f32 v200, v176, v177
    s_branch L_overQ4
    .p2align 12
L_padQ4:
    s_branch L_retQa
L_overQ4:
    v_cvt_pk_bf16_f32 v201, v178, v179
    v_mfma_f32_32x32x16_bf16 v[240:255], a[212:215], v[228:231], v[240:255]
    v_exp_f32 v184, v184
    v_exp_f32 v185, v185
    v_exp_f32 v186, v186
    v_exp_f32 v187, v187
    v_cvt_pk_bf16_f32 v202, v180, v181
    v_cvt_pk_bf16_f32 v203, v182, v183
    v_mfma_f32_32x32x16_bf16 v[240:255], a[216:219], v[232:235], v[240:255]
    v_exp_f32 v188, v188
    v_exp_f32 v189, v189
    v_exp_f32 v190, v190
    v_exp_f32 v191, v191
    v_cvt_pk_bf16_f32 v204, v184, v185
    v_cvt_pk_bf16_f32 v205, v186, v187
    v_mfma_f32_32x32x16_bf16 v[240:255], a[220:223], v[236:239], v[240:255]
    v_cvt_pk_bf16_f32 v206, v188, v189
    v_cvt_pk_bf16_f32 v207, v190, v191
    v_exp_f32 v160, v160
    v_exp_f32 v161, v161
    v_exp_f32 v162, v162
    v_exp_f32 v163, v163
    v_mfma_f32_32x32x16_bf16 v[144:159], a[64:67], v[192:195], v[208:223]
    ds_read_b64_tr_b16 a[64:65], v14 offset:6144
    v_exp_f32 v164, v164
    v_exp_f32 v165, v165
    v_exp_f32 v166, v166
    v_exp_f32 v167, v167
    v_cvt_pk_bf16_f32 v224, v160, v161
    v_cvt_pk_bf16_f32 v225, v162, v163
    v_mfma_f32_32x32x16_bf16 v[144:159], a[68:71], v[196:199], v[144:159]
    ds_read_b64_tr_b16 a[66:67], v15 offset:6144
    v_exp_f32 v168, v168
    v_exp_f32 v169, v169
    v_exp_f32 v170, v170
    v_exp_f32 v171, v171
    v_cvt_pk_bf16_f32 v226, v164, v165
    v_cvt_pk_bf16_f32 v227, v166, v167
    s_waitcnt lgkmcnt(6)
    v_mfma_f32_32x32x16_bf16 v[240:255], a[80:83], v[200:203], v[240:255]
    ds_read_b64_tr_b16 a[68:69], v14 offset:6400
    v_exp_f32 v172, v172
    v_exp_f32 v173, v173
    v_exp_f32 v174, v174
    v_exp_f32 v175, v175
    v_cvt_pk_bf16_f32 v228, v168, v169
    v_cvt_pk_bf16_f32 v229, v170, v171
    v_mfma_f32_32x32x16_bf16 v[240:255], a[84:87], v[204:207], v[240:255]
    ds_read_b64_tr_b16 a[70:71], v15 offset:6400
    v_cvt_pk_bf16_f32 v230, v172, v173
    v_cvt_pk_bf16_f32 v231, v174, v175
    v_exp_f32 v144, v144
    v_exp_f32 v145, v145
    v_exp_f32 v146, v146
    v_exp_f32 v147, v147
    v_mfma_f32_32x32x16_bf16 v[176:191], a[72:75], v[192:195], v[208:223]
    ds_read_b64_tr_b16 a[72:73], v14 offset:8192
    v_exp_f32 v148, v148
    v_exp_f32 v149, v149
    v_exp_f32 v150, v150
    v_exp_f32 v151, v151
    v_cvt_pk_bf16_f32 v200, v144, v145
    v_cvt_pk_bf16_f32 v201, v146, v147
    v_mfma_f32_32x32x16_bf16 v[176:191], a[76:79], v[196:199], v[176:191]
    ds_read_b64_tr_b16 a[74:75], v15 offset:8192
    v_exp_f32 v152, v152
    v_exp_f32 v153, v153
    v_exp_f32 v154, v154
    v_exp_f32 v155, v155
    v_cvt_pk_bf16_f32 v202, v148, v149
    v_cvt_pk_bf16_f32 v203, v150, v151
    s_waitcnt lgkmcnt(6)
    v_mfma_f32_32x32x16_bf16 v[240:255], a[88:91], v[224:227], v[240:255]
    ds_read_b64_tr_b16 a[76:77], v14 offset:8448
    v_exp_f32 v156, v156
    v_exp_f32 v157, v157
    v_exp_f32 v158, v158
    v_exp_f32 v159, v159
    v_cvt_pk_bf16_f32 v204, v152, v153
    v_cvt_pk_bf16_f32 v205, v154, v155
    v_mfma_f32_32x32x16_bf16 v[240:255], a[92:95], v[228:231], v[240:255]
    ds_read_b64_tr_b16 a[78:79], v15 offset:8448
    v_cvt_pk_bf16_f32 v206, v156, v157
    v_cvt_pk_bf16_f32 v207, v158, v159
    v_exp_f32 v176, v176
    v_exp_f32 v177, v177
    v_exp_f32 v178, v178
    v_exp_f32 v179, v179
    v_mfma_f32_32x32x16_bf16 v[160:175], a[96:99], v[192:195], v[208:223]
    ds_read_b64_tr_b16 a[96:97], v14 offset:10240
    v_exp_f32 v180, v180
    v_exp_f32 v181, v181
    v_exp_f32 v182, v182
    v_exp_f32 v183, v183
    v_cvt_pk_bf16_f32 v224, v176, v177
    v_cvt_pk_bf16_f32 v225, v178, v179
    v_mfma_f32_32x32x16_bf16 v[160:175], a[100:103], v[196:199], v[160:175]
    ds_read_b64_tr_b16 a[98:99], v15 offset:10240
    v_exp_f32 v184, v184
    v_exp_f32 v185, v185
    v_exp_f32 v186, v186
    v_exp_f32 v187, v187
    v_cvt_pk_bf16_f32 v226, v180, v181
    v_cvt_pk_bf16_f32 v227, v182, v183
    s_waitcnt lgkmcnt(6)
    v_mfma_f32_32x32x16_bf16 v[240:255], a[64:67], v[200:203], v[240:255]
    ds_read_b64_tr_b16 a[100:101], v14 offset:10496
    v_exp_f32 v188, v188
    v_exp_f32 v189, v189
    v_exp_f32 v190, v190
    v_exp_f32 v191, v191
    v_cvt_pk_bf16_f32 v228, v184, v185
    v_cvt_pk_bf16_f32 v229, v186, v187
    v_mfma_f32_32x32x16_bf16 v[240:255], a[68:71], v[204:207], v[240:255]
    ds_read_b64_tr_b16 a[102:103], v15 offset:10496
    v_cvt_pk_bf16_f32 v230, v188, v189
    v_cvt_pk_bf16_f32 v231, v190, v191
    v_exp_f32 v160, v160
    v_exp_f32 v161, v161
    v_exp_f32 v162, v162
    v_exp_f32 v163, v163
    v_mfma_f32_32x32x16_bf16 v[144:159], a[104:107], v[192:195], v[208:223]
    ds_read_b64_tr_b16 a[104:105], v14 offset:12288
    v_exp_f32 v164, v164
    v_exp_f32 v165, v165
    v_exp_f32 v166, v166
    v_exp_f32 v167, v167
    v_cvt_pk_bf16_f32 v200, v160, v161
    v_cvt_pk_bf16_f32 v201, v162, v163
    v_mfma_f32_32x32x16_bf16 v[144:159], a[108:111], v[196:199], v[144:159]
    ds_read_b64_tr_b16 a[106:107], v15 offset:12288
    v_exp_f32 v168, v168
    v_exp_f32 v169, v169
    v_exp_f32 v170, v170
    v_exp_f32 v171, v171
    v_cvt_pk_bf16_f32 v202, v164, v165
    v_cvt_pk_bf16_f32 v203, v166, v167
    s_waitcnt lgkmcnt(6)
    v_mfma_f32_32x32x16_bf16 v[240:255], a[72:75], v[224:227], v[240:255]
    ds_read_b64_tr_b16 a[108:109], v14 offset:12544
    v_exp_f32 v172, v172
    v_exp_f32 v173, v173
    v_exp_f32 v174, v174
    v_exp_f32 v175, v175
    v_cvt_pk_bf16_f32 v204, v168, v169
    v_cvt_pk_bf16_f32 v205, v170, v171
    v_mfma_f32_32x32x16_bf16 v[240:255], a[76:79], v[228:231], v[240:255]
    ds_read_b64_tr_b16 a[110:111], v15 offset:12544
    v_cvt_pk_bf16_f32 v206, v172, v173
    v_cvt_pk_bf16_f32 v207, v174, v175
    v_exp_f32 v144, v144
    v_exp_f32 v145, v145
    v_exp_f32 v146, v146
    v_exp_f32 v147, v147
    v_mfma_f32_32x32x16_bf16 v[176:191], a[240:243], v[192:195], v[208:223]
    ds_read_b64_tr_b16 a[240:241], v14 offset:14336
    v_exp_f32 v148, v148
    v_exp_f32 v149, v149
    v_exp_f32 v150, v150
    v_exp_f32 v151, v151
    v_cvt_pk_bf16_f32 v224, v144, v145
    v_cvt_pk_bf16_f32 v225, v146, v147
    v_mfma_f32_32x32x16_bf16 v[176:191], a[244:247], v[196:199], v[176:191]
    ds_read_b64_tr_b16 a[242:243], v15 offset:14336
    v_exp_f32 v152, v152
    v_exp_f32 v153, v153
    v_exp_f32 v154, v154
    v_exp_f32 v155, v155
    v_cvt_pk_bf16_f32 v226, v148, v149
    v_cvt_pk_bf16_f32 v227, v150, v151
    s_waitcnt lgkmcnt(6)
    v_mfma_f32_32x32x16_bf16 v[240:255], a[96:99], v[200:203], v[240:255]
    ds_read_b64_tr_b16 a[244:245], v14 offset:14592
    v_exp_f32 v156, v156
    v_exp_f32 v157, v157
    v_exp_f32 v158, v158
    v_exp_f32 v159, v159
    v_cvt_pk_bf16_f32 v228, v152, v153
    v_cvt_pk_bf16_f32 v229, v154, v155
    v_mfma_f32_32x32x16_bf16 v[240:255], a[100:103], v[204:207], v[240:255]
    ds_read_b64_tr_b16 a[246:247], v15 offset:14592
    v_cvt_pk_bf16_f32 v230, v156, v157
    v_cvt_pk_bf16_f32 v231, v158, v159
    v_exp_f32 v176, v176
    v_exp_f32 v177, v177
    v_exp_f32 v178, v178
    v_exp_f32 v179, v179
    s_waitcnt lgkmcnt(4)
    v_mfma_f32_32x32x16_bf16 v[240:255], a[104:107], v[224:227], v[240:255]
    v_exp_f32 v180, v180
    v_exp_f32 v181, v181
    v_exp_f32 v182, v182
    v_exp_f32 v183, v183
    v_cvt_pk_bf16_f32 v200, v176, v177
    v_cvt_pk_bf16_f32 v201, v178, v179
    v_mfma_f32_32x32x16_bf16 v[240:255], a[108:111], v[228:231], v[240:255]
    v_exp_f32 v184, v184
    v_exp_f32 v185, v185
    v_exp_f32 v186, v186
    v_exp_f32 v187, v187
    v_cvt_pk_bf16_f32 v202, v180, v181
    v_cvt_pk_bf16_f32 v203, v182, v183
    v_exp_f32 v188, v188
    v_exp_f32 v189, v189
    v_exp_f32 v190, v190
    v_exp_f32 v191, v191
    v_cvt_pk_bf16_f32 v204, v184, v185
    v_cvt_pk_bf16_f32 v205, v186, v187
    v_cvt_pk_bf16_f32 v206, v188, v189
    v_cvt_pk_bf16_f32 v207, v190, v191
    s_waitcnt lgkmcnt(0)
    v_mfma_f32_32x32x16_bf16 v[240:255], a[240:243], v[200:203], v[240:255]
    v_mfma_f32_32x32x16_bf16 v[240:255], a[244:247], v[204:207], v[240:255]
    s_nop 11
    v_cndmask_b32 v2, 0, v240, s[92:93]
    v_cndmask_b32 v2, v2, v252, s[94:95]
    v_mov_b32 v3, v2
    v_maximum3_f32 v4, |v240|, |v241|, |v242|
    v_maximum3_f32 v4, v4, |v243|, |v244|
    v_permlane32_swap_b32 v2, v3
    v_add_f32 v2, v2, v3
    v_rcp_f32 v2, v2
    v_maximum3_f32 v4, v4, |v245|, |v246|
    v_maximum3_f32 v4, v4, |v247|, |v248|
    v_maximum3_f32 v4, v4, |v249|, |v250|
    v_maximum3_f32 v4, v4, |v251|, |v252|
    v_maximum3_f32 v4, v4, |v253|, |v254|
    v_mul_f32 v3, 0x49800000, v2
    v_maximum3_f32 v4, v4, |v255|, v3
    v_cmp_ngt_f32 vcc, 0x7b800000, v4
    s_cbranch_vccnz L_slowattQ
L_backattQ:
    v_mul_f32 v2, 0x3ef5fdf0, v2
    v_cndmask_b32 v3, v2, 0, s[92:93]
    v_cndmask_b32 v4, v2, 0, s[94:95]
    v_mul_f32 v244, v2, v244
    v_mul_f32 v245, v2, v245
    v_mul_f32 v246, v2, v246
    v_mul_f32 v247, v2, v247
    v_mul_f32 v248, v2, v248
    v_mul_f32 v249, v2, v249
    v_mul_f32 v250, v2, v250
    v_mul_f32 v251, v2, v251
    v_mul_f32 v240, v3, v240
    v_mul_f32 v241, v3, v241
    v_mul_f32 v242, v3, v242
    v_mul_f32 v243, v3, v243
    v_mul_f32 v252, v4, v252
    v_mul_f32 v253, v4, v253
    v_mul_f32 v254, v4, v254
    v_mul_f32 v255, v4, v255
    v_cvt_pk_bf16_f32 v232, v240, v241
    v_cvt_pk_bf16_f32 v233, v242, v243
    v_cvt_pk_bf16_f32 v234, v244, v245
    v_cvt_pk_bf16_f32 v235, v246, v247
    v_cvt_pk_bf16_f32 v236, v248, v249
    v_cvt_pk_bf16_f32 v237, v250, v251
    v_cvt_pk_bf16_f32 v238, v252, v253
    v_cvt_pk_bf16_f32 v239, v254, v255
    buffer_store_dwordx4 v[232:235], v1, s[24:27], s98 offen offset:0 sc1
    buffer_store_dwordx4 v[236:239], v1, s[24:27], s98 offen offset:1024 sc1
    s_waitcnt vmcnt(0)
    s_buffer_atomic_or s91, s[24:27], s83 offset:12288
    s_waitcnt lgkmcnt(0)
    s_endpgm
L_slow_dbgG:
    s_waitcnt lgkmcnt(0)
    s_cmp_lg_u32 s76, 0x1010101
    s_cbranch_scc0 L_back_dbgG
    v_mov_b32 v29, 0
    s_mov_b32 s3, 65536
L_spin_dbgG:
    global_load_dword v28, v29, s[32:33] sc1
    s_waitcnt vmcnt(0)
    v_readfirstlane_b32 s76, v28
    s_nop 1
    s_cmp_lg_u32 s76, 0x1010101
    s_cbranch_scc0 L_back_dbgG
    s_sub_u32 s3, s3, 1
    s_cmp_lg_u32 s3, 0
    s_cbranch_scc1 L_spin_dbgG
    s_branch L_back_dbgG
L_slow_kvG:
    s_waitcnt lgkmcnt(0)
    s_and_b32 vcc_hi, s76, s77
    s_andn2_b32 vcc_hi, s90, vcc_hi
    s_cbranch_scc0 L_back_kvG
    s_add_u32 s2, s74, 0
    s_mov_b32 s3, 65536
L_spin_kvG:
    buffer_load_dwordx2 v[28:29], off, s[24:27], s2 sc1
    s_waitcnt vmcnt(0)
    v_readfirstlane_b32 s76, v28
    v_readfirstlane_b32 s77, v29
    s_nop 1
    s_and_b32 vcc_hi, s76, s77
    s_andn2_b32 vcc_hi, s90, vcc_hi
    s_cbranch_scc0 L_back_kvG
    s_sub_u32 s3, s3, 1
    s_cmp_lg_u32 s3, 0
    s_cbranch_scc1 L_spin_kvG
    s_branch L_back_kvG
L_slow_qG:
    s_waitcnt lgkmcnt(0)
    s_andn2_b32 vcc_hi, s96, s78
    s_cbranch_scc0 L_back_qG
    s_add_u32 s2, s73, 2048
    s_mov_b32 s3, 65536
L_spin_qG:
    buffer_load_dword v28, off, s[24:27], s2 sc1
    s_waitcnt vmcnt(0)
    v_readfirstlane_b32 s78, v28
    s_nop 1
    s_andn2_b32 vcc_hi, s96, s78
    s_cbranch_scc0 L_back_qG
    s_sub_u32 s3, s3, 1
    s_cmp_lg_u32 s3, 0
    s_cbranch_scc1 L_spin_qG
    s_branch L_back_qG
L_slow_haG:
    s_waitcnt lgkmcnt(0)
    s_andn2_b32 vcc_hi, 0xfffffff, s76
    s_cbranch_scc0 L_back_haG
    s_add_u32 s2, s100, 4096
    s_mov_b32 s3, 65536
L_spin_haG:
    buffer_load_dword v28, off, s[24:27], s2 sc1
    s_waitcnt vmcnt(0)
    v_readfirstlane_b32 s76, v28
    s_nop 1
    s_andn2_b32 vcc_hi, 0xfffffff, s76
    s_cbranch_scc0 L_back_haG
    s_sub_u32 s3, s3, 1
    s_cmp_lg_u32 s3, 0
    s_cbranch_scc1 L_spin_haG
    s_branch L_back_haG
L_slow_hb:
    s_waitcnt lgkmcnt(0)
    s_andn2_b32 vcc_hi, 0xfffffff, s77
    s_cbranch_scc0 L_back_hb
    s_add_u32 s2, s100, 8192
    s_mov_b32 s3, 65536
L_spin_hb:
    buffer_load_dword v28, off, s[24:27], s2 sc1
    s_waitcnt vmcnt(0)
    v_readfirstlane_b32 s77, v28
    s_nop 1
    s_andn2_b32 vcc_hi, 0xfffffff, s77
    s_cbranch_scc0 L_back_hb
    s_sub_u32 s3, s3, 1
    s_cmp_lg_u32 s3, 0
    s_cbranch_scc1 L_spin_hb
    s_branch L_back_hb
L_slow_o:
    s_waitcnt lgkmcnt(0)
    s_andn2_b32 vcc_hi, s68, s78
    s_cbranch_scc0 L_back_o
    s_add_u32 s2, s100, 12288
    s_mov_b32 s3, 65536
L_spin_o:
    buffer_load_dword v28, off, s[24:27], s2 sc1
    s_waitcnt vmcnt(0)
    v_readfirstlane_b32 s78, v28
    s_nop 1
    s_andn2_b32 vcc_hi, s68, s78
    s_cbranch_scc0 L_back_o
    s_sub_u32 s3, s3, 1
    s_cmp_lg_u32 s3, 0
    s_cbranch_scc1 L_spin_o
    s_branch L_back_o
L_slow_dbgQ:
    s_waitcnt lgkmcnt(0)
    s_cmp_lg_u32 s76, 0x1010101
    s_cbranch_scc0 L_back_dbgQ
    v_mov_b32 v29, 0
    s_mov_b32 s3, 65536
L_spin_dbgQ:
    global_load_dword v28, v29, s[32:33] sc1
    s_waitcnt vmcnt(0)
    v_readfirstlane_b32 s76, v28
    s_nop 1
    s_cmp_lg_u32 s76, 0x1010101
    s_cbranch_scc0 L_back_dbgQ
    s_sub_u32 s3, s3, 1
    s_cmp_lg_u32 s3, 0
    s_cbranch_scc1 L_spin_dbgQ
    s_branch L_back_dbgQ
L_slow_kvQ:
    s_waitcnt lgkmcnt(0)
    s_and_b32 vcc_hi, s76, s77
    s_andn2_b32 vcc_hi, s90, vcc_hi
    s_cbranch_scc0 L_back_kvQ
    s_add_u32 s2, s74, 0
    s_waitcnt vmcnt(0)
    s_buffer_atomic_or s75, s[24:27], s79 offset:0
    s_mov_b32 s3, 65536
L_spin_kvQ:
    buffer_load_dwordx2 v[28:29], off, s[24:27], s2 sc1
    s_waitcnt vmcnt(0)
    v_readfirstlane_b32 s76, v28
    v_readfirstlane_b32 s77, v29
    s_nop 1
    s_and_b32 vcc_hi, s76, s77
    s_andn2_b32 vcc_hi, s90, vcc_hi
    s_cbranch_scc0 L_back_kvQ
    s_sub_u32 s3, s3, 1
    s_cmp_lg_u32 s3, 0
    s_cbranch_scc1 L_spin_kvQ
    s_branch L_back_kvQ
L_slow_qQ:
    s_waitcnt lgkmcnt(0)
    s_andn2_b32 vcc_hi, s96, s78
    s_cbranch_scc0 L_back_qQ
    s_add_u32 s2, s73, 2048
    s_mov_b32 s3, 65536
L_spin_qQ:
    buffer_load_dword v28, off, s[24:27], s2 sc1
    s_waitcnt vmcnt(0)
    v_readfirstlane_b32 s78, v28
    s_nop 1
    s_andn2_b32 vcc_hi, s96, s78
    s_cbranch_scc0 L_back_qQ
    s_sub_u32 s3, s3, 1
    s_cmp_lg_u32 s3, 0
    s_cbranch_scc1 L_spin_qQ
    s_branch L_back_qQ
L_pfend:
L_slowattG:
    s_waitcnt lgkmcnt(0)
    s_nop 7
    s_nop 7
    ds_read_b128 a[208:211], v22 offset:0
    ds_read_b128 a[212:215], v23 offset:1024
    s_waitcnt lgkmcnt(0)
    v_mfma_f32_32x32x16_bf16 v[160:175], a[208:211], v[192:195], 0
    v_mfma_f32_32x32x16_bf16 v[160:175], a[212:215], v[196:199], v[160:175]
    s_nop 7
    s_nop 7
    ds_read_b128 a[208:211], v22 offset:16384
    ds_read_b128 a[212:215], v23 offset:17408
    s_waitcnt lgkmcnt(0)
    v_mfma_f32_32x32x16_bf16 v[176:191], a[208:211], v[192:195], 0
    v_mfma_f32_32x32x16_bf16 v[176:191], a[212:215], v[196:199], v[176:191]
    s_nop 7
    s_nop 7
    v_cndmask_b32 v160, v160, v176, s[34:35]
    v_cndmask_b32 v161, v161, v177, s[36:37]
    v_cndmask_b32 v162, v162, v178, s[38:39]
    v_cndmask_b32 v163, v163, v179, s[40:41]
    v_cndmask_b32 v164, v164, v180, s[42:43]
    v_cndmask_b32 v165, v165, v181, s[44:45]
    v_cndmask_b32 v166, v166, v182, s[46:47]
    v_cndmask_b32 v167, v167, v183, s[48:49]
    v_cndmask_b32 v168, v168, v184, s[50:51]
    v_cndmask_b32 v169, v169, v185, s[52:53]
    v_cndmask_b32 v170, v170, v186, s[54:55]
    v_cndmask_b32 v171, v171, v187, s[56:57]
    v_cndmask_b32 v172, v172, v188, s[58:59]
    v_cndmask_b32 v173, v173, v189, s[60:61]
    v_cndmask_b32 v174, v174, v190, s[62:63]
    v_cndmask_b32 v175, v175, v191, s[64:65]
    v_max3_f32 v2, v160, v161, v160
    v_max3_f32 v2, v162, v163, v2
    v_max3_f32 v2, v164, v165, v2
    v_max3_f32 v2, v166, v167, v2
    v_max3_f32 v2, v168, v169, v2
    v_max3_f32 v2, v170, v171, v2
    v_max3_f32 v2, v172, v173, v2
    v_max3_f32 v2, v174, v175, v2
    ds_read_b128 a[208:211], v22 offset:2048
    ds_read_b128 a[212:215], v23 offset:3072
    s_waitcnt lgkmcnt(0)
    v_mfma_f32_32x32x16_bf16 v[160:175], a[208:211], v[192:195], 0
    v_mfma_f32_32x32x16_bf16 v[160:175], a[212:215], v[196:199], v[160:175]
    s_nop 7
    s_nop 7
    v_max3_f32 v2, v160, v161, v2
    v_max3_f32 v2, v162, v163, v2
    v_max3_f32 v2, v164, v165, v2
    v_max3_f32 v2, v166, v167, v2
    v_max3_f32 v2, v168, v169, v2
    v_max3_f32 v2, v170, v171, v2
    v_max3_f32 v2, v172, v173, v2
    v_max3_f32 v2, v174, v175, v2
    ds_read_b128 a[208:211], v22 offset:4096
    ds_read_b128 a[212:215], v23 offset:5120
    s_waitcnt lgkmcnt(0)
    v_mfma_f32_32x32x16_bf16 v[160:175], a[208:211], v[192:195], 0
    v_mfma_f32_32x32x16_bf16 v[160:175], a[212:215], v[196:199], v[160:175]
    s_nop 7
    s_nop 7
    v_max3_f32 v2, v160, v161, v2
    v_max3_f32 v2, v162, v163, v2
    v_max3_f32 v2, v164, v165, v2
    v_max3_f32 v2, v166, v167, v2
    v_max3_f32 v2, v168, v169, v2
    v_max3_f32 v2, v170, v171, v2
    v_max3_f32 v2, v172, v173, v2
    v_max3_f32 v2, v174, v175, v2
    ds_read_b128 a[208:211], v22 offset:6144
    ds_read_b128 a[212:215], v23 offset:7168
    s_waitcnt lgkmcnt(0)
    v_mfma_f32_32x32x16_bf16 v[160:175], a[208:211], v[192:195], 0
    v_mfma_f32_32x32x16_bf16 v[160:175], a[212:215], v[196:199], v[160:175]
    s_nop 7
    s_nop 7
    v_max3_f32 v2, v160, v161, v2
    v_max3_f32 v2, v162, v163, v2
    v_max3_f32 v2, v164, v165, v2
    v_max3_f32 v2, v166, v167, v2
    v_max3_f32 v2, v168, v169, v2
    v_max3_f32 v2, v170, v171, v2
    v_max3_f32 v2, v172, v173, v2
    v_max3_f32 v2, v174, v175, v2
    ds_read_b128 a[208:211], v22 offset:8192
    ds_read_b128 a[212:215], v23 offset:9216
    s_waitcnt lgkmcnt(0)
    v_mfma_f32_32x32x16_bf16 v[160:175], a[208:211], v[192:195], 0
    v_mfma_f32_32x32x16_bf16 v[160:175], a[212:215], v[196:199], v[160:175]
    s_nop 7
    s_nop 7
    v_max3_f32 v2, v160, v161, v2
    v_max3_f32 v2, v162, v163, v2
    v_max3_f32 v2, v164, v165, v2
    v_max3_f32 v2, v166, v167, v2
    v_max3_f32 v2, v168, v169, v2
    v_max3_f32 v2, v170, v171, v2
    v_max3_f32 v2, v172, v173, v2
    v_max3_f32 v2, v174, v175, v2
    ds_read_b128 a[208:211], v22 offset:10240
    ds_read_b128 a[212:215], v23 offset:11264
    s_waitcnt lgkmcnt(0)
    v_mfma_f32_32x32x16_bf16 v[160:175], a[208:211], v[192:195], 0
    v_mfma_f32_32x32x16_bf16 v[160:175], a[212:215], v[196:199], v[160:175]
    s_nop 7
    s_nop 7
    v_max3_f32 v2, v160, v161, v2
    v_max3_f32 v2, v162, v163, v2
    v_max3_f32 v2, v164, v165, v2
    v_max3_f32 v2, v166, v167, v2
    v_max3_f32 v2, v168, v169, v2
    v_max3_f32 v2, v170, v171, v2
    v_max3_f32 v2, v172, v173, v2
    v_max3_f32 v2, v174, v175, v2
    ds_read_b128 a[208:211], v22 offset:12288
    ds_read_b128 a[212:215], v23 offset:13312
    s_waitcnt lgkmcnt(0)
    v_mfma_f32_32x32x16_bf16 v[160:175], a[208:211], v[192:195], 0
    v_mfma_f32_32x32x16_bf16 v[160:175], a[212:215], v[196:199], v[160:175]
    s_nop 7
    s_nop 7
    v_max3_f32 v2, v160, v161, v2
    v_max3_f32 v2, v162, v163, v2
    v_max3_f32 v2, v164, v165, v2
    v_max3_f32 v2, v166, v167, v2
    v_max3_f32 v2, v168, v169, v2
    v_max3_f32 v2, v170, v171, v2
    v_max3_f32 v2, v172, v173, v2
    v_max3_f32 v2, v174, v175, v2
    ds_read_b128 a[208:211], v22 offset:14336
    ds_read_b128 a[212:215], v23 offset:15360
    s_waitcnt lgkmcnt(0)
    v_mfma_f32_32x32x16_bf16 v[160:175], a[208:211], v[192:195], 0
    v_mfma_f32_32x32x16_bf16 v[160:175], a[212:215], v[196:199], v[160:175]
    s_nop 7
    s_nop 7
    v_max3_f32 v2, v160, v161, v2
    v_max3_f32 v2, v162, v163, v2
    v_max3_f32 v2, v164, v165, v2
    v_max3_f32 v2, v166, v167, v2
    v_max3_f32 v2, v168, v169, v2
    v_max3_f32 v2, v170, v171, v2
    v_max3_f32 v2, v172, v173, v2
    v_max3_f32 v2, v174, v175, v2
    v_mov_b32 v3, v2
    s_nop 1
    v_permlane32_swap_b32 v2, v3
    v_max_f32 v2, v2, v3
    v_sub_f32 v208, 0, v2
    v_sub_f32 v209, 0, v2
    v_sub_f32 v210, 0, v2
    v_sub_f32 v211, 0, v2
    v_sub_f32 v212, 0, v2
    v_sub_f32 v213, 0, v2
    v_sub_f32 v214, 0, v2
    v_sub_f32 v215, 0, v2
    v_sub_f32 v216, 0, v2
    v_sub_f32 v217, 0, v2
    v_sub_f32 v218, 0, v2
    v_sub_f32 v219, 0, v2
    v_sub_f32 v220, 0, v2
    v_sub_f32 v221, 0, v2
    v_sub_f32 v222, 0, v2
    v_sub_f32 v223, 0, v2
    v_lshrrev_b32 v207, 5, v0
    v_mad_u32_u24 v207, v207, 36, 32
    v_sub_u32 v207, v207, v0
    v_mul_u32_u24 v207, 0x10001, v207
    v_add_u32 v207, -1, v207
    v_pk_sub_i16 v200, v207, 32 op_sel_hi:[1,0]
    v_pk_sub_i16 v201, v207, 30 op_sel_hi:[1,0]
    v_pk_sub_i16 v202, v207, 24 op_sel_hi:[1,0]
    v_pk_sub_i16 v203, v207, 22 op_sel_hi:[1,0]
    v_pk_sub_i16 v204, v207, 16 op_sel_hi:[1,0]
    v_pk_sub_i16 v205, v207, 14 op_sel_hi:[1,0]
    v_pk_sub_i16 v206, v207, 8 op_sel_hi:[1,0]
    v_pk_sub_i16 v207, v207, 6 op_sel_hi:[1,0]
    v_pk_ashrrev_i16 v200, 15, v200 op_sel_hi:[0,1]
    v_pk_ashrrev_i16 v201, 15, v201 op_sel_hi:[0,1]
    v_pk_ashrrev_i16 v202, 15, v202 op_sel_hi:[0,1]
    v_pk_ashrrev_i16 v203, 15, v203 op_sel_hi:[0,1]
    v_pk_ashrrev_i16 v204, 15, v204 op_sel_hi:[0,1]
    v_pk_ashrrev_i16 v205, 15, v205 op_sel_hi:[0,1]
    v_pk_ashrrev_i16 v206, 15, v206 op_sel_hi:[0,1]
    v_pk_ashrrev_i16 v207, 15, v207 op_sel_hi:[0,1]
    ds_read_b128 a[208:211], v22 offset:0
    ds_read_b128 a[212:215], v23 offset:1024
    s_waitcnt lgkmcnt(0)
    v_mfma_f32_32x32x16_bf16 v[160:175], a[208:211], v[192:195], v[208:223]
    v_mfma_f32_32x32x16_bf16 v[160:175], a[212:215], v[196:199], v[160:175]
    s_nop 7
    s_nop 7
    ds_read_b128 a[208:211], v22 offset:16384
    ds_read_b128 a[212:215], v23 offset:17408
    s_waitcnt lgkmcnt(0)
    v_mfma_f32_32x32x16_bf16 v[176:191], a[208:211], v[192:195], v[208:223]
    v_mfma_f32_32x32x16_bf16 v[176:191], a[212:215], v[196:199], v[176:191]
    s_nop 7
    s_nop 7
    v_cndmask_b32 v160, v160, v176, s[34:35]
    v_cndmask_b32 v161, v161, v177, s[36:37]
    v_cndmask_b32 v162, v162, v178, s[38:39]
    v_cndmask_b32 v163, v163, v179, s[40:41]
    v_cndmask_b32 v164, v164, v180, s[42:43]
    v_cndmask_b32 v165, v165, v181, s[44:45]
    v_cndmask_b32 v166, v166, v182, s[46:47]
    v_cndmask_b32 v167, v167, v183, s[48:49]
    v_cndmask_b32 v168, v168, v184, s[50:51]
    v_cndmask_b32 v169, v169, v185, s[52:53]
    v_cndmask_b32 v170, v170, v186, s[54:55]
    v_cndmask_b32 v171, v171, v187, s[56:57]
    v_cndmask_b32 v172, v172, v188, s[58:59]
    v_cndmask_b32 v173, v173, v189, s[60:61]
    v_cndmask_b32 v174, v174, v190, s[62:63]
    v_cndmask_b32 v175, v175, v191, s[64:65]
    v_exp_f32 v160, v160
    v_exp_f32 v161, v161
    v_exp_f32 v162, v162
    v_exp_f32 v163, v163
    v_exp_f32 v164, v164
    v_exp_f32 v165, v165
    v_exp_f32 v166, v166
    v_exp_f32 v167, v167
    v_exp_f32 v168, v168
    v_exp_f32 v169, v169
    v_exp_f32 v170, v170
    v_exp_f32 v171, v171
    v_exp_f32 v172, v172
    v_exp_f32 v173, v173
    v_exp_f32 v174, v174
    v_exp_f32 v175, v175
    v_cvt_pk_bf16_f32 v224, v160, v161
    v_cvt_pk_bf16_f32 v225, v162, v163
    v_cvt_pk_bf16_f32 v226, v164, v165
    v_cvt_pk_bf16_f32 v227, v166, v167
    v_cvt_pk_bf16_f32 v228, v168, v169
    v_cvt_pk_bf16_f32 v229, v170, v171
    v_cvt_pk_bf16_f32 v230, v172, v173
    v_cvt_pk_bf16_f32 v231, v174, v175
    v_and_b32 v232, v200, v224
    v_and_b32 v233, v201, v225
    v_and_b32 v234, v202, v226
    v_and_b32 v235, v203, v227
    v_and_b32 v236, v204, v228
    v_and_b32 v237, v205, v229
    v_and_b32 v238, v206, v230
    v_and_b32 v239, v207, v231
    v_xor_b32 v224, v232, v224
    v_xor_b32 v225, v233, v225
    v_xor_b32 v226, v234, v226
    v_xor_b32 v227, v235, v227
    v_xor_b32 v228, v236, v228
    v_xor_b32 v229, v237, v229
    v_xor_b32 v230, v238, v230
    v_xor_b32 v231, v239, v231
    ds_read_b64_tr_b16 a[216:217], v6 offset:0
    ds_read_b64_tr_b16 a[218:219], v7 offset:0
    ds_read_b64_tr_b16 a[220:221], v6 offset:256
    ds_read_b64_tr_b16 a[222:223], v7 offset:256
    s_waitcnt lgkmcnt(0)
    v_mfma_f32_32x32x16_bf16 v[240:255], a[216:219], v[224:227], 0
    v_mfma_f32_32x32x16_bf16 v[240:255], a[220:223], v[228:231], v[240:255]
    ds_read_b64_tr_b16 a[208:209], v6 offset:16384
    ds_read_b64_tr_b16 a[210:211], v7 offset:16384
    ds_read_b64_tr_b16 a[212:213], v6 offset:16640
    ds_read_b64_tr_b16 a[214:215], v7 offset:16640
    s_waitcnt lgkmcnt(0)
    v_mfma_f32_32x32x16_bf16 v[240:255], a[208:211], v[232:235], v[240:255]
    v_mfma_f32_32x32x16_bf16 v[240:255], a[212:215], v[236:239], v[240:255]
    s_nop 7
    s_nop 7
    ds_read_b128 a[208:211], v22 offset:2048
    ds_read_b128 a[212:215], v23 offset:3072
    s_waitcnt lgkmcnt(0)
    v_mfma_f32_32x32x16_bf16 v[160:175], a[208:211], v[192:195], v[208:223]
    v_mfma_f32_32x32x16_bf16 v[160:175], a[212:215], v[196:199], v[160:175]
    s_nop 7
    s_nop 7
    v_exp_f32 v160, v160
    v_exp_f32 v161, v161
    v_exp_f32 v162, v162
    v_exp_f32 v163, v163
    v_exp_f32 v164, v164
    v_exp_f32 v165, v165
    v_exp_f32 v166, v166
    v_exp_f32 v167, v167
    v_exp_f32 v168, v168
    v_exp_f32 v169, v169
    v_exp_f32 v170, v170
    v_exp_f32 v171, v171
    v_exp_f32 v172, v172
    v_exp_f32 v173, v173
    v_exp_f32 v174, v174
    v_exp_f32 v175, v175
    v_cvt_pk_bf16_f32 v224, v160, v161
    v_cvt_pk_bf16_f32 v225, v162, v163
    v_cvt_pk_bf16_f32 v226, v164, v165
    v_cvt_pk_bf16_f32 v227, v166, v167
    v_cvt_pk_bf16_f32 v228, v168, v169
    v_cvt_pk_bf16_f32 v229, v170, v171
    v_cvt_pk_bf16_f32 v230, v172, v173
    v_cvt_pk_bf16_f32 v231, v174, v175
    ds_read_b64_tr_b16 a[216:217], v6 offset:2048
    ds_read_b64_tr_b16 a[218:219], v7 offset:2048
    ds_read_b64_tr_b16 a[220:221], v6 offset:2304
    ds_read_b64_tr_b16 a[222:223], v7 offset:2304
    s_waitcnt lgkmcnt(0)
    v_mfma_f32_32x32x16_bf16 v[240:255], a[216:219], v[224:227], v[240:255]
    v_mfma_f32_32x32x16_bf16 v[240:255], a[220:223], v[228:231], v[240:255]
    ds_read_b128 a[208:211], v22 offset:4096
    ds_read_b128 a[212:215], v23 offset:5120
    s_waitcnt lgkmcnt(0)
    v_mfma_f32_32x32x16_bf16 v[160:175], a[208:211], v[192:195], v[208:223]
    v_mfma_f32_32x32x16_bf16 v[160:175], a[212:215], v[196:199], v[160:175]
    s_nop 7
    s_nop 7
    v_exp_f32 v160, v160
    v_exp_f32 v161, v161
    v_exp_f32 v162, v162
    v_exp_f32 v163, v163
    v_exp_f32 v164, v164
    v_exp_f32 v165, v165
    v_exp_f32 v166, v166
    v_exp_f32 v167, v167
    v_exp_f32 v168, v168
    v_exp_f32 v169, v169
    v_exp_f32 v170, v170
    v_exp_f32 v171, v171
    v_exp_f32 v172, v172
    v_exp_f32 v173, v173
    v_exp_f32 v174, v174
    v_exp_f32 v175, v175
    v_cvt_pk_bf16_f32 v224, v160, v161
    v_cvt_pk_bf16_f32 v225, v162, v163
    v_cvt_pk_bf16_f32 v226, v164, v165
    v_cvt_pk_bf16_f32 v227, v166, v167
    v_cvt_pk_bf16_f32 v228, v168, v169
    v_cvt_pk_bf16_f32 v229, v170, v171
    v_cvt_pk_bf16_f32 v230, v172, v173
    v_cvt_pk_bf16_f32 v231, v174, v175
    ds_read_b64_tr_b16 a[216:217], v6 offset:4096
    ds_read_b64_tr_b16 a[218:219], v7 offset:4096
    ds_read_b64_tr_b16 a[220:221], v6 offset:4352
    ds_read_b64_tr_b16 a[222:223], v7 offset:4352
    s_waitcnt lgkmcnt(0)
    v_mfma_f32_32x32x16_bf16 v[240:255], a[216:219], v[224:227], v[240:255]
    v_mfma_f32_32x32x16_bf16 v[240:255], a[220:223], v[228:231], v[240:255]
    ds_read_b128 a[208:211], v22 offset:6144
    ds_read_b128 a[212:215], v23 offset:7168
    s_waitcnt lgkmcnt(0)
    v_mfma_f32_32x32x16_bf16 v[160:175], a[208:211], v[192:195], v[208:223]
    v_mfma_f32_32x32x16_bf16 v[160:175], a[212:215], v[196:199], v[160:175]
    s_nop 7
    s_nop 7
    v_exp_f32 v160, v160
    v_exp_f32 v161, v161
    v_exp_f32 v162, v162
    v_exp_f32 v163, v163
    v_exp_f32 v164, v164
    v_exp_f32 v165, v165
    v_exp_f32 v166, v166
    v_exp_f32 v167, v167
    v_exp_f32 v168, v168
    v_exp_f32 v169, v169
    v_exp_f32 v170, v170
    v_exp_f32 v171, v171
    v_exp_f32 v172, v172
    v_exp_f32 v173, v173
    v_exp_f32 v174, v174
    v_exp_f32 v175, v175
    v_cvt_pk_bf16_f32 v224, v160, v161
    v_cvt_pk_bf16_f32 v225, v162, v163
    v_cvt_pk_bf16_f32 v226, v164, v165
    v_cvt_pk_bf16_f32 v227, v166, v167
    v_cvt_pk_bf16_f32 v228, v168, v169
    v_cvt_pk_bf16_f32 v229, v170, v171
    v_cvt_pk_bf16_f32 v230, v172, v173
    v_cvt_pk_bf16_f32 v231, v174, v175
    ds_read_b64_tr_b16 a[216:217], v6 offset:6144
    ds_read_b64_tr_b16 a[218:219], v7 offset:6144
    ds_read_b64_tr_b16 a[220:221], v6 offset:6400
    ds_read_b64_tr_b16 a[222:223], v7 offset:6400
    s_waitcnt lgkmcnt(0)
    v_mfma_f32_32x32x16_bf16 v[240:255], a[216:219], v[224:227], v[240:255]
    v_mfma_f32_32x32x16_bf16 v[240:255], a[220:223], v[228:231], v[240:255]
    ds_read_b128 a[208:211], v22 offset:8192
    ds_read_b128 a[212:215], v23 offset:9216
    s_waitcnt lgkmcnt(0)
    v_mfma_f32_32x32x16_bf16 v[160:175], a[208:211], v[192:195], v[208:223]
    v_mfma_f32_32x32x16_bf16 v[160:175], a[212:215], v[196:199], v[160:175]
    s_nop 7
    s_nop 7
    v_exp_f32 v160, v160
    v_exp_f32 v161, v161
    v_exp_f32 v162, v162
    v_exp_f32 v163, v163
    v_exp_f32 v164, v164
    v_exp_f32 v165, v165
    v_exp_f32 v166, v166
    v_exp_f32 v167, v167
    v_exp_f32 v168, v168
    v_exp_f32 v169, v169
    v_exp_f32 v170, v170
    v_exp_f32 v171, v171
    v_exp_f32 v172, v172
    v_exp_f32 v173, v173
    v_exp_f32 v174, v174
    v_exp_f32 v175, v175
    v_cvt_pk_bf16_f32 v224, v160, v161
    v_cvt_pk_bf16_f32 v225, v162, v163
    v_cvt_pk_bf16_f32 v226, v164, v165
    v_cvt_pk_bf16_f32 v227, v166, v167
    v_cvt_pk_bf16_f32 v228, v168, v169
    v_cvt_pk_bf16_f32 v229, v170, v171
    v_cvt_pk_bf16_f32 v230, v172, v173
    v_cvt_pk_bf16_f32 v231, v174, v175
    ds_read_b64_tr_b16 a[216:217], v6 offset:8192
    ds_read_b64_tr_b16 a[218:219], v7 offset:8192
    ds_read_b64_tr_b16 a[220:221], v6 offset:8448
    ds_read_b64_tr_b16 a[222:223], v7 offset:8448
    s_waitcnt lgkmcnt(0)
    v_mfma_f32_32x32x16_bf16 v[240:255], a[216:219], v[224:227], v[240:255]
    v_mfma_f32_32x32x16_bf16 v[240:255], a[220:223], v[228:231], v[240:255]
    ds_read_b128 a[208:211], v22 offset:10240
    ds_read_b128 a[212:215], v23 offset:11264
    s_waitcnt lgkmcnt(0)
    v_mfma_f32_32x32x16_bf16 v[160:175], a[208:211], v[192:195], v[208:223]
    v_mfma_f32_32x32x16_bf16 v[160:175], a[212:215], v[196:199], v[160:175]
    s_nop 7
    s_nop 7
    v_exp_f32 v160, v160
    v_exp_f32 v161, v161
    v_exp_f32 v162, v162
    v_exp_f32 v163, v163
    v_exp_f32 v164, v164
    v_exp_f32 v165, v165
    v_exp_f32 v166, v166
    v_exp_f32 v167, v167
    v_exp_f32 v168, v168
    v_exp_f32 v169, v169
    v_exp_f32 v170, v170
    v_exp_f32 v171, v171
    v_exp_f32 v172, v172
    v_exp_f32 v173, v173
    v_exp_f32 v174, v174
    v_exp_f32 v175, v175
    v_cvt_pk_bf16_f32 v224, v160, v161
    v_cvt_pk_bf16_f32 v225, v162, v163
    v_cvt_pk_bf16_f32 v226, v164, v165
    v_cvt_pk_bf16_f32 v227, v166, v167
    v_cvt_pk_bf16_f32 v228, v168, v169
    v_cvt_pk_bf16_f32 v229, v170, v171
    v_cvt_pk_bf16_f32 v230, v172, v173
    v_cvt_pk_bf16_f32 v231, v174, v175
    ds_read_b64_tr_b16 a[216:217], v6 offset:10240
    ds_read_b64_tr_b16 a[218:219], v7 offset:10240
    ds_read_b64_tr_b16 a[220:221], v6 offset:10496
    ds_read_b64_tr_b16 a[222:223], v7 offset:10496
    s_waitcnt lgkmcnt(0)
    v_mfma_f32_32x32x16_bf16 v[240:255], a[216:219], v[224:227], v[240:255]
    v_mfma_f32_32x32x16_bf16 v[240:255], a[220:223], v[228:231], v[240:255]
    ds_read_b128 a[208:211], v22 offset:12288
    ds_read_b128 a[212:215], v23 offset:13312
    s_waitcnt lgkmcnt(0)
    v_mfma_f32_32x32x16_bf16 v[160:175], a[208:211], v[192:195], v[208:223]
    v_mfma_f32_32x32x16_bf16 v[160:175], a[212:215], v[196:199], v[160:175]
    s_nop 7
    s_nop 7
    v_exp_f32 v160, v160
    v_exp_f32 v161, v161
    v_exp_f32 v162, v162
    v_exp_f32 v163, v163
    v_exp_f32 v164, v164
    v_exp_f32 v165, v165
    v_exp_f32 v166, v166
    v_exp_f32 v167, v167
    v_exp_f32 v168, v168
    v_exp_f32 v169, v169
    v_exp_f32 v170, v170
    v_exp_f32 v171, v171
    v_exp_f32 v172, v172
    v_exp_f32 v173, v173
    v_exp_f32 v174, v174
    v_exp_f32 v175, v175
    v_cvt_pk_bf16_f32 v224, v160, v161
    v_cvt_pk_bf16_f32 v225, v162, v163
    v_cvt_pk_bf16_f32 v226, v164, v165
    v_cvt_pk_bf16_f32 v227, v166, v167
    v_cvt_pk_bf16_f32 v228, v168, v169
    v_cvt_pk_bf16_f32 v229, v170, v171
    v_cvt_pk_bf16_f32 v230, v172, v173
    v_cvt_pk_bf16_f32 v231, v174, v175
    ds_read_b64_tr_b16 a[216:217], v6 offset:12288
    ds_read_b64_tr_b16 a[218:219], v7 offset:12288
    ds_read_b64_tr_b16 a[220:221], v6 offset:12544
    ds_read_b64_tr_b16 a[222:223], v7 offset:12544
    s_waitcnt lgkmcnt(0)
    v_mfma_f32_32x32x16_bf16 v[240:255], a[216:219], v[224:227], v[240:255]
    v_mfma_f32_32x32x16_bf16 v[240:255], a[220:223], v[228:231], v[240:255]
    ds_read_b128 a[208:211], v22 offset:14336
    ds_read_b128 a[212:215], v23 offset:15360
    s_waitcnt lgkmcnt(0)
    v_mfma_f32_32x32x16_bf16 v[160:175], a[208:211], v[192:195], v[208:223]
    v_mfma_f32_32x32x16_bf16 v[160:175], a[212:215], v[196:199], v[160:175]
    s_nop 7
    s_nop 7
    v_exp_f32 v160, v160
    v_exp_f32 v161, v161
    v_exp_f32 v162, v162
    v_exp_f32 v163, v163
    v_exp_f32 v164, v164
    v_exp_f32 v165, v165
    v_exp_f32 v166, v166
    v_exp_f32 v167, v167
    v_exp_f32 v168, v168
    v_exp_f32 v169, v169
    v_exp_f32 v170, v170
    v_exp_f32 v171, v171
    v_exp_f32 v172, v172
    v_exp_f32 v173, v173
    v_exp_f32 v174, v174
    v_exp_f32 v175, v175
    v_cvt_pk_bf16_f32 v224, v160, v161
    v_cvt_pk_bf16_f32 v225, v162, v163
    v_cvt_pk_bf16_f32 v226, v164, v165
    v_cvt_pk_bf16_f32 v227, v166, v167
    v_cvt_pk_bf16_f32 v228, v168, v169
    v_cvt_pk_bf16_f32 v229, v170, v171
    v_cvt_pk_bf16_f32 v230, v172, v173
    v_cvt_pk_bf16_f32 v231, v174, v175
    ds_read_b64_tr_b16 a[216:217], v6 offset:14336
    ds_read_b64_tr_b16 a[218:219], v7 offset:14336
    ds_read_b64_tr_b16 a[220:221], v6 offset:14592
    ds_read_b64_tr_b16 a[222:223], v7 offset:14592
    s_waitcnt lgkmcnt(0)
    v_mfma_f32_32x32x16_bf16 v[240:255], a[216:219], v[224:227], v[240:255]
    v_mfma_f32_32x32x16_bf16 v[240:255], a[220:223], v[228:231], v[240:255]
    s_nop 11
    v_cndmask_b32 v2, 0, v240, s[92:93]
    v_cndmask_b32 v2, v2, v252, s[94:95]
    v_mov_b32 v3, v2
    s_nop 1
    v_permlane32_swap_b32 v2, v3
    v_add_f32 v2, v2, v3
    v_rcp_f32 v2, v2
    s_nop 3
    s_branch L_backattG
L_slowattQ:
    s_waitcnt lgkmcnt(0)
    s_nop 7
    s_nop 7
    ds_read_b128 a[208:211], v22 offset:0
    ds_read_b128 a[212:215], v23 offset:1024
    s_waitcnt lgkmcnt(0)
    v_mfma_f32_32x32x16_bf16 v[160:175], a[208:211], v[192:195], 0
    v_mfma_f32_32x32x16_bf16 v[160:175], a[212:215], v[196:199], v[160:175]
    s_nop 7
    s_nop 7
    ds_read_b128 a[208:211], v22 offset:16384
    ds_read_b128 a[212:215], v23 offset:17408
    s_waitcnt lgkmcnt(0)
    v_mfma_f32_32x32x16_bf16 v[176:191], a[208:211], v[192:195], 0
    v_mfma_f32_32x32x16_bf16 v[176:191], a[212:215], v[196:199], v[176:191]
    s_nop 7
    s_nop 7
    v_cndmask_b32 v160, v160, v176, s[34:35]
    v_cndmask_b32 v161, v161, v177, s[36:37]
    v_cndmask_b32 v162, v162, v178, s[38:39]
    v_cndmask_b32 v163, v163, v179, s[40:41]
    v_cndmask_b32 v164, v164, v180, s[42:43]
    v_cndmask_b32 v165, v165, v181, s[44:45]
    v_cndmask_b32 v166, v166, v182, s[46:47]
    v_cndmask_b32 v167, v167, v183, s[48:49]
    v_cndmask_b32 v168, v168, v184, s[50:51]
    v_cndmask_b32 v169, v169, v185, s[52:53]
    v_cndmask_b32 v170, v170, v186, s[54:55]
    v_cndmask_b32 v171, v171, v187, s[56:57]
    v_cndmask_b32 v172, v172, v188, s[58:59]
    v_cndmask_b32 v173, v173, v189, s[60:61]
    v_cndmask_b32 v174, v174, v190, s[62:63]
    v_cndmask_b32 v175, v175, v191, s[64:65]
    v_max3_f32 v2, v160, v161, v160
    v_max3_f32 v2, v162, v163, v2
    v_max3_f32 v2, v164, v165, v2
    v_max3_f32 v2, v166, v167, v2
    v_max3_f32 v2, v168, v169, v2
    v_max3_f32 v2, v170, v171, v2
    v_max3_f32 v2, v172, v173, v2
    v_max3_f32 v2, v174, v175, v2
    ds_read_b128 a[208:211], v22 offset:2048
    ds_read_b128 a[212:215], v23 offset:3072
    s_waitcnt lgkmcnt(0)
    v_mfma_f32_32x32x16_bf16 v[160:175], a[208:211], v[192:195], 0
    v_mfma_f32_32x32x16_bf16 v[160:175], a[212:215], v[196:199], v[160:175]
    s_nop 7
    s_nop 7
    v_max3_f32 v2, v160, v161, v2
    v_max3_f32 v2, v162, v163, v2
    v_max3_f32 v2, v164, v165, v2
    v_max3_f32 v2, v166, v167, v2
    v_max3_f32 v2, v168, v169, v2
    v_max3_f32 v2, v170, v171, v2
    v_max3_f32 v2, v172, v173, v2
    v_max3_f32 v2, v174, v175, v2
    ds_read_b128 a[208:211], v22 offset:4096
    ds_read_b128 a[212:215], v23 offset:5120
    s_waitcnt lgkmcnt(0)
    v_mfma_f32_32x32x16_bf16 v[160:175], a[208:211], v[192:195], 0
    v_mfma_f32_32x32x16_bf16 v[160:175], a[212:215], v[196:199], v[160:175]
    s_nop 7
    s_nop 7
    v_max3_f32 v2, v160, v161, v2
    v_max3_f32 v2, v162, v163, v2
    v_max3_f32 v2, v164, v165, v2
    v_max3_f32 v2, v166, v167, v2
    v_max3_f32 v2, v168, v169, v2
    v_max3_f32 v2, v170, v171, v2
    v_max3_f32 v2, v172, v173, v2
    v_max3_f32 v2, v174, v175, v2
    ds_read_b128 a[208:211], v22 offset:6144
    ds_read_b128 a[212:215], v23 offset:7168
    s_waitcnt lgkmcnt(0)
    v_mfma_f32_32x32x16_bf16 v[160:175], a[208:211], v[192:195], 0
    v_mfma_f32_32x32x16_bf16 v[160:175], a[212:215], v[196:199], v[160:175]
    s_nop 7
    s_nop 7
    v_max3_f32 v2, v160, v161, v2
    v_max3_f32 v2, v162, v163, v2
    v_max3_f32 v2, v164, v165, v2
    v_max3_f32 v2, v166, v167, v2
    v_max3_f32 v2, v168, v169, v2
    v_max3_f32 v2, v170, v171, v2
    v_max3_f32 v2, v172, v173, v2
    v_max3_f32 v2, v174, v175, v2
    ds_read_b128 a[208:211], v22 offset:8192
    ds_read_b128 a[212:215], v23 offset:9216
    s_waitcnt lgkmcnt(0)
    v_mfma_f32_32x32x16_bf16 v[160:175], a[208:211], v[192:195], 0
    v_mfma_f32_32x32x16_bf16 v[160:175], a[212:215], v[196:199], v[160:175]
    s_nop 7
    s_nop 7
    v_max3_f32 v2, v160, v161, v2
    v_max3_f32 v2, v162, v163, v2
    v_max3_f32 v2, v164, v165, v2
    v_max3_f32 v2, v166, v167, v2
    v_max3_f32 v2, v168, v169, v2
    v_max3_f32 v2, v170, v171, v2
    v_max3_f32 v2, v172, v173, v2
    v_max3_f32 v2, v174, v175, v2
    ds_read_b128 a[208:211], v22 offset:10240
    ds_read_b128 a[212:215], v23 offset:11264
    s_waitcnt lgkmcnt(0)
    v_mfma_f32_32x32x16_bf16 v[160:175], a[208:211], v[192:195], 0
    v_mfma_f32_32x32x16_bf16 v[160:175], a[212:215], v[196:199], v[160:175]
    s_nop 7
    s_nop 7
    v_max3_f32 v2, v160, v161, v2
    v_max3_f32 v2, v162, v163, v2
    v_max3_f32 v2, v164, v165, v2
    v_max3_f32 v2, v166, v167, v2
    v_max3_f32 v2, v168, v169, v2
    v_max3_f32 v2, v170, v171, v2
    v_max3_f32 v2, v172, v173, v2
    v_max3_f32 v2, v174, v175, v2
    ds_read_b128 a[208:211], v22 offset:12288
    ds_read_b128 a[212:215], v23 offset:13312
    s_waitcnt lgkmcnt(0)
    v_mfma_f32_32x32x16_bf16 v[160:175], a[208:211], v[192:195], 0
    v_mfma_f32_32x32x16_bf16 v[160:175], a[212:215], v[196:199], v[160:175]
    s_nop 7
    s_nop 7
    v_max3_f32 v2, v160, v161, v2
    v_max3_f32 v2, v162, v163, v2
    v_max3_f32 v2, v164, v165, v2
    v_max3_f32 v2, v166, v167, v2
    v_max3_f32 v2, v168, v169, v2
    v_max3_f32 v2, v170, v171, v2
    v_max3_f32 v2, v172, v173, v2
    v_max3_f32 v2, v174, v175, v2
    ds_read_b128 a[208:211], v22 offset:14336
    ds_read_b128 a[212:215], v23 offset:15360
    s_waitcnt lgkmcnt(0)
    v_mfma_f32_32x32x16_bf16 v[160:175], a[208:211], v[192:195], 0
    v_mfma_f32_32x32x16_bf16 v[160:175], a[212:215], v[196:199], v[160:175]
    s_nop 7
    s_nop 7
    v_max3_f32 v2, v160, v161, v2
    v_max3_f32 v2, v162, v163, v2
    v_max3_f32 v2, v164, v165, v2
    v_max3_f32 v2, v166, v167, v2
    v_max3_f32 v2, v168, v169, v2
    v_max3_f32 v2, v170, v171, v2
    v_max3_f32 v2, v172, v173, v2
    v_max3_f32 v2, v174, v175, v2
    v_mov_b32 v3, v2
    s_nop 1
    v_permlane32_swap_b32 v2, v3
    v_max_f32 v2, v2, v3
    v_sub_f32 v208, 0, v2
    v_sub_f32 v209, 0, v2
    v_sub_f32 v210, 0, v2
    v_sub_f32 v211, 0, v2
    v_sub_f32 v212, 0, v2
    v_sub_f32 v213, 0, v2
    v_sub_f32 v214, 0, v2
    v_sub_f32 v215, 0, v2
    v_sub_f32 v216, 0, v2
    v_sub_f32 v217, 0, v2
    v_sub_f32 v218, 0, v2
    v_sub_f32 v219, 0, v2
    v_sub_f32 v220, 0, v2
    v_sub_f32 v221, 0, v2
    v_sub_f32 v222, 0, v2
    v_sub_f32 v223, 0, v2
    v_lshrrev_b32 v207, 5, v0
    v_mad_u32_u24 v207, v207, 36, 32
    v_sub_u32 v207, v207, v0
    v_mul_u32_u24 v207, 0x10001, v207
    v_add_u32 v207, -1, v207
    v_pk_sub_i16 v200, v207, 32 op_sel_hi:[1,0]
    v_pk_sub_i16 v201, v207, 30 op_sel_hi:[1,0]
    v_pk_sub_i16 v202, v207, 24 op_sel_hi:[1,0]
    v_pk_sub_i16 v203, v207, 22 op_sel_hi:[1,0]
    v_pk_sub_i16 v204, v207, 16 op_sel_hi:[1,0]
    v_pk_sub_i16 v205, v207, 14 op_sel_hi:[1,0]
    v_pk_sub_i16 v206, v207, 8 op_sel_hi:[1,0]
    v_pk_sub_i16 v207, v207, 6 op_sel_hi:[1,0]
    v_pk_ashrrev_i16 v200, 15, v200 op_sel_hi:[0,1]
    v_pk_ashrrev_i16 v201, 15, v201 op_sel_hi:[0,1]
    v_pk_ashrrev_i16 v202, 15, v202 op_sel_hi:[0,1]
    v_pk_ashrrev_i16 v203, 15, v203 op_sel_hi:[0,1]
    v_pk_ashrrev_i16 v204, 15, v204 op_sel_hi:[0,1]
    v_pk_ashrrev_i16 v205, 15, v205 op_sel_hi:[0,1]
    v_pk_ashrrev_i16 v206, 15, v206 op_sel_hi:[0,1]
    v_pk_ashrrev_i16 v207, 15, v207 op_sel_hi:[0,1]
    ds_read_b128 a[208:211], v22 offset:0
    ds_read_b128 a[212:215], v23 offset:1024
    s_waitcnt lgkmcnt(0)
    v_mfma_f32_32x32x16_bf16 v[160:175], a[208:211], v[192:195], v[208:223]
    v_mfma_f32_32x32x16_bf16 v[160:175], a[212:215], v[196:199], v[160:175]
    s_nop 7
    s_nop 7
    ds_read_b128 a[208:211], v22 offset:16384
    ds_read_b128 a[212:215], v23 offset:17408
    s_waitcnt lgkmcnt(0)
    v_mfma_f32_32x32x16_bf16 v[176:191], a[208:211], v[192:195], v[208:223]
    v_mfma_f32_32x32x16_bf16 v[176:191], a[212:215], v[196:199], v[176:191]
    s_nop 7
    s_nop 7
    v_cndmask_b32 v160, v160, v176, s[34:35]
    v_cndmask_b32 v161, v161, v177, s[36:37]
    v_cndmask_b32 v162, v162, v178, s[38:39]
    v_cndmask_b32 v163, v163, v179, s[40:41]
    v_cndmask_b32 v164, v164, v180, s[42:43]
    v_cndmask_b32 v165, v165, v181, s[44:45]
    v_cndmask_b32 v166, v166, v182, s[46:47]
    v_cndmask_b32 v167, v167, v183, s[48:49]
    v_cndmask_b32 v168, v168, v184, s[50:51]
    v_cndmask_b32 v169, v169, v185, s[52:53]
    v_cndmask_b32 v170, v170, v186, s[54:55]
    v_cndmask_b32 v171, v171, v187, s[56:57]
    v_cndmask_b32 v172, v172, v188, s[58:59]
    v_cndmask_b32 v173, v173, v189, s[60:61]
    v_cndmask_b32 v174, v174, v190, s[62:63]
    v_cndmask_b32 v175, v175, v191, s[64:65]
    v_exp_f32 v160, v160
    v_exp_f32 v161, v161
    v_exp_f32 v162, v162
    v_exp_f32 v163, v163
    v_exp_f32 v164, v164
    v_exp_f32 v165, v165
    v_exp_f32 v166, v166
    v_exp_f32 v167, v167
    v_exp_f32 v168, v168
    v_exp_f32 v169, v169
    v_exp_f32 v170, v170
    v_exp_f32 v171, v171
    v_exp_f32 v172, v172
    v_exp_f32 v173, v173
    v_exp_f32 v174, v174
    v_exp_f32 v175, v175
    v_cvt_pk_bf16_f32 v224, v160, v161
    v_cvt_pk_bf16_f32 v225, v162, v163
    v_cvt_pk_bf16_f32 v226, v164, v165
    v_cvt_pk_bf16_f32 v227, v166, v167
    v_cvt_pk_bf16_f32 v228, v168, v169
    v_cvt_pk_bf16_f32 v229, v170, v171
    v_cvt_pk_bf16_f32 v230, v172, v173
    v_cvt_pk_bf16_f32 v231, v174, v175
    v_and_b32 v232, v200, v224
    v_and_b32 v233, v201, v225
    v_and_b32 v234, v202, v226
    v_and_b32 v235, v203, v227
    v_and_b32 v236, v204, v228
    v_and_b32 v237, v205, v229
    v_and_b32 v238, v206, v230
    v_and_b32 v239, v207, v231
    v_xor_b32 v224, v232, v224
    v_xor_b32 v225, v233, v225
    v_xor_b32 v226, v234, v226
    v_xor_b32 v227, v235, v227
    v_xor_b32 v228, v236, v228
    v_xor_b32 v229, v237, v229
    v_xor_b32 v230, v238, v230
    v_xor_b32 v231, v239, v231
    ds_read_b64_tr_b16 a[216:217], v14 offset:0
    ds_read_b64_tr_b16 a[218:219], v15 offset:0
    ds_read_b64_tr_b16 a[220:221], v14 offset:256
    ds_read_b64_tr_b16 a[222:223], v15 offset:256
    s_waitcnt lgkmcnt(0)
    v_mfma_f32_32x32x16_bf16 v[240:255], a[216:219], v[224:227], 0
    v_mfma_f32_32x32x16_bf16 v[240:255], a[220:223], v[228:231], v[240:255]
    ds_read_b64_tr_b16 a[208:209], v14 offset:16384
    ds_read_b64_tr_b16 a[210:211], v15 offset:16384
    ds_read_b64_tr_b16 a[212:213], v14 offset:16640
    ds_read_b64_tr_b16 a[214:215], v15 offset:16640
    s_waitcnt lgkmcnt(0)
    v_mfma_f32_32x32x16_bf16 v[240:255], a[208:211], v[232:235], v[240:255]
    v_mfma_f32_32x32x16_bf16 v[240:255], a[212:215], v[236:239], v[240:255]
    s_nop 7
    s_nop 7
    ds_read_b128 a[208:211], v22 offset:2048
    ds_read_b128 a[212:215], v23 offset:3072
    s_waitcnt lgkmcnt(0)
    v_mfma_f32_32x32x16_bf16 v[160:175], a[208:211], v[192:195], v[208:223]
    v_mfma_f32_32x32x16_bf16 v[160:175], a[212:215], v[196:199], v[160:175]
    s_nop 7
    s_nop 7
    v_exp_f32 v160, v160
    v_exp_f32 v161, v161
    v_exp_f32 v162, v162
    v_exp_f32 v163, v163
    v_exp_f32 v164, v164
    v_exp_f32 v165, v165
    v_exp_f32 v166, v166
    v_exp_f32 v167, v167
    v_exp_f32 v168, v168
    v_exp_f32 v169, v169
    v_exp_f32 v170, v170
    v_exp_f32 v171, v171
    v_exp_f32 v172, v172
    v_exp_f32 v173, v173
    v_exp_f32 v174, v174
    v_exp_f32 v175, v175
    v_cvt_pk_bf16_f32 v224, v160, v161
    v_cvt_pk_bf16_f32 v225, v162, v163
    v_cvt_pk_bf16_f32 v226, v164, v165
    v_cvt_pk_bf16_f32 v227, v166, v167
    v_cvt_pk_bf16_f32 v228, v168, v169
    v_cvt_pk_bf16_f32 v229, v170, v171
    v_cvt_pk_bf16_f32 v230, v172, v173
    v_cvt_pk_bf16_f32 v231, v174, v175
    ds_read_b64_tr_b16 a[216:217], v14 offset:2048
    ds_read_b64_tr_b16 a[218:219], v15 offset:2048
    ds_read_b64_tr_b16 a[220:221], v14 offset:2304
    ds_read_b64_tr_b16 a[222:223], v15 offset:2304
    s_waitcnt lgkmcnt(0)
    v_mfma_f32_32x32x16_bf16 v[240:255], a[216:219], v[224:227], v[240:255]
    v_mfma_f32_32x32x16_bf16 v[240:255], a[220:223], v[228:231], v[240:255]
    ds_read_b128 a[208:211], v22 offset:4096
    ds_read_b128 a[212:215], v23 offset:5120
    s_waitcnt lgkmcnt(0)
    v_mfma_f32_32x32x16_bf16 v[160:175], a[208:211], v[192:195], v[208:223]
    v_mfma_f32_32x32x16_bf16 v[160:175], a[212:215], v[196:199], v[160:175]
    s_nop 7
    s_nop 7
    v_exp_f32 v160, v160
    v_exp_f32 v161, v161
    v_exp_f32 v162, v162
    v_exp_f32 v163, v163
    v_exp_f32 v164, v164
    v_exp_f32 v165, v165
    v_exp_f32 v166, v166
    v_exp_f32 v167, v167
    v_exp_f32 v168, v168
    v_exp_f32 v169, v169
    v_exp_f32 v170, v170
    v_exp_f32 v171, v171
    v_exp_f32 v172, v172
    v_exp_f32 v173, v173
    v_exp_f32 v174, v174
    v_exp_f32 v175, v175
    v_cvt_pk_bf16_f32 v224, v160, v161
    v_cvt_pk_bf16_f32 v225, v162, v163
    v_cvt_pk_bf16_f32 v226, v164, v165
    v_cvt_pk_bf16_f32 v227, v166, v167
    v_cvt_pk_bf16_f32 v228, v168, v169
    v_cvt_pk_bf16_f32 v229, v170, v171
    v_cvt_pk_bf16_f32 v230, v172, v173
    v_cvt_pk_bf16_f32 v231, v174, v175
    ds_read_b64_tr_b16 a[216:217], v14 offset:4096
    ds_read_b64_tr_b16 a[218:219], v15 offset:4096
    ds_read_b64_tr_b16 a[220:221], v14 offset:4352
    ds_read_b64_tr_b16 a[222:223], v15 offset:4352
    s_waitcnt lgkmcnt(0)
    v_mfma_f32_32x32x16_bf16 v[240:255], a[216:219], v[224:227], v[240:255]
    v_mfma_f32_32x32x16_bf16 v[240:255], a[220:223], v[228:231], v[240:255]
    ds_read_b128 a[208:211], v22 offset:6144
    ds_read_b128 a[212:215], v23 offset:7168
    s_waitcnt lgkmcnt(0)
    v_mfma_f32_32x32x16_bf16 v[160:175], a[208:211], v[192:195], v[208:223]
    v_mfma_f32_32x32x16_bf16 v[160:175], a[212:215], v[196:199], v[160:175]
    s_nop 7
    s_nop 7
    v_exp_f32 v160, v160
    v_exp_f32 v161, v161
    v_exp_f32 v162, v162
    v_exp_f32 v163, v163
    v_exp_f32 v164, v164
    v_exp_f32 v165, v165
    v_exp_f32 v166, v166
    v_exp_f32 v167, v167
    v_exp_f32 v168, v168
    v_exp_f32 v169, v169
    v_exp_f32 v170, v170
    v_exp_f32 v171, v171
    v_exp_f32 v172, v172
    v_exp_f32 v173, v173
    v_exp_f32 v174, v174
    v_exp_f32 v175, v175
    v_cvt_pk_bf16_f32 v224, v160, v161
    v_cvt_pk_bf16_f32 v225, v162, v163
    v_cvt_pk_bf16_f32 v226, v164, v165
    v_cvt_pk_bf16_f32 v227, v166, v167
    v_cvt_pk_bf16_f32 v228, v168, v169
    v_cvt_pk_bf16_f32 v229, v170, v171
    v_cvt_pk_bf16_f32 v230, v172, v173
    v_cvt_pk_bf16_f32 v231, v174, v175
    ds_read_b64_tr_b16 a[216:217], v14 offset:6144
    ds_read_b64_tr_b16 a[218:219], v15 offset:6144
    ds_read_b64_tr_b16 a[220:221], v14 offset:6400
    ds_read_b64_tr_b16 a[222:223], v15 offset:6400
    s_waitcnt lgkmcnt(0)
    v_mfma_f32_32x32x16_bf16 v[240:255], a[216:219], v[224:227], v[240:255]
    v_mfma_f32_32x32x16_bf16 v[240:255], a[220:223], v[228:231], v[240:255]
    ds_read_b128 a[208:211], v22 offset:8192
    ds_read_b128 a[212:215], v23 offset:9216
    s_waitcnt lgkmcnt(0)
    v_mfma_f32_32x32x16_bf16 v[160:175], a[208:211], v[192:195], v[208:223]
    v_mfma_f32_32x32x16_bf16 v[160:175], a[212:215], v[196:199], v[160:175]
    s_nop 7
    s_nop 7
    v_exp_f32 v160, v160
    v_exp_f32 v161, v161
    v_exp_f32 v162, v162
    v_exp_f32 v163, v163
    v_exp_f32 v164, v164
    v_exp_f32 v165, v165
    v_exp_f32 v166, v166
    v_exp_f32 v167, v167
    v_exp_f32 v168, v168
    v_exp_f32 v169, v169
    v_exp_f32 v170, v170
    v_exp_f32 v171, v171
    v_exp_f32 v172, v172
    v_exp_f32 v173, v173
    v_exp_f32 v174, v174
    v_exp_f32 v175, v175
    v_cvt_pk_bf16_f32 v224, v160, v161
    v_cvt_pk_bf16_f32 v225, v162, v163
    v_cvt_pk_bf16_f32 v226, v164, v165
    v_cvt_pk_bf16_f32 v227, v166, v167
    v_cvt_pk_bf16_f32 v228, v168, v169
    v_cvt_pk_bf16_f32 v229, v170, v171
    v_cvt_pk_bf16_f32 v230, v172, v173
    v_cvt_pk_bf16_f32 v231, v174, v175
    ds_read_b64_tr_b16 a[216:217], v14 offset:8192
    ds_read_b64_tr_b16 a[218:219], v15 offset:8192
    ds_read_b64_tr_b16 a[220:221], v14 offset:8448
    ds_read_b64_tr_b16 a[222:223], v15 offset:8448
    s_waitcnt lgkmcnt(0)
    v_mfma_f32_32x32x16_bf16 v[240:255], a[216:219], v[224:227], v[240:255]
    v_mfma_f32_32x32x16_bf16 v[240:255], a[220:223], v[228:231], v[240:255]
    ds_read_b128 a[208:211], v22 offset:10240
    ds_read_b128 a[212:215], v23 offset:11264
    s_waitcnt lgkmcnt(0)
    v_mfma_f32_32x32x16_bf16 v[160:175], a[208:211], v[192:195], v[208:223]
    v_mfma_f32_32x32x16_bf16 v[160:175], a[212:215], v[196:199], v[160:175]
    s_nop 7
    s_nop 7
    v_exp_f32 v160, v160
    v_exp_f32 v161, v161
    v_exp_f32 v162, v162
    v_exp_f32 v163, v163
    v_exp_f32 v164, v164
    v_exp_f32 v165, v165
    v_exp_f32 v166, v166
    v_exp_f32 v167, v167
    v_exp_f32 v168, v168
    v_exp_f32 v169, v169
    v_exp_f32 v170, v170
    v_exp_f32 v171, v171
    v_exp_f32 v172, v172
    v_exp_f32 v173, v173
    v_exp_f32 v174, v174
    v_exp_f32 v175, v175
    v_cvt_pk_bf16_f32 v224, v160, v161
    v_cvt_pk_bf16_f32 v225, v162, v163
    v_cvt_pk_bf16_f32 v226, v164, v165
    v_cvt_pk_bf16_f32 v227, v166, v167
    v_cvt_pk_bf16_f32 v228, v168, v169
    v_cvt_pk_bf16_f32 v229, v170, v171
    v_cvt_pk_bf16_f32 v230, v172, v173
    v_cvt_pk_bf16_f32 v231, v174, v175
    ds_read_b64_tr_b16 a[216:217], v14 offset:10240
    ds_read_b64_tr_b16 a[218:219], v15 offset:10240
    ds_read_b64_tr_b16 a[220:221], v14 offset:10496
    ds_read_b64_tr_b16 a[222:223], v15 offset:10496
    s_waitcnt lgkmcnt(0)
    v_mfma_f32_32x32x16_bf16 v[240:255], a[216:219], v[224:227], v[240:255]
    v_mfma_f32_32x32x16_bf16 v[240:255], a[220:223], v[228:231], v[240:255]
    ds_read_b128 a[208:211], v22 offset:12288
    ds_read_b128 a[212:215], v23 offset:13312
    s_waitcnt lgkmcnt(0)
    v_mfma_f32_32x32x16_bf16 v[160:175], a[208:211], v[192:195], v[208:223]
    v_mfma_f32_32x32x16_bf16 v[160:175], a[212:215], v[196:199], v[160:175]
    s_nop 7
    s_nop 7
    v_exp_f32 v160, v160
    v_exp_f32 v161, v161
    v_exp_f32 v162, v162
    v_exp_f32 v163, v163
    v_exp_f32 v164, v164
    v_exp_f32 v165, v165
    v_exp_f32 v166, v166
    v_exp_f32 v167, v167
    v_exp_f32 v168, v168
    v_exp_f32 v169, v169
    v_exp_f32 v170, v170
    v_exp_f32 v171, v171
    v_exp_f32 v172, v172
    v_exp_f32 v173, v173
    v_exp_f32 v174, v174
    v_exp_f32 v175, v175
    v_cvt_pk_bf16_f32 v224, v160, v161
    v_cvt_pk_bf16_f32 v225, v162, v163
    v_cvt_pk_bf16_f32 v226, v164, v165
    v_cvt_pk_bf16_f32 v227, v166, v167
    v_cvt_pk_bf16_f32 v228, v168, v169
    v_cvt_pk_bf16_f32 v229, v170, v171
    v_cvt_pk_bf16_f32 v230, v172, v173
    v_cvt_pk_bf16_f32 v231, v174, v175
    ds_read_b64_tr_b16 a[216:217], v14 offset:12288
    ds_read_b64_tr_b16 a[218:219], v15 offset:12288
    ds_read_b64_tr_b16 a[220:221], v14 offset:12544
    ds_read_b64_tr_b16 a[222:223], v15 offset:12544
    s_waitcnt lgkmcnt(0)
    v_mfma_f32_32x32x16_bf16 v[240:255], a[216:219], v[224:227], v[240:255]
    v_mfma_f32_32x32x16_bf16 v[240:255], a[220:223], v[228:231], v[240:255]
    ds_read_b128 a[208:211], v22 offset:14336
    ds_read_b128 a[212:215], v23 offset:15360
    s_waitcnt lgkmcnt(0)
    v_mfma_f32_32x32x16_bf16 v[160:175], a[208:211], v[192:195], v[208:223]
    v_mfma_f32_32x32x16_bf16 v[160:175], a[212:215], v[196:199], v[160:175]
    s_nop 7
    s_nop 7
    v_exp_f32 v160, v160
    v_exp_f32 v161, v161
    v_exp_f32 v162, v162
    v_exp_f32 v163, v163
    v_exp_f32 v164, v164
    v_exp_f32 v165, v165
    v_exp_f32 v166, v166
    v_exp_f32 v167, v167
    v_exp_f32 v168, v168
    v_exp_f32 v169, v169
    v_exp_f32 v170, v170
    v_exp_f32 v171, v171
    v_exp_f32 v172, v172
    v_exp_f32 v173, v173
    v_exp_f32 v174, v174
    v_exp_f32 v175, v175
    v_cvt_pk_bf16_f32 v224, v160, v161
    v_cvt_pk_bf16_f32 v225, v162, v163
    v_cvt_pk_bf16_f32 v226, v164, v165
    v_cvt_pk_bf16_f32 v227, v166, v167
    v_cvt_pk_bf16_f32 v228, v168, v169
    v_cvt_pk_bf16_f32 v229, v170, v171
    v_cvt_pk_bf16_f32 v230, v172, v173
    v_cvt_pk_bf16_f32 v231, v174, v175
    ds_read_b64_tr_b16 a[216:217], v14 offset:14336
    ds_read_b64_tr_b16 a[218:219], v15 offset:14336
    ds_read_b64_tr_b16 a[220:221], v14 offset:14592
    ds_read_b64_tr_b16 a[222:223], v15 offset:14592
    s_waitcnt lgkmcnt(0)
    v_mfma_f32_32x32x16_bf16 v[240:255], a[216:219], v[224:227], v[240:255]
    v_mfma_f32_32x32x16_bf16 v[240:255], a[220:223], v[228:231], v[240:255]
    s_nop 11
    v_cndmask_b32 v2, 0, v240, s[92:93]
    v_cndmask_b32 v2, v2, v252, s[94:95]
    v_mov_b32 v3, v2
    s_nop 1
    v_permlane32_swap_b32 v2, v3
    v_add_f32 v2, v2, v3
    v_rcp_f32 v2, v2
    s_nop 3
    s_branch L_backattQ
L_exit:
    s_endpgm
.section .rodata,"a"
.p2align 6
.amdhsa_kernel recurrent_scan__sliding_block__glu_gated_swiglu__prompt_kernel
  .amdhsa_next_free_vgpr 512
  .amdhsa_next_free_sgpr 102
  .amdhsa_accum_offset 256
  .amdhsa_group_segment_fixed_size 0
  .amdhsa_kernarg_size 80
  .amdhsa_user_sgpr_count 2
  .amdhsa_user_sgpr_kernarg_segment_ptr 1
  .amdhsa_system_sgpr_workgroup_id_x 1
.end_amdhsa_kernel
```
